```python
import torch

def _softmax(x, axis=-1):
    return torch.softmax(x, dim=axis)

def _gelu(x):
    return torch.nn.functional.gelu(x, approximate='tanh')

def _silu(x):
    return torch.nn.functional.silu(x)

def _sigmoid(x):
    return torch.sigmoid(x)

def _layernorm(x, axis=-1, eps=1e-05):
    m = x.mean(dim=axis, keepdim=True)
    v = x.var(dim=axis, keepdim=True, unbiased=False)
    return (x - m) / torch.sqrt(v + eps)

def _scatter_add(tgt, idx, src, axis=0):
    return tgt.clone().index_add_(axis, idx, src)

def _segment_sum(src, seg, n):
    out = torch.zeros((n,) + src.shape[1:], dtype=src.dtype)
    return out.index_add_(0, seg, src)

def _pad(x, pw):
    flat = tuple((v for pair in reversed(pw) for v in pair))
    return torch.nn.functional.pad(x, flat)
kernel_name = 'parallel_sum__memory_aug_recurrent_mem_tr__moe_arch_mod__prompt'

def setup_inputs():

    _w = lambda a: (lambda t: t.to(torch.bfloat16) if t.is_floating_point() else t)(torch.as_tensor(a))

    def _A_setup():
        B, S, Dm = (1, 2048, 512)
        H, Dh = (32, 128)
        M, seg = (8, 32)
        seg = min(seg, S)
        S = S // seg * seg
        return {'x': _w((lambda *s: torch.randn(*s, dtype=torch.bfloat16) * 0.05)(B, S, Dm)), 'mem0': _w((lambda *s: torch.randn(*s, dtype=torch.bfloat16) * 1.6)(B, M, Dm)), 'Wq': _w((lambda *s: torch.randn(*s, dtype=torch.bfloat16) * 0.8)(Dm, H, Dh) * Dm ** (-0.5)), 'Wk': _w((lambda *s: torch.randn(*s, dtype=torch.bfloat16) * 0.8)(Dm, H, Dh) * Dm ** (-0.5)), 'Wv': _w((lambda *s: torch.randn(*s, dtype=torch.bfloat16) * 1.6)(Dm, H, Dh) * Dm ** (-0.5)), 'Wo': _w((lambda *s: torch.randn(*s, dtype=torch.bfloat16) * 1.6)(H, Dh, Dm) * (H * Dh) ** (-0.5)), 'seg_len': seg}
    _A_in = _A_setup()

    def _B_setup():
        B, S, D, F, C = (1, 2048, 512, 1792, 2)
        return {'x': _w((lambda *s: torch.randn(*s, dtype=torch.bfloat16) * 0.05)(B, S, D)), 'w_r': _w((lambda *s: torch.randn(*s, dtype=torch.bfloat16) * 0.05)(D)), 'w_gate': _w((lambda *s: torch.randn(*s, dtype=torch.bfloat16) * 0.05)(D, F)), 'w_up': _w((lambda *s: torch.randn(*s, dtype=torch.bfloat16) * 0.05)(D, F)), 'w_down': _w((lambda *s: torch.randn(*s, dtype=torch.bfloat16) * 0.05)(F, D))}
    _B_in = _B_setup()
    return {'A_x': _A_in['x'], 'A_mem0': _A_in['mem0'], 'A_Wq': _A_in['Wq'], 'A_Wk': _A_in['Wk'], 'A_Wv': _A_in['Wv'], 'A_Wo': _A_in['Wo'], 'A_seg_len': _A_in['seg_len'], 'B_x': _B_in['x'], 'B_w_r': _B_in['w_r'], 'B_w_gate': _B_in['w_gate'], 'B_w_up': _B_in['w_up'], 'B_w_down': _B_in['w_down']}

def reference(A_x, A_mem0, A_Wq, A_Wk, A_Wv, A_Wo, A_seg_len, B_x, B_w_r, B_w_gate, B_w_up, B_w_down):

    def _A_ref(x, mem0, Wq, Wk, Wv, Wo, seg_len):
        B, S, Dm = x.shape
        H, Dh = (Wq.shape[1], Wq.shape[2])
        M = mem0.shape[1]
        scale = Dh ** (-0.5)
        n_seg = S // seg_len
        L = M + seg_len
        idx = torch.arange(L)
        mask = (idx[:, None] < M) | (idx[:, None] >= idx[None, :])
        mem = mem0
        outs = []
        for s in range(n_seg):
            xs = x[:, s * seg_len:(s + 1) * seg_len, :].clone()
            h = torch.concatenate([mem, xs], axis=1)
            q = torch.einsum('btd,dhe->bhte', h, Wq)
            k = torch.einsum('btd,dhe->bhte', h, Wk)
            v = torch.einsum('btd,dhe->bhte', h, Wv)
            scores = torch.einsum('bhqe,bhke->bhqk', q, k) * scale
            scores = torch.where(mask[None, None], scores, -1000000000.0)
            p = _softmax(scores, axis=-1)
            o = torch.einsum('bhqk,bhke->bhqe', p, v)
            o = torch.einsum('bhte,hed->btd', o, Wo)
            mem = o[:, :M, :].clone()
            outs.append(o[:, M:, :])
        return torch.concatenate(outs, axis=1)

    def _B_ref(x, w_r, w_gate, w_up, w_down):
        B, S, D = x.shape
        C = 2
        r = x @ w_r
        idx = torch.argsort(-r, axis=-1)[:, :C]
        idx_e = (lambda x, n, axis: torch.repeat_interleave(x, n, dim=axis))(idx.reshape(B, C, 1), D, axis=2)
        x_sel = (lambda x, i, axis: torch.take_along_dim(x, i, dim=axis))(x, idx_e, axis=1)
        g = _silu(x_sel @ w_gate)
        u = x_sel @ w_up
        y = g * u @ w_down
        r_sel = _sigmoid((lambda x, i, axis: torch.take_along_dim(x, i, dim=axis))(r, idx, axis=1))
        y = y * r_sel.reshape(B, C, 1)
        b_off = (torch.arange(B) * S).reshape(B, 1)
        flat_idx = (idx + b_off).reshape(B * C)
        zero = (x * 0.0).reshape(B * S, D)
        upd = _scatter_add(zero, flat_idx, y.reshape(B * C, D), axis=0)
        return x + upd.reshape(B, S, D)
    x = A_x
    xn = _layernorm(x, axis=-1)
    return x + _A_ref(xn, A_mem0, A_Wq, A_Wk, A_Wv, A_Wo, A_seg_len) + _B_ref(xn, B_w_r, B_w_gate, B_w_up, B_w_down)
```

```asm
; @launch grid=(256,1,1) block=(256,1,1) lds=163840
.amdgcn_target "amdgcn-amd-amdhsa--gfx950"
.text
.globl parallel_sum__memory_aug_recurrent_mem_tr__moe_arch_mod__prompt_kernel
.p2align 8
.type parallel_sum__memory_aug_recurrent_mem_tr__moe_arch_mod__prompt_kernel,@function
parallel_sum__memory_aug_recurrent_mem_tr__moe_arch_mod__prompt_kernel:
    s_cmp_ge_u32 s2, 256
    s_cbranch_scc1 L_end0
    s_load_dwordx4 s[4:7], s[0:1], 104
    s_load_dwordx4 s[76:79], s[0:1], 0
    s_load_dwordx8 s[80:87], s[0:1], 16
    s_load_dwordx8 s[88:95], s[0:1], 64
    s_load_dwordx2 s[70:71], s[0:1], 96
    s_getreg_b32 s20, hwreg(HW_REG_XCC_ID)
    s_and_b32 s20, s20, 7
    v_lshrrev_b32 v1, 6, v0
    s_nop 0
    v_readfirstlane_b32 s21, v1
    s_waitcnt lgkmcnt(0)
    s_mov_b32 s8, s6
    s_and_b32 s9, s7, 0xffff
    s_mov_b32 s10, 0x10000000
    s_mov_b32 s11, 0x00020000
    s_mov_b32 s12, s4
    s_and_b32 s13, s5, 0xffff
    s_mov_b32 s14, 0x100
    s_mov_b32 s15, 0x00020000
    s_cmp_lg_u32 s21, 0
    s_cbranch_scc1 L_role_wait
    s_mov_b64 exec, 1
    v_mov_b32 v3, 1
    s_lshl_b32 s25, s20, 5
    v_mov_b32 v4, s25
    buffer_atomic_add v3, v4, s[12:15], 0 offen sc0
    s_add_u32 s25, s20, 1
    v_mov_b32 v5, 0
    s_mov_b32 s26, 0
    s_cmp_ge_u32 s2, 64
    s_cbranch_scc1 L_poll_win
    s_and_b32 s24, s20, 3
    s_cbranch_scc1 L_bid
L_poll_win:
    buffer_load_dword v6, v5, s[12:15], 0 offen offset:4 sc1
    s_waitcnt vmcnt(0)
    v_readfirstlane_b32 s24, v6
    s_cmp_lg_u32 s24, 0
    s_cbranch_scc1 L_have_win
    s_add_u32 s26, s26, 1
    s_cmp_lt_u32 s26, 12
    s_cbranch_scc1 L_poll_win
L_bid:
    v_mov_b32 v6, s25
    v_mov_b32 v7, 0
    buffer_atomic_cmpswap v[6:7], v5, s[12:15], 0 offen offset:4 sc0
    s_waitcnt vmcnt(0)
    v_readfirstlane_b32 s24, v6
    s_cmp_eq_u32 s24, 0
    s_cselect_b32 s24, s25, s24
L_have_win:
    v_readfirstlane_b32 s22, v3
    s_mov_b32 s23, 0xffff
    s_cmp_gt_u32 s22, 31
    s_cbranch_scc1 L_role_done
    s_sub_u32 s24, s24, 1
    s_xor_b32 s24, s24, s20
    s_sub_u32 s23, s24, 3
    s_add_u32 s25, s24, 4
    s_cmp_ge_u32 s24, 4
    s_cselect_b32 s23, s23, s25
    s_cmp_eq_u32 s24, 0
    s_cselect_b32 s23, 0, s23
    s_lshl_b32 s23, s23, 5
    s_add_u32 s23, s23, s22
L_role_done:
    v_mov_b32 v3, s23
    v_mov_b32 v4, 0
    ds_write_b32 v4, v3
    s_mov_b64 exec, -1
L_role_wait:
    s_waitcnt lgkmcnt(0)
    s_barrier
    v_mov_b32 v4, 0
    ds_read_b32 v3, v4
    s_waitcnt lgkmcnt(0)
    v_readfirstlane_b32 s23, v3
    s_barrier
    s_cmp_gt_u32 s23, 31
    s_cbranch_scc1 L_worker
    v_and_b32 v18, 63, v0
    v_and_b32 v16, 15, v0
    v_lshrrev_b32 v17, 4, v18
    v_lshlrev_b32 v2, 4, v18
    v_lshlrev_b32 v3, 4, v0
    v_add_u32 v4, 0x10000, v3
    v_add_u32 v5, 0x20000, v3
    v_xor_b32 v6, 1024, v3
    v_xor_b32 v7, 2048, v3
    v_xor_b32 v8, 3072, v3
    v_and_b32 v19, 2, v16
    v_cmp_ne_u32 vcc, 0, v19
    v_mov_b32 v20, 0x4444
    v_mov_b32 v21, 0xeeee
    v_cndmask_b32 v1, v20, v21, vcc
    v_and_b32 v22, 4, v16
    v_cmp_ne_u32 vcc, 0, v22
    s_nop 1
    v_cndmask_b32 v20, v20, v21, vcc
    v_lshl_or_b32 v1, v20, 16, v1
    v_lshrrev_b32 v20, 2, v16
    v_and_b32 v21, 1, v16
    v_lshl_add_u32 v20, v20, 1, v21
    v_mul_u32_u24 v22, 320, v20
    v_lshl_add_u32 v13, v17, 5, v22
    v_lshl_add_u32 v13, v19, 3, v13
    v_and_b32 v30, 4, v16
    v_lshlrev_b32 v30, 2, v30
    v_xor_b32 v13, v13, v30
    v_lshlrev_b32 v22, 1, v19
    v_xor_b32 v20, v20, v22
    v_mul_u32_u24 v22, 320, v20
    v_mul_u32_u24 v20, 544, v20
    v_lshl_add_u32 v11, v17, 4, v20
    s_lshl_b32 s25, s21, 6
    v_lshl_add_u32 v12, v17, 4, v22
    v_add_u32 v12, s25, v12
    v_lshl_add_u32 v12, v19, 2, v12
    v_xor_b32 v12, v12, v30
    v_mul_u32_u24 v20, 1088, v17
    v_lshl_add_u32 v20, v16, 2, v20
    v_add_u32 v10, s25, v20
    v_add_u32 v10, 24576, v10
    v_lshrrev_b32 v20, 1, v16
    s_lshl_b32 s25, s21, 3
    v_add_u32 v20, s25, v20
    v_lshlrev_b32 v20, 12, v20
    v_lshrrev_b32 v22, 1, v17
    v_lshl_add_u32 v20, v22, 11, v20
    v_and_b32 v19, 1, v17
    v_lshl_add_u32 v20, v19, 5, v20
    v_lshl_add_u32 v20, v21, 4, v20
    s_lshl_b32 s25, s23, 6
    v_add_u32 v9, s25, v20
    v_bfe_u32 v20, v16, 1, 1
    s_and_b32 s25, s21, 2
    v_add_u32 v20, s25, v20
    v_lshl_add_u32 v30, v20, 2, v22
    v_lshlrev_b32 v30, 4, v30
    v_lshl_add_u32 v30, v21, 3, v30
    v_lshl_add_u32 v30, v19, 2, v30
    s_lshr_b32 s25, s23, 1
    s_lshl_b32 s25, s25, 8
    s_and_b32 s27, s23, 1
    s_lshl_b32 s27, s27, 5
    s_add_u32 s25, s25, s27
    v_add_u32 v30, s25, v30
    v_cmp_gt_u32 vcc, 4, v16
    v_mov_b32 v28, 0x7f000000
    s_nop 0
    v_cndmask_b32 v28, v28, v30, vcc
    v_mov_b32 v14, v28
    v_lshl_add_u32 v20, v20, 1, v22
    v_lshlrev_b32 v20, 10, v20
    v_lshl_add_u32 v20, v21, 4, v20
    v_lshl_add_u32 v20, v19, 2, v20
    s_lshl_b32 s25, s23, 5
    v_add_u32 v29, s25, v20
    v_lshlrev_b32 v21, 4, v21
    v_mov_b32 v22, 0x3f80
    v_lshlrev_b32 v22, v21, v22
    v_lshrrev_b32 v21, 2, v16
    v_cmp_eq_u32 vcc, 0, v21
    s_nop 1
    v_cndmask_b32 v32, 0, v22, vcc
    v_cmp_eq_u32 vcc, 1, v21
    s_nop 1
    v_cndmask_b32 v33, 0, v22, vcc
    v_cmp_eq_u32 vcc, 2, v21
    s_nop 1
    v_cndmask_b32 v34, 0, v22, vcc
    v_cmp_eq_u32 vcc, 3, v21
    s_nop 1
    v_cndmask_b32 v35, 0, v22, vcc
    ds_write_b128 v2, v[32:35] offset:31744
    v_lshrrev_b32 v19, 1, v17
    v_and_b32 v20, 1, v17
    v_lshlrev_b32 v21, 18, v19
    v_lshl_add_u32 v21, v20, 16, v21
    s_lshl_b32 s25, s23, 8
    s_lshl_b32 s27, s21, 6
    s_add_u32 s25, s25, s27
    v_add_u32 v21, s25, v21
    v_lshl_add_u32 v23, v16, 2, v21
    v_add_u32 v24, 0x2000, v23
    v_lshlrev_b32 v21, 12, v20
    v_lshl_add_u32 v21, v19, 14, v21
    v_lshl_add_u32 v21, v16, 4, v21
    s_lshl_b32 s25, s23, 17
    s_lshl_b32 s27, s21, 8
    s_add_u32 s25, s25, s27
    v_add_u32 v27, s25, v21
    s_mov_b32 s39, 0x05040100
    s_mov_b32 s40, 0x07060302
    v_lshrrev_b32 v25, 4, v0
    v_lshlrev_b32 v25, 13, v25
    v_lshl_add_u32 v25, v16, 4, v25
    s_lshl_b32 s25, s23, 8
    v_add_u32 v25, s25, v25
    s_xor_b32 s44, s21, 0
    s_lshl_b32 s44, s44, 20
    s_xor_b32 s45, s21, 1
    s_lshl_b32 s45, s45, 20
    s_xor_b32 s46, s21, 2
    s_lshl_b32 s46, s46, 20
    s_xor_b32 s47, s21, 3
    s_lshl_b32 s47, s47, 20
    v_mov_b32 v112, -1
    v_mov_b32 v113, -1
    v_mov_b32 v114, -1
    v_mov_b32 v115, -1
    s_lshl_b32 s34, s23, 12
    s_and_b32 s33, s21, 1
    s_lshl_b32 s27, s33, 3
    s_lshl_b32 s33, s33, 12
    s_add_u32 s37, s33, 1572864
    s_add_u32 s33, s33, 1048576
    s_waitcnt lgkmcnt(0)
    s_mov_b32 s16, s78
    s_and_b32 s17, s79, 0xffff
    s_mov_b32 s18, 0x2000
    s_mov_b32 s19, 0x00020000
    buffer_load_dword v15, v29, s[16:19], s27 offen
    s_mov_b32 s52, s86
    s_and_b32 s53, s87, 0xffff
    s_mov_b32 s54, 0x400000
    s_mov_b32 s55, 0x00020000
    v_lshlrev_b32 v25, 13, v17
    v_lshl_add_u32 v25, v16, 4, v25
    s_lshl_b32 s25, s23, 8
    s_lshl_b32 s27, s21, 20
    s_add_u32 s25, s25, s27
    v_add_u32 v25, s25, v25
    v_lshlrev_b32 v19, 10, v17
    v_lshl_add_u32 v19, v16, 2, v19
    s_lshl_b32 s25, s21, 6
    s_add_u32 s25, s25, 98304
    v_add_u32 v19, s25, v19
    s_lshl_b32 s56, s21, 12
    s_add_u32 s56, s56, 98304
    s_lshr_b32 s25, s44, 8
    v_add_u32 v116, s25, v19
    s_lshr_b32 s25, s45, 8
    v_add_u32 v117, s25, v19
    s_lshr_b32 s25, s46, 8
    v_add_u32 v118, s25, v19
    s_lshr_b32 s25, s47, 8
    v_add_u32 v119, s25, v19
    s_mov_b32 s16, s80
    s_and_b32 s17, s81, 0xffff
    s_mov_b32 s18, 0x400000
    s_mov_b32 s19, 0x00020000
    s_add_u32 m0, s56, 0
    s_mov_b32 s25, 0
    buffer_load_dwordx4 v25, s[16:19], s25 offen lds
    s_add_u32 m0, s56, 1024
    s_mov_b32 s25, 65536
    buffer_load_dwordx4 v25, s[16:19], s25 offen lds
    s_add_u32 m0, s56, 2048
    s_mov_b32 s25, 262144
    buffer_load_dwordx4 v25, s[16:19], s25 offen lds
    s_add_u32 m0, s56, 3072
    s_mov_b32 s25, 327680
    buffer_load_dwordx4 v25, s[16:19], s25 offen lds
    s_add_u32 m0, s56, 16384
    s_mov_b32 s25, 131072
    buffer_load_dwordx4 v25, s[16:19], s25 offen lds
    s_add_u32 m0, s56, 17408
    s_mov_b32 s25, 196608
    buffer_load_dwordx4 v25, s[16:19], s25 offen lds
    s_add_u32 m0, s56, 18432
    s_mov_b32 s25, 393216
    buffer_load_dwordx4 v25, s[16:19], s25 offen lds
    s_add_u32 m0, s56, 19456
    s_mov_b32 s25, 458752
    buffer_load_dwordx4 v25, s[16:19], s25 offen lds
    s_add_u32 m0, s56, 32768
    s_mov_b32 s25, 524288
    buffer_load_dwordx4 v25, s[16:19], s25 offen lds
    s_add_u32 m0, s56, 33792
    s_mov_b32 s25, 589824
    buffer_load_dwordx4 v25, s[16:19], s25 offen lds
    s_add_u32 m0, s56, 34816
    s_mov_b32 s25, 786432
    buffer_load_dwordx4 v25, s[16:19], s25 offen lds
    s_add_u32 m0, s56, 35840
    s_mov_b32 s25, 851968
    buffer_load_dwordx4 v25, s[16:19], s25 offen lds
    s_waitcnt vmcnt(8)
    s_waitcnt lgkmcnt(0)
    s_barrier
    s_add_u32 m0, s56, 49152
    s_mov_b32 s25, 655360
    buffer_load_dwordx4 v25, s[16:19], s25 offen lds
    s_add_u32 m0, s56, 50176
    s_mov_b32 s25, 720896
    buffer_load_dwordx4 v25, s[16:19], s25 offen lds
    s_add_u32 m0, s56, 51200
    s_mov_b32 s25, 917504
    buffer_load_dwordx4 v25, s[16:19], s25 offen lds
    s_add_u32 m0, s56, 52224
    s_mov_b32 s25, 983040
    buffer_load_dwordx4 v25, s[16:19], s25 offen lds
    ds_read2st64_b32 v[96:97], v116 offset0:0 offset1:1
    ds_read2st64_b32 v[98:99], v116 offset0:2 offset1:3
    ds_read2st64_b32 v[100:101], v117 offset0:0 offset1:1
    ds_read2st64_b32 v[102:103], v117 offset0:2 offset1:3
    ds_read2st64_b32 v[120:121], v118 offset0:0 offset1:1
    ds_read2st64_b32 v[122:123], v118 offset0:2 offset1:3
    ds_read2st64_b32 v[124:125], v119 offset0:0 offset1:1
    ds_read2st64_b32 v[126:127], v119 offset0:2 offset1:3
    s_waitcnt lgkmcnt(6)
    v_perm_b32 v104, v97, v96, s39
    v_accvgpr_write_b32 a0, v104
    v_perm_b32 v105, v97, v96, s40
    ds_write_b32 v3, v105 offset:32768
    v_perm_b32 v106, v99, v98, s39
    v_accvgpr_write_b32 a2, v106
    v_perm_b32 v107, v99, v98, s40
    ds_write_b32 v3, v107 offset:32776
    s_waitcnt lgkmcnt(0)
    v_perm_b32 v108, v101, v100, s39
    v_accvgpr_write_b32 a8, v108
    v_perm_b32 v109, v101, v100, s40
    v_accvgpr_write_b32 a16, v109
    v_perm_b32 v110, v103, v102, s39
    v_accvgpr_write_b32 a10, v110
    v_perm_b32 v111, v103, v102, s40
    v_accvgpr_write_b32 a18, v111
    s_waitcnt lgkmcnt(0)
    v_perm_b32 v104, v121, v120, s39
    v_accvgpr_write_b32 a24, v104
    v_perm_b32 v105, v121, v120, s40
    v_accvgpr_write_b32 a32, v105
    v_perm_b32 v106, v123, v122, s39
    v_accvgpr_write_b32 a26, v106
    v_perm_b32 v107, v123, v122, s40
    v_accvgpr_write_b32 a34, v107
    s_waitcnt lgkmcnt(0)
    v_perm_b32 v108, v125, v124, s39
    v_accvgpr_write_b32 a40, v108
    v_perm_b32 v109, v125, v124, s40
    ds_write_b32 v4, v109 offset:8192
    v_perm_b32 v110, v127, v126, s39
    v_accvgpr_write_b32 a42, v110
    v_perm_b32 v111, v127, v126, s40
    ds_write_b32 v4, v111 offset:8200
    s_waitcnt vmcnt(8)
    s_waitcnt lgkmcnt(0)
    s_barrier
    s_add_u32 s25, s34, 0
    buffer_store_dwordx4 v[112:115], v3, s[8:11], s25 offen
    s_add_u32 s25, s34, 131072
    buffer_store_dwordx4 v[112:115], v3, s[8:11], s25 offen
    s_add_u32 s25, s34, 262144
    buffer_store_dwordx4 v[112:115], v3, s[8:11], s25 offen
    s_add_u32 s25, s34, 393216
    buffer_store_dwordx4 v[112:115], v3, s[8:11], s25 offen
    s_lshl_b32 s27, s23, 14
    s_add_u32 s25, s27, 1572864
    buffer_store_dwordx4 v[112:115], v3, s[8:11], s25 offen sc1
    s_add_u32 s25, s27, 1576960
    buffer_store_dwordx4 v[112:115], v3, s[8:11], s25 offen sc1
    s_add_u32 s25, s27, 1581056
    buffer_store_dwordx4 v[112:115], v3, s[8:11], s25 offen sc1
    s_add_u32 s25, s27, 1585152
    buffer_store_dwordx4 v[112:115], v3, s[8:11], s25 offen sc1
    s_add_u32 s25, s33, 8192
    buffer_store_dword v112, v28, s[8:11], s25 offen
    s_add_u32 s25, s33, 16384
    buffer_store_dword v112, v28, s[8:11], s25 offen
    s_add_u32 s25, s33, 24576
    buffer_store_dword v112, v28, s[8:11], s25 offen
    v_min_u32 v15, 0xfffffffe, v15
    buffer_store_dword v15, v28, s[8:11], s33 offen
    s_add_u32 m0, s56, 0
    s_mov_b32 s25, 32768
    buffer_load_dwordx4 v25, s[16:19], s25 offen lds
    s_add_u32 m0, s56, 1024
    s_mov_b32 s25, 98304
    buffer_load_dwordx4 v25, s[16:19], s25 offen lds
    s_add_u32 m0, s56, 2048
    s_mov_b32 s25, 294912
    buffer_load_dwordx4 v25, s[16:19], s25 offen lds
    s_add_u32 m0, s56, 3072
    s_mov_b32 s25, 360448
    buffer_load_dwordx4 v25, s[16:19], s25 offen lds
    s_mov_b32 s25, 0
    buffer_load_dwordx4 v[32:35], v27, s[52:55], s25 offen
    buffer_load_dwordx4 v[36:39], v27, s[52:55], s25 offen offset:1024
    s_mov_b32 s25, 8192
    buffer_load_dwordx4 v[40:43], v27, s[52:55], s25 offen
    buffer_load_dwordx4 v[44:47], v27, s[52:55], s25 offen offset:1024
    ds_read2st64_b32 v[96:97], v116 offset0:64 offset1:65
    ds_read2st64_b32 v[98:99], v116 offset0:66 offset1:67
    ds_read2st64_b32 v[100:101], v117 offset0:64 offset1:65
    ds_read2st64_b32 v[102:103], v117 offset0:66 offset1:67
    ds_read2st64_b32 v[120:121], v118 offset0:64 offset1:65
    ds_read2st64_b32 v[122:123], v118 offset0:66 offset1:67
    ds_read2st64_b32 v[124:125], v119 offset0:64 offset1:65
    ds_read2st64_b32 v[126:127], v119 offset0:66 offset1:67
    s_waitcnt lgkmcnt(6)
    v_perm_b32 v104, v97, v96, s39
    v_accvgpr_write_b32 a1, v104
    v_perm_b32 v105, v97, v96, s40
    ds_write_b32 v3, v105 offset:32772
    v_perm_b32 v106, v99, v98, s39
    v_accvgpr_write_b32 a3, v106
    v_perm_b32 v107, v99, v98, s40
    ds_write_b32 v3, v107 offset:32780
    s_waitcnt lgkmcnt(0)
    v_perm_b32 v108, v101, v100, s39
    v_accvgpr_write_b32 a9, v108
    v_perm_b32 v109, v101, v100, s40
    v_accvgpr_write_b32 a17, v109
    v_perm_b32 v110, v103, v102, s39
    v_accvgpr_write_b32 a11, v110
    v_perm_b32 v111, v103, v102, s40
    v_accvgpr_write_b32 a19, v111
    s_waitcnt lgkmcnt(0)
    v_perm_b32 v104, v121, v120, s39
    v_accvgpr_write_b32 a25, v104
    v_perm_b32 v105, v121, v120, s40
    v_accvgpr_write_b32 a33, v105
    v_perm_b32 v106, v123, v122, s39
    v_accvgpr_write_b32 a27, v106
    v_perm_b32 v107, v123, v122, s40
    v_accvgpr_write_b32 a35, v107
    s_waitcnt lgkmcnt(0)
    v_perm_b32 v108, v125, v124, s39
    v_accvgpr_write_b32 a41, v108
    v_perm_b32 v109, v125, v124, s40
    ds_write_b32 v4, v109 offset:8196
    v_perm_b32 v110, v127, v126, s39
    v_accvgpr_write_b32 a43, v110
    v_perm_b32 v111, v127, v126, s40
    ds_write_b32 v4, v111 offset:8204
    s_waitcnt vmcnt(24)
    s_waitcnt lgkmcnt(0)
    s_barrier
    s_add_u32 m0, s56, 16384
    s_mov_b32 s25, 163840
    buffer_load_dwordx4 v25, s[16:19], s25 offen lds
    s_add_u32 m0, s56, 17408
    s_mov_b32 s25, 229376
    buffer_load_dwordx4 v25, s[16:19], s25 offen lds
    s_add_u32 m0, s56, 18432
    s_mov_b32 s25, 425984
    buffer_load_dwordx4 v25, s[16:19], s25 offen lds
    s_add_u32 m0, s56, 19456
    s_mov_b32 s25, 491520
    buffer_load_dwordx4 v25, s[16:19], s25 offen lds
    s_mov_b32 s25, 2048
    buffer_load_dwordx4 v[48:51], v27, s[52:55], s25 offen
    buffer_load_dwordx4 v[52:55], v27, s[52:55], s25 offen offset:1024
    s_mov_b32 s25, 10240
    buffer_load_dwordx4 v[56:59], v27, s[52:55], s25 offen
    buffer_load_dwordx4 v[60:63], v27, s[52:55], s25 offen offset:1024
    ds_read2st64_b32 v[96:97], v116 offset0:128 offset1:129
    ds_read2st64_b32 v[98:99], v116 offset0:130 offset1:131
    ds_read2st64_b32 v[100:101], v117 offset0:128 offset1:129
    ds_read2st64_b32 v[102:103], v117 offset0:130 offset1:131
    ds_read2st64_b32 v[120:121], v118 offset0:128 offset1:129
    ds_read2st64_b32 v[122:123], v118 offset0:130 offset1:131
    ds_read2st64_b32 v[124:125], v119 offset0:128 offset1:129
    ds_read2st64_b32 v[126:127], v119 offset0:130 offset1:131
    s_waitcnt lgkmcnt(6)
    v_perm_b32 v104, v97, v96, s39
    v_accvgpr_write_b32 a4, v104
    v_perm_b32 v105, v97, v96, s40
    ds_write_b32 v3, v105 offset:36864
    v_perm_b32 v106, v99, v98, s39
    v_accvgpr_write_b32 a6, v106
    v_perm_b32 v107, v99, v98, s40
    ds_write_b32 v3, v107 offset:36872
    s_waitcnt lgkmcnt(0)
    v_perm_b32 v108, v101, v100, s39
    v_accvgpr_write_b32 a12, v108
    v_perm_b32 v109, v101, v100, s40
    v_accvgpr_write_b32 a20, v109
    v_perm_b32 v110, v103, v102, s39
    v_accvgpr_write_b32 a14, v110
    v_perm_b32 v111, v103, v102, s40
    v_accvgpr_write_b32 a22, v111
    s_waitcnt lgkmcnt(0)
    v_perm_b32 v104, v121, v120, s39
    v_accvgpr_write_b32 a28, v104
    v_perm_b32 v105, v121, v120, s40
    v_accvgpr_write_b32 a36, v105
    v_perm_b32 v106, v123, v122, s39
    v_accvgpr_write_b32 a30, v106
    v_perm_b32 v107, v123, v122, s40
    v_accvgpr_write_b32 a38, v107
    s_waitcnt lgkmcnt(0)
    v_perm_b32 v108, v125, v124, s39
    v_accvgpr_write_b32 a44, v108
    v_perm_b32 v109, v125, v124, s40
    ds_write_b32 v4, v109 offset:12288
    v_perm_b32 v110, v127, v126, s39
    v_accvgpr_write_b32 a46, v110
    v_perm_b32 v111, v127, v126, s40
    ds_write_b32 v4, v111 offset:12296
    s_waitcnt vmcnt(28)
    s_waitcnt lgkmcnt(0)
    s_barrier
    s_add_u32 m0, s56, 32768
    s_mov_b32 s25, 557056
    buffer_load_dwordx4 v25, s[16:19], s25 offen lds
    s_add_u32 m0, s56, 33792
    s_mov_b32 s25, 622592
    buffer_load_dwordx4 v25, s[16:19], s25 offen lds
    s_add_u32 m0, s56, 34816
    s_mov_b32 s25, 819200
    buffer_load_dwordx4 v25, s[16:19], s25 offen lds
    s_add_u32 m0, s56, 35840
    s_mov_b32 s25, 884736
    buffer_load_dwordx4 v25, s[16:19], s25 offen lds
    s_mov_b32 s25, 32768
    buffer_load_dwordx4 v[64:67], v27, s[52:55], s25 offen
    buffer_load_dwordx4 v[68:71], v27, s[52:55], s25 offen offset:1024
    s_mov_b32 s25, 40960
    buffer_load_dwordx4 v[72:75], v27, s[52:55], s25 offen
    buffer_load_dwordx4 v[76:79], v27, s[52:55], s25 offen offset:1024
    ds_read2st64_b32 v[96:97], v116 offset0:192 offset1:193
    ds_read2st64_b32 v[98:99], v116 offset0:194 offset1:195
    ds_read2st64_b32 v[100:101], v117 offset0:192 offset1:193
    ds_read2st64_b32 v[102:103], v117 offset0:194 offset1:195
    ds_read2st64_b32 v[120:121], v118 offset0:192 offset1:193
    ds_read2st64_b32 v[122:123], v118 offset0:194 offset1:195
    ds_read2st64_b32 v[124:125], v119 offset0:192 offset1:193
    ds_read2st64_b32 v[126:127], v119 offset0:194 offset1:195
    s_waitcnt lgkmcnt(6)
    v_perm_b32 v104, v97, v96, s39
    v_accvgpr_write_b32 a5, v104
    v_perm_b32 v105, v97, v96, s40
    ds_write_b32 v3, v105 offset:36868
    v_perm_b32 v106, v99, v98, s39
    v_accvgpr_write_b32 a7, v106
    v_perm_b32 v107, v99, v98, s40
    ds_write_b32 v3, v107 offset:36876
    s_waitcnt lgkmcnt(0)
    v_perm_b32 v108, v101, v100, s39
    v_accvgpr_write_b32 a13, v108
    v_perm_b32 v109, v101, v100, s40
    v_accvgpr_write_b32 a21, v109
    v_perm_b32 v110, v103, v102, s39
    v_accvgpr_write_b32 a15, v110
    v_perm_b32 v111, v103, v102, s40
    v_accvgpr_write_b32 a23, v111
    s_waitcnt lgkmcnt(0)
    v_perm_b32 v104, v121, v120, s39
    v_accvgpr_write_b32 a29, v104
    v_perm_b32 v105, v121, v120, s40
    v_accvgpr_write_b32 a37, v105
    v_perm_b32 v106, v123, v122, s39
    v_accvgpr_write_b32 a31, v106
    v_perm_b32 v107, v123, v122, s40
    v_accvgpr_write_b32 a39, v107
    s_waitcnt lgkmcnt(0)
    v_perm_b32 v108, v125, v124, s39
    v_accvgpr_write_b32 a45, v108
    v_perm_b32 v109, v125, v124, s40
    ds_write_b32 v4, v109 offset:12292
    v_perm_b32 v110, v127, v126, s39
    v_accvgpr_write_b32 a47, v110
    v_perm_b32 v111, v127, v126, s40
    ds_write_b32 v4, v111 offset:12300
    s_waitcnt vmcnt(20)
    s_waitcnt lgkmcnt(0)
    s_barrier
    s_barrier
    s_cmp_lg_u32 s21, 0
    s_cbranch_scc1 L_t_arrived
    s_mov_b64 exec, 1
    v_mov_b32 v112, 1
    v_mov_b32 v113, 0
    buffer_atomic_add v112, v113, s[12:15], 0 offen offset:36
    s_mov_b64 exec, -1
L_t_arrived:
    s_add_u32 m0, s56, 49152
    s_mov_b32 s25, 688128
    buffer_load_dwordx4 v25, s[16:19], s25 offen lds
    s_add_u32 m0, s56, 50176
    s_mov_b32 s25, 753664
    buffer_load_dwordx4 v25, s[16:19], s25 offen lds
    s_add_u32 m0, s56, 51200
    s_mov_b32 s25, 950272
    buffer_load_dwordx4 v25, s[16:19], s25 offen lds
    s_add_u32 m0, s56, 52224
    s_mov_b32 s25, 1015808
    buffer_load_dwordx4 v25, s[16:19], s25 offen lds
    ds_read2st64_b32 v[96:97], v116 offset0:0 offset1:1
    ds_read2st64_b32 v[98:99], v116 offset0:2 offset1:3
    ds_read2st64_b32 v[100:101], v117 offset0:0 offset1:1
    ds_read2st64_b32 v[102:103], v117 offset0:2 offset1:3
    ds_read2st64_b32 v[120:121], v118 offset0:0 offset1:1
    ds_read2st64_b32 v[122:123], v118 offset0:2 offset1:3
    ds_read2st64_b32 v[124:125], v119 offset0:0 offset1:1
    ds_read2st64_b32 v[126:127], v119 offset0:2 offset1:3
    s_waitcnt lgkmcnt(6)
    v_perm_b32 v104, v97, v96, s39
    ds_write_b32 v3, v104 offset:49152
    v_perm_b32 v105, v97, v96, s40
    v_accvgpr_write_b32 a48, v105
    v_perm_b32 v106, v99, v98, s39
    ds_write_b32 v3, v106 offset:49160
    v_perm_b32 v107, v99, v98, s40
    v_accvgpr_write_b32 a50, v107
    s_waitcnt lgkmcnt(0)
    v_perm_b32 v108, v101, v100, s39
    v_accvgpr_write_b32 a56, v108
    v_perm_b32 v109, v101, v100, s40
    v_accvgpr_write_b32 a64, v109
    v_perm_b32 v110, v103, v102, s39
    v_accvgpr_write_b32 a58, v110
    v_perm_b32 v111, v103, v102, s40
    v_accvgpr_write_b32 a66, v111
    s_waitcnt lgkmcnt(0)
    v_perm_b32 v104, v121, v120, s39
    v_accvgpr_write_b32 a72, v104
    v_perm_b32 v105, v121, v120, s40
    v_accvgpr_write_b32 a80, v105
    v_perm_b32 v106, v123, v122, s39
    v_accvgpr_write_b32 a74, v106
    v_perm_b32 v107, v123, v122, s40
    v_accvgpr_write_b32 a82, v107
    s_waitcnt lgkmcnt(0)
    v_perm_b32 v108, v125, v124, s39
    v_accvgpr_write_b32 a88, v108
    v_perm_b32 v109, v125, v124, s40
    v_accvgpr_write_b32 a96, v109
    v_perm_b32 v110, v127, v126, s39
    v_accvgpr_write_b32 a90, v110
    v_perm_b32 v111, v127, v126, s40
    v_accvgpr_write_b32 a98, v111
    s_waitcnt vmcnt(16)
    s_waitcnt lgkmcnt(0)
    s_barrier
    s_mov_b32 s16, s82
    s_and_b32 s17, s83, 0xffff
    s_mov_b32 s18, 0x400000
    s_mov_b32 s19, 0x00020000
    s_add_u32 m0, s56, 0
    s_mov_b32 s25, 0
    buffer_load_dwordx4 v25, s[16:19], s25 offen lds
    s_add_u32 m0, s56, 1024
    s_mov_b32 s25, 65536
    buffer_load_dwordx4 v25, s[16:19], s25 offen lds
    s_add_u32 m0, s56, 2048
    s_mov_b32 s25, 262144
    buffer_load_dwordx4 v25, s[16:19], s25 offen lds
    s_add_u32 m0, s56, 3072
    s_mov_b32 s25, 327680
    buffer_load_dwordx4 v25, s[16:19], s25 offen lds
    s_mov_b32 s25, 34816
    buffer_load_dwordx4 v[80:83], v27, s[52:55], s25 offen
    buffer_load_dwordx4 v[84:87], v27, s[52:55], s25 offen offset:1024
    s_mov_b32 s25, 43008
    buffer_load_dwordx4 v[88:91], v27, s[52:55], s25 offen
    buffer_load_dwordx4 v[92:95], v27, s[52:55], s25 offen offset:1024
    ds_read2st64_b32 v[96:97], v116 offset0:64 offset1:65
    ds_read2st64_b32 v[98:99], v116 offset0:66 offset1:67
    ds_read2st64_b32 v[100:101], v117 offset0:64 offset1:65
    ds_read2st64_b32 v[102:103], v117 offset0:66 offset1:67
    ds_read2st64_b32 v[120:121], v118 offset0:64 offset1:65
    ds_read2st64_b32 v[122:123], v118 offset0:66 offset1:67
    ds_read2st64_b32 v[124:125], v119 offset0:64 offset1:65
    ds_read2st64_b32 v[126:127], v119 offset0:66 offset1:67
    s_waitcnt lgkmcnt(6)
    v_perm_b32 v104, v97, v96, s39
    ds_write_b32 v3, v104 offset:49156
    v_perm_b32 v105, v97, v96, s40
    v_accvgpr_write_b32 a49, v105
    v_perm_b32 v106, v99, v98, s39
    ds_write_b32 v3, v106 offset:49164
    v_perm_b32 v107, v99, v98, s40
    v_accvgpr_write_b32 a51, v107
    s_waitcnt lgkmcnt(0)
    v_perm_b32 v108, v101, v100, s39
    v_accvgpr_write_b32 a57, v108
    v_perm_b32 v109, v101, v100, s40
    v_accvgpr_write_b32 a65, v109
    v_perm_b32 v110, v103, v102, s39
    v_accvgpr_write_b32 a59, v110
    v_perm_b32 v111, v103, v102, s40
    v_accvgpr_write_b32 a67, v111
    s_waitcnt lgkmcnt(0)
    v_perm_b32 v104, v121, v120, s39
    v_accvgpr_write_b32 a73, v104
    v_perm_b32 v105, v121, v120, s40
    v_accvgpr_write_b32 a81, v105
    v_perm_b32 v106, v123, v122, s39
    v_accvgpr_write_b32 a75, v106
    v_perm_b32 v107, v123, v122, s40
    v_accvgpr_write_b32 a83, v107
    s_waitcnt lgkmcnt(0)
    v_perm_b32 v108, v125, v124, s39
    v_accvgpr_write_b32 a89, v108
    v_perm_b32 v109, v125, v124, s40
    v_accvgpr_write_b32 a97, v109
    v_perm_b32 v110, v127, v126, s39
    v_accvgpr_write_b32 a91, v110
    v_perm_b32 v111, v127, v126, s40
    v_accvgpr_write_b32 a99, v111
    s_waitcnt vmcnt(16)
    s_waitcnt lgkmcnt(0)
    s_barrier
    s_add_u32 m0, s56, 16384
    s_mov_b32 s25, 131072
    buffer_load_dwordx4 v25, s[16:19], s25 offen lds
    s_add_u32 m0, s56, 17408
    s_mov_b32 s25, 196608
    buffer_load_dwordx4 v25, s[16:19], s25 offen lds
    s_add_u32 m0, s56, 18432
    s_mov_b32 s25, 393216
    buffer_load_dwordx4 v25, s[16:19], s25 offen lds
    s_add_u32 m0, s56, 19456
    s_mov_b32 s25, 458752
    buffer_load_dwordx4 v25, s[16:19], s25 offen lds
    ds_read2st64_b32 v[96:97], v116 offset0:128 offset1:129
    ds_read2st64_b32 v[98:99], v116 offset0:130 offset1:131
    ds_read2st64_b32 v[100:101], v117 offset0:128 offset1:129
    ds_read2st64_b32 v[102:103], v117 offset0:130 offset1:131
    ds_read2st64_b32 v[120:121], v118 offset0:128 offset1:129
    ds_read2st64_b32 v[122:123], v118 offset0:130 offset1:131
    ds_read2st64_b32 v[124:125], v119 offset0:128 offset1:129
    ds_read2st64_b32 v[126:127], v119 offset0:130 offset1:131
    s_waitcnt lgkmcnt(6)
    v_perm_b32 v104, v97, v96, s39
    ds_write_b32 v3, v104 offset:53248
    v_perm_b32 v105, v97, v96, s40
    v_accvgpr_write_b32 a52, v105
    v_perm_b32 v106, v99, v98, s39
    ds_write_b32 v3, v106 offset:53256
    v_perm_b32 v107, v99, v98, s40
    v_accvgpr_write_b32 a54, v107
    s_waitcnt lgkmcnt(0)
    v_perm_b32 v108, v101, v100, s39
    v_accvgpr_write_b32 a60, v108
    v_perm_b32 v109, v101, v100, s40
    v_accvgpr_write_b32 a68, v109
    v_perm_b32 v110, v103, v102, s39
    v_accvgpr_write_b32 a62, v110
    v_perm_b32 v111, v103, v102, s40
    v_accvgpr_write_b32 a70, v111
    s_waitcnt lgkmcnt(0)
    v_perm_b32 v104, v121, v120, s39
    v_accvgpr_write_b32 a76, v104
    v_perm_b32 v105, v121, v120, s40
    v_accvgpr_write_b32 a84, v105
    v_perm_b32 v106, v123, v122, s39
    v_accvgpr_write_b32 a78, v106
    v_perm_b32 v107, v123, v122, s40
    v_accvgpr_write_b32 a86, v107
    s_waitcnt lgkmcnt(0)
    v_perm_b32 v108, v125, v124, s39
    v_accvgpr_write_b32 a92, v108
    v_perm_b32 v109, v125, v124, s40
    v_accvgpr_write_b32 a100, v109
    v_perm_b32 v110, v127, v126, s39
    v_accvgpr_write_b32 a94, v110
    v_perm_b32 v111, v127, v126, s40
    v_accvgpr_write_b32 a102, v111
    s_waitcnt vmcnt(12)
    s_waitcnt lgkmcnt(0)
    s_barrier
    s_add_u32 m0, s56, 32768
    s_mov_b32 s25, 524288
    buffer_load_dwordx4 v25, s[16:19], s25 offen lds
    s_add_u32 m0, s56, 33792
    s_mov_b32 s25, 589824
    buffer_load_dwordx4 v25, s[16:19], s25 offen lds
    s_add_u32 m0, s56, 34816
    s_mov_b32 s25, 786432
    buffer_load_dwordx4 v25, s[16:19], s25 offen lds
    s_add_u32 m0, s56, 35840
    s_mov_b32 s25, 851968
    buffer_load_dwordx4 v25, s[16:19], s25 offen lds
    ds_read2st64_b32 v[96:97], v116 offset0:192 offset1:193
    ds_read2st64_b32 v[98:99], v116 offset0:194 offset1:195
    ds_read2st64_b32 v[100:101], v117 offset0:192 offset1:193
    ds_read2st64_b32 v[102:103], v117 offset0:194 offset1:195
    ds_read2st64_b32 v[120:121], v118 offset0:192 offset1:193
    ds_read2st64_b32 v[122:123], v118 offset0:194 offset1:195
    ds_read2st64_b32 v[124:125], v119 offset0:192 offset1:193
    ds_read2st64_b32 v[126:127], v119 offset0:194 offset1:195
    s_waitcnt lgkmcnt(6)
    v_perm_b32 v104, v97, v96, s39
    ds_write_b32 v3, v104 offset:53252
    v_perm_b32 v105, v97, v96, s40
    v_accvgpr_write_b32 a53, v105
    v_perm_b32 v106, v99, v98, s39
    ds_write_b32 v3, v106 offset:53260
    v_perm_b32 v107, v99, v98, s40
    v_accvgpr_write_b32 a55, v107
    s_waitcnt lgkmcnt(0)
    v_perm_b32 v108, v101, v100, s39
    v_accvgpr_write_b32 a61, v108
    v_perm_b32 v109, v101, v100, s40
    v_accvgpr_write_b32 a69, v109
    v_perm_b32 v110, v103, v102, s39
    v_accvgpr_write_b32 a63, v110
    v_perm_b32 v111, v103, v102, s40
    v_accvgpr_write_b32 a71, v111
    s_waitcnt lgkmcnt(0)
    v_perm_b32 v104, v121, v120, s39
    v_accvgpr_write_b32 a77, v104
    v_perm_b32 v105, v121, v120, s40
    v_accvgpr_write_b32 a85, v105
    v_perm_b32 v106, v123, v122, s39
    v_accvgpr_write_b32 a79, v106
    v_perm_b32 v107, v123, v122, s40
    v_accvgpr_write_b32 a87, v107
    s_waitcnt lgkmcnt(0)
    v_perm_b32 v108, v125, v124, s39
    v_accvgpr_write_b32 a93, v108
    v_perm_b32 v109, v125, v124, s40
    v_accvgpr_write_b32 a101, v109
    v_perm_b32 v110, v127, v126, s39
    v_accvgpr_write_b32 a95, v110
    v_perm_b32 v111, v127, v126, s40
    v_accvgpr_write_b32 a103, v111
    s_waitcnt vmcnt(12)
    s_waitcnt lgkmcnt(0)
    s_barrier
    s_add_u32 m0, s56, 49152
    s_mov_b32 s25, 655360
    buffer_load_dwordx4 v25, s[16:19], s25 offen lds
    s_add_u32 m0, s56, 50176
    s_mov_b32 s25, 720896
    buffer_load_dwordx4 v25, s[16:19], s25 offen lds
    s_add_u32 m0, s56, 51200
    s_mov_b32 s25, 917504
    buffer_load_dwordx4 v25, s[16:19], s25 offen lds
    s_add_u32 m0, s56, 52224
    s_mov_b32 s25, 983040
    buffer_load_dwordx4 v25, s[16:19], s25 offen lds
    ds_read2st64_b32 v[96:97], v116 offset0:0 offset1:1
    ds_read2st64_b32 v[98:99], v116 offset0:2 offset1:3
    ds_read2st64_b32 v[100:101], v117 offset0:0 offset1:1
    ds_read2st64_b32 v[102:103], v117 offset0:2 offset1:3
    ds_read2st64_b32 v[120:121], v118 offset0:0 offset1:1
    ds_read2st64_b32 v[122:123], v118 offset0:2 offset1:3
    ds_read2st64_b32 v[124:125], v119 offset0:0 offset1:1
    ds_read2st64_b32 v[126:127], v119 offset0:2 offset1:3
    s_waitcnt lgkmcnt(6)
    v_perm_b32 v104, v97, v96, s39
    ds_write_b32 v3, v104 offset:40960
    v_perm_b32 v105, v97, v96, s40
    v_accvgpr_write_b32 a104, v105
    v_perm_b32 v106, v99, v98, s39
    ds_write_b32 v3, v106 offset:40968
    v_perm_b32 v107, v99, v98, s40
    v_accvgpr_write_b32 a106, v107
    s_waitcnt lgkmcnt(0)
    v_perm_b32 v108, v101, v100, s39
    v_accvgpr_write_b32 a112, v108
    v_perm_b32 v109, v101, v100, s40
    v_accvgpr_write_b32 a120, v109
    v_perm_b32 v110, v103, v102, s39
    v_accvgpr_write_b32 a114, v110
    v_perm_b32 v111, v103, v102, s40
    v_accvgpr_write_b32 a122, v111
    s_waitcnt lgkmcnt(0)
    v_perm_b32 v104, v121, v120, s39
    ds_write_b32 v4, v104 offset:0
    v_perm_b32 v105, v121, v120, s40
    v_accvgpr_write_b32 a128, v105
    v_perm_b32 v106, v123, v122, s39
    ds_write_b32 v4, v106 offset:8
    v_perm_b32 v107, v123, v122, s40
    v_accvgpr_write_b32 a130, v107
    s_waitcnt lgkmcnt(0)
    v_perm_b32 v108, v125, v124, s39
    v_accvgpr_write_b32 a136, v108
    v_perm_b32 v109, v125, v124, s40
    v_accvgpr_write_b32 a144, v109
    v_perm_b32 v110, v127, v126, s39
    v_accvgpr_write_b32 a138, v110
    v_perm_b32 v111, v127, v126, s40
    v_accvgpr_write_b32 a146, v111
    s_waitcnt vmcnt(8)
    s_waitcnt lgkmcnt(0)
    s_barrier
    s_add_u32 m0, s56, 0
    s_mov_b32 s25, 32768
    buffer_load_dwordx4 v25, s[16:19], s25 offen lds
    s_add_u32 m0, s56, 1024
    s_mov_b32 s25, 98304
    buffer_load_dwordx4 v25, s[16:19], s25 offen lds
    s_add_u32 m0, s56, 2048
    s_mov_b32 s25, 294912
    buffer_load_dwordx4 v25, s[16:19], s25 offen lds
    s_add_u32 m0, s56, 3072
    s_mov_b32 s25, 360448
    buffer_load_dwordx4 v25, s[16:19], s25 offen lds
    ds_read2st64_b32 v[96:97], v116 offset0:64 offset1:65
    ds_read2st64_b32 v[98:99], v116 offset0:66 offset1:67
    ds_read2st64_b32 v[100:101], v117 offset0:64 offset1:65
    ds_read2st64_b32 v[102:103], v117 offset0:66 offset1:67
    ds_read2st64_b32 v[120:121], v118 offset0:64 offset1:65
    ds_read2st64_b32 v[122:123], v118 offset0:66 offset1:67
    ds_read2st64_b32 v[124:125], v119 offset0:64 offset1:65
    ds_read2st64_b32 v[126:127], v119 offset0:66 offset1:67
    s_waitcnt lgkmcnt(6)
    v_perm_b32 v104, v97, v96, s39
    ds_write_b32 v3, v104 offset:40964
    v_perm_b32 v105, v97, v96, s40
    v_accvgpr_write_b32 a105, v105
    v_perm_b32 v106, v99, v98, s39
    ds_write_b32 v3, v106 offset:40972
    v_perm_b32 v107, v99, v98, s40
    v_accvgpr_write_b32 a107, v107
    s_waitcnt lgkmcnt(0)
    v_perm_b32 v108, v101, v100, s39
    v_accvgpr_write_b32 a113, v108
    v_perm_b32 v109, v101, v100, s40
    v_accvgpr_write_b32 a121, v109
    v_perm_b32 v110, v103, v102, s39
    v_accvgpr_write_b32 a115, v110
    v_perm_b32 v111, v103, v102, s40
    v_accvgpr_write_b32 a123, v111
    s_waitcnt lgkmcnt(0)
    v_perm_b32 v104, v121, v120, s39
    ds_write_b32 v4, v104 offset:4
    v_perm_b32 v105, v121, v120, s40
    v_accvgpr_write_b32 a129, v105
    v_perm_b32 v106, v123, v122, s39
    ds_write_b32 v4, v106 offset:12
    v_perm_b32 v107, v123, v122, s40
    v_accvgpr_write_b32 a131, v107
    s_waitcnt lgkmcnt(0)
    v_perm_b32 v108, v125, v124, s39
    v_accvgpr_write_b32 a137, v108
    v_perm_b32 v109, v125, v124, s40
    v_accvgpr_write_b32 a145, v109
    v_perm_b32 v110, v127, v126, s39
    v_accvgpr_write_b32 a139, v110
    v_perm_b32 v111, v127, v126, s40
    v_accvgpr_write_b32 a147, v111
    s_waitcnt vmcnt(8)
    s_waitcnt lgkmcnt(0)
    s_barrier
    s_add_u32 m0, s56, 16384
    s_mov_b32 s25, 163840
    buffer_load_dwordx4 v25, s[16:19], s25 offen lds
    s_add_u32 m0, s56, 17408
    s_mov_b32 s25, 229376
    buffer_load_dwordx4 v25, s[16:19], s25 offen lds
    s_add_u32 m0, s56, 18432
    s_mov_b32 s25, 425984
    buffer_load_dwordx4 v25, s[16:19], s25 offen lds
    s_add_u32 m0, s56, 19456
    s_mov_b32 s25, 491520
    buffer_load_dwordx4 v25, s[16:19], s25 offen lds
    ds_read2st64_b32 v[96:97], v116 offset0:128 offset1:129
    ds_read2st64_b32 v[98:99], v116 offset0:130 offset1:131
    ds_read2st64_b32 v[100:101], v117 offset0:128 offset1:129
    ds_read2st64_b32 v[102:103], v117 offset0:130 offset1:131
    ds_read2st64_b32 v[120:121], v118 offset0:128 offset1:129
    ds_read2st64_b32 v[122:123], v118 offset0:130 offset1:131
    ds_read2st64_b32 v[124:125], v119 offset0:128 offset1:129
    ds_read2st64_b32 v[126:127], v119 offset0:130 offset1:131
    s_waitcnt lgkmcnt(6)
    v_perm_b32 v104, v97, v96, s39
    ds_write_b32 v3, v104 offset:45056
    v_perm_b32 v105, v97, v96, s40
    v_accvgpr_write_b32 a108, v105
    v_perm_b32 v106, v99, v98, s39
    ds_write_b32 v3, v106 offset:45064
    v_perm_b32 v107, v99, v98, s40
    v_accvgpr_write_b32 a110, v107
    s_waitcnt lgkmcnt(0)
    v_perm_b32 v108, v101, v100, s39
    v_accvgpr_write_b32 a116, v108
    v_perm_b32 v109, v101, v100, s40
    v_accvgpr_write_b32 a124, v109
    v_perm_b32 v110, v103, v102, s39
    v_accvgpr_write_b32 a118, v110
    v_perm_b32 v111, v103, v102, s40
    v_accvgpr_write_b32 a126, v111
    s_waitcnt lgkmcnt(0)
    v_perm_b32 v104, v121, v120, s39
    ds_write_b32 v4, v104 offset:4096
    v_perm_b32 v105, v121, v120, s40
    v_accvgpr_write_b32 a132, v105
    v_perm_b32 v106, v123, v122, s39
    ds_write_b32 v4, v106 offset:4104
    v_perm_b32 v107, v123, v122, s40
    v_accvgpr_write_b32 a134, v107
    s_waitcnt lgkmcnt(0)
    v_perm_b32 v108, v125, v124, s39
    v_accvgpr_write_b32 a140, v108
    v_perm_b32 v109, v125, v124, s40
    v_accvgpr_write_b32 a148, v109
    v_perm_b32 v110, v127, v126, s39
    v_accvgpr_write_b32 a142, v110
    v_perm_b32 v111, v127, v126, s40
    v_accvgpr_write_b32 a150, v111
    s_waitcnt vmcnt(8)
    s_waitcnt lgkmcnt(0)
    s_barrier
    s_add_u32 m0, s56, 32768
    s_mov_b32 s25, 557056
    buffer_load_dwordx4 v25, s[16:19], s25 offen lds
    s_add_u32 m0, s56, 33792
    s_mov_b32 s25, 622592
    buffer_load_dwordx4 v25, s[16:19], s25 offen lds
    s_add_u32 m0, s56, 34816
    s_mov_b32 s25, 819200
    buffer_load_dwordx4 v25, s[16:19], s25 offen lds
    s_add_u32 m0, s56, 35840
    s_mov_b32 s25, 884736
    buffer_load_dwordx4 v25, s[16:19], s25 offen lds
    ds_read2st64_b32 v[96:97], v116 offset0:192 offset1:193
    ds_read2st64_b32 v[98:99], v116 offset0:194 offset1:195
    ds_read2st64_b32 v[100:101], v117 offset0:192 offset1:193
    ds_read2st64_b32 v[102:103], v117 offset0:194 offset1:195
    ds_read2st64_b32 v[120:121], v118 offset0:192 offset1:193
    ds_read2st64_b32 v[122:123], v118 offset0:194 offset1:195
    ds_read2st64_b32 v[124:125], v119 offset0:192 offset1:193
    ds_read2st64_b32 v[126:127], v119 offset0:194 offset1:195
    s_waitcnt lgkmcnt(6)
    v_perm_b32 v104, v97, v96, s39
    ds_write_b32 v3, v104 offset:45060
    v_perm_b32 v105, v97, v96, s40
    v_accvgpr_write_b32 a109, v105
    v_perm_b32 v106, v99, v98, s39
    ds_write_b32 v3, v106 offset:45068
    v_perm_b32 v107, v99, v98, s40
    v_accvgpr_write_b32 a111, v107
    s_waitcnt lgkmcnt(0)
    v_perm_b32 v108, v101, v100, s39
    v_accvgpr_write_b32 a117, v108
    v_perm_b32 v109, v101, v100, s40
    v_accvgpr_write_b32 a125, v109
    v_perm_b32 v110, v103, v102, s39
    v_accvgpr_write_b32 a119, v110
    v_perm_b32 v111, v103, v102, s40
    v_accvgpr_write_b32 a127, v111
    s_waitcnt lgkmcnt(0)
    v_perm_b32 v104, v121, v120, s39
    ds_write_b32 v4, v104 offset:4100
    v_perm_b32 v105, v121, v120, s40
    v_accvgpr_write_b32 a133, v105
    v_perm_b32 v106, v123, v122, s39
    ds_write_b32 v4, v106 offset:4108
    v_perm_b32 v107, v123, v122, s40
    v_accvgpr_write_b32 a135, v107
    s_waitcnt lgkmcnt(0)
    v_perm_b32 v108, v125, v124, s39
    v_accvgpr_write_b32 a141, v108
    v_perm_b32 v109, v125, v124, s40
    v_accvgpr_write_b32 a149, v109
    v_perm_b32 v110, v127, v126, s39
    v_accvgpr_write_b32 a143, v110
    v_perm_b32 v111, v127, v126, s40
    v_accvgpr_write_b32 a151, v111
    s_waitcnt vmcnt(8)
    s_waitcnt lgkmcnt(0)
    s_barrier
    s_add_u32 m0, s56, 49152
    s_mov_b32 s25, 688128
    buffer_load_dwordx4 v25, s[16:19], s25 offen lds
    s_add_u32 m0, s56, 50176
    s_mov_b32 s25, 753664
    buffer_load_dwordx4 v25, s[16:19], s25 offen lds
    s_add_u32 m0, s56, 51200
    s_mov_b32 s25, 950272
    buffer_load_dwordx4 v25, s[16:19], s25 offen lds
    s_add_u32 m0, s56, 52224
    s_mov_b32 s25, 1015808
    buffer_load_dwordx4 v25, s[16:19], s25 offen lds
    ds_read2st64_b32 v[96:97], v116 offset0:0 offset1:1
    ds_read2st64_b32 v[98:99], v116 offset0:2 offset1:3
    ds_read2st64_b32 v[100:101], v117 offset0:0 offset1:1
    ds_read2st64_b32 v[102:103], v117 offset0:2 offset1:3
    ds_read2st64_b32 v[120:121], v118 offset0:0 offset1:1
    ds_read2st64_b32 v[122:123], v118 offset0:2 offset1:3
    ds_read2st64_b32 v[124:125], v119 offset0:0 offset1:1
    ds_read2st64_b32 v[126:127], v119 offset0:2 offset1:3
    s_waitcnt lgkmcnt(6)
    v_perm_b32 v104, v97, v96, s39
    v_accvgpr_write_b32 a152, v104
    v_perm_b32 v105, v97, v96, s40
    ds_write_b32 v3, v105 offset:57344
    v_perm_b32 v106, v99, v98, s39
    v_accvgpr_write_b32 a154, v106
    v_perm_b32 v107, v99, v98, s40
    ds_write_b32 v3, v107 offset:57352
    s_waitcnt lgkmcnt(0)
    v_perm_b32 v108, v101, v100, s39
    v_accvgpr_write_b32 a160, v108
    v_perm_b32 v109, v101, v100, s40
    v_accvgpr_write_b32 a168, v109
    v_perm_b32 v110, v103, v102, s39
    v_accvgpr_write_b32 a162, v110
    v_perm_b32 v111, v103, v102, s40
    v_accvgpr_write_b32 a170, v111
    s_waitcnt lgkmcnt(0)
    v_perm_b32 v104, v121, v120, s39
    v_accvgpr_write_b32 a176, v104
    v_perm_b32 v105, v121, v120, s40
    v_accvgpr_write_b32 a184, v105
    v_perm_b32 v106, v123, v122, s39
    v_accvgpr_write_b32 a178, v106
    v_perm_b32 v107, v123, v122, s40
    v_accvgpr_write_b32 a186, v107
    s_waitcnt lgkmcnt(0)
    v_perm_b32 v108, v125, v124, s39
    v_accvgpr_write_b32 a192, v108
    v_perm_b32 v109, v125, v124, s40
    v_accvgpr_write_b32 a200, v109
    v_perm_b32 v110, v127, v126, s39
    v_accvgpr_write_b32 a194, v110
    v_perm_b32 v111, v127, v126, s40
    v_accvgpr_write_b32 a202, v111
    s_waitcnt vmcnt(8)
    s_waitcnt lgkmcnt(0)
    s_barrier
    s_mov_b32 s16, s84
    s_and_b32 s17, s85, 0xffff
    s_mov_b32 s18, 0x400000
    s_mov_b32 s19, 0x00020000
    s_add_u32 m0, s56, 0
    s_mov_b32 s25, 0
    buffer_load_dwordx4 v25, s[16:19], s25 offen lds
    s_add_u32 m0, s56, 1024
    s_mov_b32 s25, 65536
    buffer_load_dwordx4 v25, s[16:19], s25 offen lds
    s_add_u32 m0, s56, 2048
    s_mov_b32 s25, 262144
    buffer_load_dwordx4 v25, s[16:19], s25 offen lds
    s_add_u32 m0, s56, 3072
    s_mov_b32 s25, 327680
    buffer_load_dwordx4 v25, s[16:19], s25 offen lds
    ds_read2st64_b32 v[96:97], v116 offset0:64 offset1:65
    ds_read2st64_b32 v[98:99], v116 offset0:66 offset1:67
    ds_read2st64_b32 v[100:101], v117 offset0:64 offset1:65
    ds_read2st64_b32 v[102:103], v117 offset0:66 offset1:67
    ds_read2st64_b32 v[120:121], v118 offset0:64 offset1:65
    ds_read2st64_b32 v[122:123], v118 offset0:66 offset1:67
    ds_read2st64_b32 v[124:125], v119 offset0:64 offset1:65
    ds_read2st64_b32 v[126:127], v119 offset0:66 offset1:67
    s_waitcnt lgkmcnt(6)
    v_perm_b32 v104, v97, v96, s39
    v_accvgpr_write_b32 a153, v104
    v_perm_b32 v105, v97, v96, s40
    ds_write_b32 v3, v105 offset:57348
    v_perm_b32 v106, v99, v98, s39
    v_accvgpr_write_b32 a155, v106
    v_perm_b32 v107, v99, v98, s40
    ds_write_b32 v3, v107 offset:57356
    s_waitcnt lgkmcnt(0)
    v_perm_b32 v108, v101, v100, s39
    v_accvgpr_write_b32 a161, v108
    v_perm_b32 v109, v101, v100, s40
    v_accvgpr_write_b32 a169, v109
    v_perm_b32 v110, v103, v102, s39
    v_accvgpr_write_b32 a163, v110
    v_perm_b32 v111, v103, v102, s40
    v_accvgpr_write_b32 a171, v111
    s_waitcnt lgkmcnt(0)
    v_perm_b32 v104, v121, v120, s39
    v_accvgpr_write_b32 a177, v104
    v_perm_b32 v105, v121, v120, s40
    v_accvgpr_write_b32 a185, v105
    v_perm_b32 v106, v123, v122, s39
    v_accvgpr_write_b32 a179, v106
    v_perm_b32 v107, v123, v122, s40
    v_accvgpr_write_b32 a187, v107
    s_waitcnt lgkmcnt(0)
    v_perm_b32 v108, v125, v124, s39
    v_accvgpr_write_b32 a193, v108
    v_perm_b32 v109, v125, v124, s40
    v_accvgpr_write_b32 a201, v109
    v_perm_b32 v110, v127, v126, s39
    v_accvgpr_write_b32 a195, v110
    v_perm_b32 v111, v127, v126, s40
    v_accvgpr_write_b32 a203, v111
    s_waitcnt vmcnt(8)
    s_waitcnt lgkmcnt(0)
    s_barrier
    s_add_u32 m0, s56, 16384
    s_mov_b32 s25, 131072
    buffer_load_dwordx4 v25, s[16:19], s25 offen lds
    s_add_u32 m0, s56, 17408
    s_mov_b32 s25, 196608
    buffer_load_dwordx4 v25, s[16:19], s25 offen lds
    s_add_u32 m0, s56, 18432
    s_mov_b32 s25, 393216
    buffer_load_dwordx4 v25, s[16:19], s25 offen lds
    s_add_u32 m0, s56, 19456
    s_mov_b32 s25, 458752
    buffer_load_dwordx4 v25, s[16:19], s25 offen lds
    ds_read2st64_b32 v[96:97], v116 offset0:128 offset1:129
    ds_read2st64_b32 v[98:99], v116 offset0:130 offset1:131
    ds_read2st64_b32 v[100:101], v117 offset0:128 offset1:129
    ds_read2st64_b32 v[102:103], v117 offset0:130 offset1:131
    ds_read2st64_b32 v[120:121], v118 offset0:128 offset1:129
    ds_read2st64_b32 v[122:123], v118 offset0:130 offset1:131
    ds_read2st64_b32 v[124:125], v119 offset0:128 offset1:129
    ds_read2st64_b32 v[126:127], v119 offset0:130 offset1:131
    s_waitcnt lgkmcnt(6)
    v_perm_b32 v104, v97, v96, s39
    v_accvgpr_write_b32 a156, v104
    v_perm_b32 v105, v97, v96, s40
    ds_write_b32 v3, v105 offset:61440
    v_perm_b32 v106, v99, v98, s39
    v_accvgpr_write_b32 a158, v106
    v_perm_b32 v107, v99, v98, s40
    ds_write_b32 v3, v107 offset:61448
    s_waitcnt lgkmcnt(0)
    v_perm_b32 v108, v101, v100, s39
    v_accvgpr_write_b32 a164, v108
    v_perm_b32 v109, v101, v100, s40
    v_accvgpr_write_b32 a172, v109
    v_perm_b32 v110, v103, v102, s39
    v_accvgpr_write_b32 a166, v110
    v_perm_b32 v111, v103, v102, s40
    v_accvgpr_write_b32 a174, v111
    s_waitcnt lgkmcnt(0)
    v_perm_b32 v104, v121, v120, s39
    v_accvgpr_write_b32 a180, v104
    v_perm_b32 v105, v121, v120, s40
    v_accvgpr_write_b32 a188, v105
    v_perm_b32 v106, v123, v122, s39
    v_accvgpr_write_b32 a182, v106
    v_perm_b32 v107, v123, v122, s40
    v_accvgpr_write_b32 a190, v107
    s_waitcnt lgkmcnt(0)
    v_perm_b32 v108, v125, v124, s39
    v_accvgpr_write_b32 a196, v108
    v_perm_b32 v109, v125, v124, s40
    v_accvgpr_write_b32 a204, v109
    v_perm_b32 v110, v127, v126, s39
    v_accvgpr_write_b32 a198, v110
    v_perm_b32 v111, v127, v126, s40
    v_accvgpr_write_b32 a206, v111
    s_waitcnt vmcnt(8)
    s_waitcnt lgkmcnt(0)
    s_barrier
    s_add_u32 m0, s56, 32768
    s_mov_b32 s25, 524288
    buffer_load_dwordx4 v25, s[16:19], s25 offen lds
    s_add_u32 m0, s56, 33792
    s_mov_b32 s25, 589824
    buffer_load_dwordx4 v25, s[16:19], s25 offen lds
    s_add_u32 m0, s56, 34816
    s_mov_b32 s25, 786432
    buffer_load_dwordx4 v25, s[16:19], s25 offen lds
    s_add_u32 m0, s56, 35840
    s_mov_b32 s25, 851968
    buffer_load_dwordx4 v25, s[16:19], s25 offen lds
    ds_read2st64_b32 v[96:97], v116 offset0:192 offset1:193
    ds_read2st64_b32 v[98:99], v116 offset0:194 offset1:195
    ds_read2st64_b32 v[100:101], v117 offset0:192 offset1:193
    ds_read2st64_b32 v[102:103], v117 offset0:194 offset1:195
    ds_read2st64_b32 v[120:121], v118 offset0:192 offset1:193
    ds_read2st64_b32 v[122:123], v118 offset0:194 offset1:195
    ds_read2st64_b32 v[124:125], v119 offset0:192 offset1:193
    ds_read2st64_b32 v[126:127], v119 offset0:194 offset1:195
    s_waitcnt lgkmcnt(6)
    v_perm_b32 v104, v97, v96, s39
    v_accvgpr_write_b32 a157, v104
    v_perm_b32 v105, v97, v96, s40
    ds_write_b32 v3, v105 offset:61444
    v_perm_b32 v106, v99, v98, s39
    v_accvgpr_write_b32 a159, v106
    v_perm_b32 v107, v99, v98, s40
    ds_write_b32 v3, v107 offset:61452
    s_waitcnt lgkmcnt(0)
    v_perm_b32 v108, v101, v100, s39
    v_accvgpr_write_b32 a165, v108
    v_perm_b32 v109, v101, v100, s40
    v_accvgpr_write_b32 a173, v109
    v_perm_b32 v110, v103, v102, s39
    v_accvgpr_write_b32 a167, v110
    v_perm_b32 v111, v103, v102, s40
    v_accvgpr_write_b32 a175, v111
    s_waitcnt lgkmcnt(0)
    v_perm_b32 v104, v121, v120, s39
    v_accvgpr_write_b32 a181, v104
    v_perm_b32 v105, v121, v120, s40
    v_accvgpr_write_b32 a189, v105
    v_perm_b32 v106, v123, v122, s39
    v_accvgpr_write_b32 a183, v106
    v_perm_b32 v107, v123, v122, s40
    v_accvgpr_write_b32 a191, v107
    s_waitcnt lgkmcnt(0)
    v_perm_b32 v108, v125, v124, s39
    v_accvgpr_write_b32 a197, v108
    v_perm_b32 v109, v125, v124, s40
    v_accvgpr_write_b32 a205, v109
    v_perm_b32 v110, v127, v126, s39
    v_accvgpr_write_b32 a199, v110
    v_perm_b32 v111, v127, v126, s40
    v_accvgpr_write_b32 a207, v111
    s_waitcnt vmcnt(8)
    s_waitcnt lgkmcnt(0)
    s_barrier
    s_add_u32 m0, s56, 49152
    s_mov_b32 s25, 655360
    buffer_load_dwordx4 v25, s[16:19], s25 offen lds
    s_add_u32 m0, s56, 50176
    s_mov_b32 s25, 720896
    buffer_load_dwordx4 v25, s[16:19], s25 offen lds
    s_add_u32 m0, s56, 51200
    s_mov_b32 s25, 917504
    buffer_load_dwordx4 v25, s[16:19], s25 offen lds
    s_add_u32 m0, s56, 52224
    s_mov_b32 s25, 983040
    buffer_load_dwordx4 v25, s[16:19], s25 offen lds
    ds_read2st64_b32 v[96:97], v116 offset0:0 offset1:1
    ds_read2st64_b32 v[98:99], v116 offset0:2 offset1:3
    ds_read2st64_b32 v[100:101], v117 offset0:0 offset1:1
    ds_read2st64_b32 v[102:103], v117 offset0:2 offset1:3
    ds_read2st64_b32 v[120:121], v118 offset0:0 offset1:1
    ds_read2st64_b32 v[122:123], v118 offset0:2 offset1:3
    ds_read2st64_b32 v[124:125], v119 offset0:0 offset1:1
    ds_read2st64_b32 v[126:127], v119 offset0:2 offset1:3
    s_waitcnt lgkmcnt(6)
    v_perm_b32 v104, v97, v96, s39
    v_accvgpr_write_b32 a208, v104
    v_perm_b32 v105, v97, v96, s40
    v_accvgpr_write_b32 a216, v105
    v_perm_b32 v106, v99, v98, s39
    v_accvgpr_write_b32 a210, v106
    v_perm_b32 v107, v99, v98, s40
    v_accvgpr_write_b32 a218, v107
    s_waitcnt lgkmcnt(4)
    v_perm_b32 v108, v101, v100, s39
    v_accvgpr_write_b32 a224, v108
    v_perm_b32 v109, v101, v100, s40
    v_accvgpr_write_b32 a232, v109
    v_perm_b32 v110, v103, v102, s39
    v_accvgpr_write_b32 a226, v110
    v_perm_b32 v111, v103, v102, s40
    v_accvgpr_write_b32 a234, v111
    s_waitcnt lgkmcnt(2)
    v_perm_b32 v104, v121, v120, s39
    v_accvgpr_write_b32 a240, v104
    v_perm_b32 v105, v121, v120, s40
    v_accvgpr_write_b32 a248, v105
    v_perm_b32 v106, v123, v122, s39
    v_accvgpr_write_b32 a242, v106
    v_perm_b32 v107, v123, v122, s40
    v_accvgpr_write_b32 a250, v107
    s_waitcnt lgkmcnt(0)
    v_perm_b32 v128, v125, v124, s39
    v_perm_b32 v136, v125, v124, s40
    v_perm_b32 v130, v127, v126, s39
    v_perm_b32 v138, v127, v126, s40
    s_waitcnt vmcnt(8)
    s_waitcnt lgkmcnt(0)
    s_barrier
    s_add_u32 m0, s56, 0
    s_mov_b32 s25, 32768
    buffer_load_dwordx4 v25, s[16:19], s25 offen lds
    s_add_u32 m0, s56, 1024
    s_mov_b32 s25, 98304
    buffer_load_dwordx4 v25, s[16:19], s25 offen lds
    s_add_u32 m0, s56, 2048
    s_mov_b32 s25, 294912
    buffer_load_dwordx4 v25, s[16:19], s25 offen lds
    s_add_u32 m0, s56, 3072
    s_mov_b32 s25, 360448
    buffer_load_dwordx4 v25, s[16:19], s25 offen lds
    ds_read2st64_b32 v[96:97], v116 offset0:64 offset1:65
    ds_read2st64_b32 v[98:99], v116 offset0:66 offset1:67
    ds_read2st64_b32 v[100:101], v117 offset0:64 offset1:65
    ds_read2st64_b32 v[102:103], v117 offset0:66 offset1:67
    ds_read2st64_b32 v[120:121], v118 offset0:64 offset1:65
    ds_read2st64_b32 v[122:123], v118 offset0:66 offset1:67
    ds_read2st64_b32 v[124:125], v119 offset0:64 offset1:65
    ds_read2st64_b32 v[126:127], v119 offset0:66 offset1:67
    s_waitcnt lgkmcnt(6)
    v_perm_b32 v104, v97, v96, s39
    v_accvgpr_write_b32 a209, v104
    v_perm_b32 v105, v97, v96, s40
    v_accvgpr_write_b32 a217, v105
    v_perm_b32 v106, v99, v98, s39
    v_accvgpr_write_b32 a211, v106
    v_perm_b32 v107, v99, v98, s40
    v_accvgpr_write_b32 a219, v107
    s_waitcnt lgkmcnt(4)
    v_perm_b32 v108, v101, v100, s39
    v_accvgpr_write_b32 a225, v108
    v_perm_b32 v109, v101, v100, s40
    v_accvgpr_write_b32 a233, v109
    v_perm_b32 v110, v103, v102, s39
    v_accvgpr_write_b32 a227, v110
    v_perm_b32 v111, v103, v102, s40
    v_accvgpr_write_b32 a235, v111
    s_waitcnt lgkmcnt(2)
    v_perm_b32 v104, v121, v120, s39
    v_accvgpr_write_b32 a241, v104
    v_perm_b32 v105, v121, v120, s40
    v_accvgpr_write_b32 a249, v105
    v_perm_b32 v106, v123, v122, s39
    v_accvgpr_write_b32 a243, v106
    v_perm_b32 v107, v123, v122, s40
    v_accvgpr_write_b32 a251, v107
    s_waitcnt lgkmcnt(0)
    v_perm_b32 v129, v125, v124, s39
    v_perm_b32 v137, v125, v124, s40
    v_perm_b32 v131, v127, v126, s39
    v_perm_b32 v139, v127, v126, s40
    s_waitcnt vmcnt(8)
    s_waitcnt lgkmcnt(0)
    s_barrier
    s_add_u32 m0, s56, 16384
    s_mov_b32 s25, 163840
    buffer_load_dwordx4 v25, s[16:19], s25 offen lds
    s_add_u32 m0, s56, 17408
    s_mov_b32 s25, 229376
    buffer_load_dwordx4 v25, s[16:19], s25 offen lds
    s_add_u32 m0, s56, 18432
    s_mov_b32 s25, 425984
    buffer_load_dwordx4 v25, s[16:19], s25 offen lds
    s_add_u32 m0, s56, 19456
    s_mov_b32 s25, 491520
    buffer_load_dwordx4 v25, s[16:19], s25 offen lds
    ds_read2st64_b32 v[96:97], v116 offset0:128 offset1:129
    ds_read2st64_b32 v[98:99], v116 offset0:130 offset1:131
    ds_read2st64_b32 v[100:101], v117 offset0:128 offset1:129
    ds_read2st64_b32 v[102:103], v117 offset0:130 offset1:131
    ds_read2st64_b32 v[120:121], v118 offset0:128 offset1:129
    ds_read2st64_b32 v[122:123], v118 offset0:130 offset1:131
    ds_read2st64_b32 v[124:125], v119 offset0:128 offset1:129
    ds_read2st64_b32 v[126:127], v119 offset0:130 offset1:131
    s_waitcnt lgkmcnt(6)
    v_perm_b32 v104, v97, v96, s39
    v_accvgpr_write_b32 a212, v104
    v_perm_b32 v105, v97, v96, s40
    v_accvgpr_write_b32 a220, v105
    v_perm_b32 v106, v99, v98, s39
    v_accvgpr_write_b32 a214, v106
    v_perm_b32 v107, v99, v98, s40
    v_accvgpr_write_b32 a222, v107
    s_waitcnt lgkmcnt(4)
    v_perm_b32 v108, v101, v100, s39
    v_accvgpr_write_b32 a228, v108
    v_perm_b32 v109, v101, v100, s40
    v_accvgpr_write_b32 a236, v109
    v_perm_b32 v110, v103, v102, s39
    v_accvgpr_write_b32 a230, v110
    v_perm_b32 v111, v103, v102, s40
    v_accvgpr_write_b32 a238, v111
    s_waitcnt lgkmcnt(2)
    v_perm_b32 v104, v121, v120, s39
    v_accvgpr_write_b32 a244, v104
    v_perm_b32 v105, v121, v120, s40
    v_accvgpr_write_b32 a252, v105
    v_perm_b32 v106, v123, v122, s39
    v_accvgpr_write_b32 a246, v106
    v_perm_b32 v107, v123, v122, s40
    v_accvgpr_write_b32 a254, v107
    s_waitcnt lgkmcnt(0)
    v_perm_b32 v132, v125, v124, s39
    v_perm_b32 v140, v125, v124, s40
    v_perm_b32 v134, v127, v126, s39
    v_perm_b32 v142, v127, v126, s40
    s_waitcnt vmcnt(8)
    s_waitcnt lgkmcnt(0)
    s_barrier
    s_add_u32 m0, s56, 32768
    s_mov_b32 s25, 557056
    buffer_load_dwordx4 v25, s[16:19], s25 offen lds
    s_add_u32 m0, s56, 33792
    s_mov_b32 s25, 622592
    buffer_load_dwordx4 v25, s[16:19], s25 offen lds
    s_add_u32 m0, s56, 34816
    s_mov_b32 s25, 819200
    buffer_load_dwordx4 v25, s[16:19], s25 offen lds
    s_add_u32 m0, s56, 35840
    s_mov_b32 s25, 884736
    buffer_load_dwordx4 v25, s[16:19], s25 offen lds
    ds_read2st64_b32 v[96:97], v116 offset0:192 offset1:193
    ds_read2st64_b32 v[98:99], v116 offset0:194 offset1:195
    ds_read2st64_b32 v[100:101], v117 offset0:192 offset1:193
    ds_read2st64_b32 v[102:103], v117 offset0:194 offset1:195
    ds_read2st64_b32 v[120:121], v118 offset0:192 offset1:193
    ds_read2st64_b32 v[122:123], v118 offset0:194 offset1:195
    ds_read2st64_b32 v[124:125], v119 offset0:192 offset1:193
    ds_read2st64_b32 v[126:127], v119 offset0:194 offset1:195
    s_waitcnt lgkmcnt(6)
    v_perm_b32 v104, v97, v96, s39
    v_accvgpr_write_b32 a213, v104
    v_perm_b32 v105, v97, v96, s40
    v_accvgpr_write_b32 a221, v105
    v_perm_b32 v106, v99, v98, s39
    v_accvgpr_write_b32 a215, v106
    v_perm_b32 v107, v99, v98, s40
    v_accvgpr_write_b32 a223, v107
    s_waitcnt lgkmcnt(4)
    v_perm_b32 v108, v101, v100, s39
    v_accvgpr_write_b32 a229, v108
    v_perm_b32 v109, v101, v100, s40
    v_accvgpr_write_b32 a237, v109
    v_perm_b32 v110, v103, v102, s39
    v_accvgpr_write_b32 a231, v110
    v_perm_b32 v111, v103, v102, s40
    v_accvgpr_write_b32 a239, v111
    s_waitcnt lgkmcnt(2)
    v_perm_b32 v104, v121, v120, s39
    v_accvgpr_write_b32 a245, v104
    v_perm_b32 v105, v121, v120, s40
    v_accvgpr_write_b32 a253, v105
    v_perm_b32 v106, v123, v122, s39
    v_accvgpr_write_b32 a247, v106
    v_perm_b32 v107, v123, v122, s40
    v_accvgpr_write_b32 a255, v107
    s_waitcnt lgkmcnt(0)
    v_perm_b32 v133, v125, v124, s39
    v_perm_b32 v141, v125, v124, s40
    v_perm_b32 v135, v127, v126, s39
    v_perm_b32 v143, v127, v126, s40
    s_waitcnt vmcnt(8)
    s_waitcnt lgkmcnt(0)
    s_barrier
    s_add_u32 m0, s56, 49152
    s_mov_b32 s25, 688128
    buffer_load_dwordx4 v25, s[16:19], s25 offen lds
    s_add_u32 m0, s56, 50176
    s_mov_b32 s25, 753664
    buffer_load_dwordx4 v25, s[16:19], s25 offen lds
    s_add_u32 m0, s56, 51200
    s_mov_b32 s25, 950272
    buffer_load_dwordx4 v25, s[16:19], s25 offen lds
    s_add_u32 m0, s56, 52224
    s_mov_b32 s25, 1015808
    buffer_load_dwordx4 v25, s[16:19], s25 offen lds
    s_getpc_b64 s[58:59]
L_pc0:
    s_add_u32 s58, s58, L_step_0-L_pc0
    s_addc_u32 s59, s59, 0
    v_lshlrev_b32 v20, 5, v0
    v_mov_b32 v21, s59
    v_add_co_u32 v20, vcc, s58, v20
    s_nop 1
    v_addc_co_u32 v21, vcc, 0, v21, vcc
    global_load_dword v22, v[20:21], off
    ds_read2st64_b32 v[96:97], v116 offset0:0 offset1:1
    ds_read2st64_b32 v[98:99], v116 offset0:2 offset1:3
    ds_read2st64_b32 v[100:101], v117 offset0:0 offset1:1
    ds_read2st64_b32 v[102:103], v117 offset0:2 offset1:3
    ds_read2st64_b32 v[120:121], v118 offset0:0 offset1:1
    ds_read2st64_b32 v[122:123], v118 offset0:2 offset1:3
    ds_read2st64_b32 v[124:125], v119 offset0:0 offset1:1
    ds_read2st64_b32 v[126:127], v119 offset0:2 offset1:3
    s_waitcnt lgkmcnt(6)
    v_perm_b32 v144, v97, v96, s39
    v_perm_b32 v152, v97, v96, s40
    v_perm_b32 v146, v99, v98, s39
    v_perm_b32 v154, v99, v98, s40
    s_waitcnt lgkmcnt(4)
    v_perm_b32 v160, v101, v100, s39
    v_perm_b32 v168, v101, v100, s40
    v_perm_b32 v162, v103, v102, s39
    v_perm_b32 v170, v103, v102, s40
    s_waitcnt lgkmcnt(2)
    v_perm_b32 v176, v121, v120, s39
    v_perm_b32 v184, v121, v120, s40
    v_perm_b32 v178, v123, v122, s39
    v_perm_b32 v186, v123, v122, s40
    s_waitcnt lgkmcnt(0)
    v_perm_b32 v192, v125, v124, s39
    v_perm_b32 v200, v125, v124, s40
    v_perm_b32 v194, v127, v126, s39
    v_perm_b32 v202, v127, v126, s40
    s_waitcnt vmcnt(9)
    s_waitcnt lgkmcnt(0)
    s_barrier
    ds_read2st64_b32 v[96:97], v116 offset0:64 offset1:65
    ds_read2st64_b32 v[98:99], v116 offset0:66 offset1:67
    ds_read2st64_b32 v[100:101], v117 offset0:64 offset1:65
    ds_read2st64_b32 v[102:103], v117 offset0:66 offset1:67
    ds_read2st64_b32 v[120:121], v118 offset0:64 offset1:65
    ds_read2st64_b32 v[122:123], v118 offset0:66 offset1:67
    ds_read2st64_b32 v[124:125], v119 offset0:64 offset1:65
    ds_read2st64_b32 v[126:127], v119 offset0:66 offset1:67
    s_waitcnt lgkmcnt(6)
    v_perm_b32 v145, v97, v96, s39
    v_perm_b32 v153, v97, v96, s40
    v_perm_b32 v147, v99, v98, s39
    v_perm_b32 v155, v99, v98, s40
    s_waitcnt lgkmcnt(4)
    v_perm_b32 v161, v101, v100, s39
    v_perm_b32 v169, v101, v100, s40
    v_perm_b32 v163, v103, v102, s39
    v_perm_b32 v171, v103, v102, s40
    s_waitcnt lgkmcnt(2)
    v_perm_b32 v177, v121, v120, s39
    v_perm_b32 v185, v121, v120, s40
    v_perm_b32 v179, v123, v122, s39
    v_perm_b32 v187, v123, v122, s40
    s_waitcnt lgkmcnt(0)
    v_perm_b32 v193, v125, v124, s39
    v_perm_b32 v201, v125, v124, s40
    v_perm_b32 v195, v127, v126, s39
    v_perm_b32 v203, v127, v126, s40
    s_waitcnt vmcnt(5)
    s_waitcnt lgkmcnt(0)
    s_barrier
    ds_read2st64_b32 v[96:97], v116 offset0:128 offset1:129
    ds_read2st64_b32 v[98:99], v116 offset0:130 offset1:131
    ds_read2st64_b32 v[100:101], v117 offset0:128 offset1:129
    ds_read2st64_b32 v[102:103], v117 offset0:130 offset1:131
    ds_read2st64_b32 v[120:121], v118 offset0:128 offset1:129
    ds_read2st64_b32 v[122:123], v118 offset0:130 offset1:131
    ds_read2st64_b32 v[124:125], v119 offset0:128 offset1:129
    ds_read2st64_b32 v[126:127], v119 offset0:130 offset1:131
    s_waitcnt lgkmcnt(6)
    v_perm_b32 v148, v97, v96, s39
    v_perm_b32 v156, v97, v96, s40
    v_perm_b32 v150, v99, v98, s39
    v_perm_b32 v158, v99, v98, s40
    s_waitcnt lgkmcnt(4)
    v_perm_b32 v164, v101, v100, s39
    v_perm_b32 v172, v101, v100, s40
    v_perm_b32 v166, v103, v102, s39
    v_perm_b32 v174, v103, v102, s40
    s_waitcnt lgkmcnt(2)
    v_perm_b32 v180, v121, v120, s39
    v_perm_b32 v188, v121, v120, s40
    v_perm_b32 v182, v123, v122, s39
    v_perm_b32 v190, v123, v122, s40
    s_waitcnt lgkmcnt(0)
    v_perm_b32 v196, v125, v124, s39
    v_perm_b32 v204, v125, v124, s40
    v_perm_b32 v198, v127, v126, s39
    v_perm_b32 v206, v127, v126, s40
    s_waitcnt vmcnt(1)
    s_waitcnt lgkmcnt(0)
    s_barrier
    v_mov_b32 v30, 0
    buffer_load_dword v29, v30, s[12:15], 0 offen offset:68 sc1
    buffer_load_dword v31, v30, s[12:15], 0 offen offset:36 sc1
    ds_read2st64_b32 v[96:97], v116 offset0:192 offset1:193
    ds_read2st64_b32 v[98:99], v116 offset0:194 offset1:195
    ds_read2st64_b32 v[100:101], v117 offset0:192 offset1:193
    ds_read2st64_b32 v[102:103], v117 offset0:194 offset1:195
    ds_read2st64_b32 v[120:121], v118 offset0:192 offset1:193
    ds_read2st64_b32 v[122:123], v118 offset0:194 offset1:195
    ds_read2st64_b32 v[124:125], v119 offset0:192 offset1:193
    ds_read2st64_b32 v[126:127], v119 offset0:194 offset1:195
    s_waitcnt lgkmcnt(6)
    v_perm_b32 v149, v97, v96, s39
    v_perm_b32 v157, v97, v96, s40
    v_perm_b32 v151, v99, v98, s39
    v_perm_b32 v159, v99, v98, s40
    s_waitcnt lgkmcnt(4)
    v_perm_b32 v165, v101, v100, s39
    v_perm_b32 v173, v101, v100, s40
    v_perm_b32 v167, v103, v102, s39
    v_perm_b32 v175, v103, v102, s40
    s_waitcnt lgkmcnt(2)
    v_perm_b32 v181, v121, v120, s39
    v_perm_b32 v189, v121, v120, s40
    v_perm_b32 v183, v123, v122, s39
    v_perm_b32 v191, v123, v122, s40
    s_waitcnt lgkmcnt(0)
    v_perm_b32 v197, v125, v124, s39
    v_perm_b32 v205, v125, v124, s40
    v_perm_b32 v199, v127, v126, s39
    v_perm_b32 v207, v127, v126, s40
    s_waitcnt lgkmcnt(0)
    s_barrier
    s_waitcnt vmcnt(63)
    v_perm_b32 v96, v36, v32, s39
    v_perm_b32 v97, v44, v40, s39
    ds_write_b64 v4, v[96:97] offset:16384
    v_perm_b32 v98, v36, v32, s40
    v_perm_b32 v99, v44, v40, s40
    ds_write_b64 v4, v[98:99] offset:32768
    v_perm_b32 v100, v37, v33, s39
    v_perm_b32 v101, v45, v41, s39
    ds_write_b64 v4, v[100:101] offset:40960
    v_perm_b32 v102, v37, v33, s40
    v_perm_b32 v103, v45, v41, s40
    ds_write_b64 v4, v[102:103] offset:49152
    v_perm_b32 v104, v38, v34, s39
    v_perm_b32 v105, v46, v42, s39
    ds_write_b64 v4, v[104:105] offset:57344
    v_perm_b32 v106, v38, v34, s40
    v_perm_b32 v107, v46, v42, s40
    ds_write_b64 v5, v[106:107] offset:0
    v_perm_b32 v108, v39, v35, s39
    v_perm_b32 v109, v47, v43, s39
    ds_write_b64 v5, v[108:109] offset:8192
    v_perm_b32 v110, v39, v35, s40
    v_perm_b32 v111, v47, v43, s40
    ds_write_b64 v3, v[110:111] offset:16384
    s_waitcnt lgkmcnt(0)
    s_mov_b32 s25, 65536
    buffer_load_dwordx4 v[32:35], v27, s[52:55], s25 offen
    buffer_load_dwordx4 v[36:39], v27, s[52:55], s25 offen offset:1024
    s_mov_b32 s25, 73728
    buffer_load_dwordx4 v[40:43], v27, s[52:55], s25 offen
    buffer_load_dwordx4 v[44:47], v27, s[52:55], s25 offen offset:1024
    s_waitcnt vmcnt(63)
    v_perm_b32 v96, v52, v48, s39
    v_perm_b32 v97, v60, v56, s39
    ds_write_b64 v4, v[96:97] offset:16392
    v_perm_b32 v98, v52, v48, s40
    v_perm_b32 v99, v60, v56, s40
    ds_write_b64 v4, v[98:99] offset:32776
    v_perm_b32 v100, v53, v49, s39
    v_perm_b32 v101, v61, v57, s39
    ds_write_b64 v4, v[100:101] offset:40968
    v_perm_b32 v102, v53, v49, s40
    v_perm_b32 v103, v61, v57, s40
    ds_write_b64 v4, v[102:103] offset:49160
    v_perm_b32 v104, v54, v50, s39
    v_perm_b32 v105, v62, v58, s39
    ds_write_b64 v4, v[104:105] offset:57352
    v_perm_b32 v106, v54, v50, s40
    v_perm_b32 v107, v62, v58, s40
    ds_write_b64 v5, v[106:107] offset:8
    v_perm_b32 v108, v55, v51, s39
    v_perm_b32 v109, v63, v59, s39
    ds_write_b64 v5, v[108:109] offset:8200
    v_perm_b32 v110, v55, v51, s40
    v_perm_b32 v111, v63, v59, s40
    ds_write_b64 v3, v[110:111] offset:16392
    s_waitcnt lgkmcnt(0)
    s_mov_b32 s25, 67584
    buffer_load_dwordx4 v[48:51], v27, s[52:55], s25 offen
    buffer_load_dwordx4 v[52:55], v27, s[52:55], s25 offen offset:1024
    s_mov_b32 s25, 75776
    buffer_load_dwordx4 v[56:59], v27, s[52:55], s25 offen
    buffer_load_dwordx4 v[60:63], v27, s[52:55], s25 offen offset:1024
    s_waitcnt vmcnt(63)
    v_perm_b32 v96, v68, v64, s39
    v_perm_b32 v97, v76, v72, s39
    ds_write_b64 v4, v[96:97] offset:20480
    v_perm_b32 v98, v68, v64, s40
    v_perm_b32 v99, v76, v72, s40
    ds_write_b64 v4, v[98:99] offset:36864
    v_perm_b32 v100, v69, v65, s39
    v_perm_b32 v101, v77, v73, s39
    ds_write_b64 v4, v[100:101] offset:45056
    v_perm_b32 v102, v69, v65, s40
    v_perm_b32 v103, v77, v73, s40
    ds_write_b64 v4, v[102:103] offset:53248
    v_perm_b32 v104, v70, v66, s39
    v_perm_b32 v105, v78, v74, s39
    ds_write_b64 v4, v[104:105] offset:61440
    v_perm_b32 v106, v70, v66, s40
    v_perm_b32 v107, v78, v74, s40
    ds_write_b64 v5, v[106:107] offset:4096
    v_perm_b32 v108, v71, v67, s39
    v_perm_b32 v109, v79, v75, s39
    ds_write_b64 v5, v[108:109] offset:12288
    v_perm_b32 v110, v71, v67, s40
    v_perm_b32 v111, v79, v75, s40
    ds_write_b64 v3, v[110:111] offset:20480
    s_waitcnt lgkmcnt(0)
    s_mov_b32 s25, 98304
    buffer_load_dwordx4 v[64:67], v27, s[52:55], s25 offen
    buffer_load_dwordx4 v[68:71], v27, s[52:55], s25 offen offset:1024
    s_mov_b32 s25, 106496
    buffer_load_dwordx4 v[72:75], v27, s[52:55], s25 offen
    buffer_load_dwordx4 v[76:79], v27, s[52:55], s25 offen offset:1024
    s_waitcnt vmcnt(63)
    v_perm_b32 v96, v84, v80, s39
    v_perm_b32 v97, v92, v88, s39
    ds_write_b64 v4, v[96:97] offset:20488
    v_perm_b32 v98, v84, v80, s40
    v_perm_b32 v99, v92, v88, s40
    ds_write_b64 v4, v[98:99] offset:36872
    v_perm_b32 v100, v85, v81, s39
    v_perm_b32 v101, v93, v89, s39
    ds_write_b64 v4, v[100:101] offset:45064
    v_perm_b32 v102, v85, v81, s40
    v_perm_b32 v103, v93, v89, s40
    ds_write_b64 v4, v[102:103] offset:53256
    v_perm_b32 v104, v86, v82, s39
    v_perm_b32 v105, v94, v90, s39
    ds_write_b64 v4, v[104:105] offset:61448
    v_perm_b32 v106, v86, v82, s40
    v_perm_b32 v107, v94, v90, s40
    ds_write_b64 v5, v[106:107] offset:4104
    v_perm_b32 v108, v87, v83, s39
    v_perm_b32 v109, v95, v91, s39
    ds_write_b64 v5, v[108:109] offset:12296
    v_perm_b32 v110, v87, v83, s40
    v_perm_b32 v111, v95, v91, s40
    ds_write_b64 v3, v[110:111] offset:20488
    s_waitcnt lgkmcnt(0)
    s_mov_b32 s25, 100352
    buffer_load_dwordx4 v[80:83], v27, s[52:55], s25 offen
    buffer_load_dwordx4 v[84:87], v27, s[52:55], s25 offen offset:1024
    s_mov_b32 s25, 108544
    buffer_load_dwordx4 v[88:91], v27, s[52:55], s25 offen
    buffer_load_dwordx4 v[92:95], v27, s[52:55], s25 offen offset:1024
    s_waitcnt vmcnt(12)
    v_perm_b32 v96, v36, v32, s39
    v_perm_b32 v97, v44, v40, s39
    ds_write_b64 v4, v[96:97] offset:24576
    v_perm_b32 v208, v36, v32, s40
    v_perm_b32 v209, v44, v40, s40
    v_perm_b32 v216, v37, v33, s39
    v_perm_b32 v217, v45, v41, s39
    v_perm_b32 v224, v37, v33, s40
    v_perm_b32 v225, v45, v41, s40
    v_perm_b32 v232, v38, v34, s39
    v_perm_b32 v233, v46, v42, s39
    v_perm_b32 v240, v38, v34, s40
    v_perm_b32 v241, v46, v42, s40
    v_perm_b32 v108, v39, v35, s39
    v_perm_b32 v109, v47, v43, s39
    ds_write_b64 v5, v[108:109] offset:16384
    v_perm_b32 v110, v39, v35, s40
    v_perm_b32 v111, v47, v43, s40
    ds_write_b64 v5, v[110:111] offset:24576
    s_waitcnt lgkmcnt(0)
    v_readfirstlane_b32 s60, v29
    v_readfirstlane_b32 s61, v31
    v_lshlrev_b32 v30, 4, v2
    s_mov_b32 s25, 1179648
    buffer_load_dword v29, v30, s[8:11], s25 offen sc1
    s_waitcnt vmcnt(9)
    v_perm_b32 v96, v52, v48, s39
    v_perm_b32 v97, v60, v56, s39
    ds_write_b64 v4, v[96:97] offset:24584
    v_perm_b32 v210, v52, v48, s40
    v_perm_b32 v211, v60, v56, s40
    v_perm_b32 v218, v53, v49, s39
    v_perm_b32 v219, v61, v57, s39
    v_perm_b32 v226, v53, v49, s40
    v_perm_b32 v227, v61, v57, s40
    v_perm_b32 v234, v54, v50, s39
    v_perm_b32 v235, v62, v58, s39
    v_perm_b32 v242, v54, v50, s40
    v_perm_b32 v243, v62, v58, s40
    v_perm_b32 v108, v55, v51, s39
    v_perm_b32 v109, v63, v59, s39
    ds_write_b64 v5, v[108:109] offset:16392
    v_perm_b32 v110, v55, v51, s40
    v_perm_b32 v111, v63, v59, s40
    ds_write_b64 v5, v[110:111] offset:24584
    s_waitcnt lgkmcnt(0)
    s_add_u32 s25, s34, 0
    buffer_load_dwordx4 v[112:115], v3, s[8:11], s25 offen sc1
    s_add_u32 s25, s34, 131072
    buffer_load_dwordx4 v[112:115], v3, s[8:11], s25 offen sc1
    s_add_u32 s25, s34, 262144
    buffer_load_dwordx4 v[112:115], v3, s[8:11], s25 offen sc1
    s_add_u32 s25, s34, 393216
    buffer_load_dwordx4 v[112:115], v3, s[8:11], s25 offen sc1
    s_and_b32 s25, s34, 0x7000
    s_add_u32 s25, s25, 1048576
    buffer_load_dwordx4 v[112:115], v3, s[8:11], s25 offen sc1
    s_waitcnt vmcnt(10)
    v_perm_b32 v96, v68, v64, s39
    v_perm_b32 v97, v76, v72, s39
    ds_write_b64 v4, v[96:97] offset:28672
    v_perm_b32 v212, v68, v64, s40
    v_perm_b32 v213, v76, v72, s40
    v_perm_b32 v220, v69, v65, s39
    v_perm_b32 v221, v77, v73, s39
    v_perm_b32 v228, v69, v65, s40
    v_perm_b32 v229, v77, v73, s40
    v_perm_b32 v236, v70, v66, s39
    v_perm_b32 v237, v78, v74, s39
    v_perm_b32 v244, v70, v66, s40
    v_perm_b32 v245, v78, v74, s40
    v_perm_b32 v108, v71, v67, s39
    v_perm_b32 v109, v79, v75, s39
    ds_write_b64 v5, v[108:109] offset:20480
    v_perm_b32 v110, v71, v67, s40
    v_perm_b32 v111, v79, v75, s40
    ds_write_b64 v5, v[110:111] offset:28672
    s_waitcnt lgkmcnt(0)
    s_waitcnt vmcnt(6)
    v_perm_b32 v96, v84, v80, s39
    v_perm_b32 v97, v92, v88, s39
    ds_write_b64 v4, v[96:97] offset:28680
    v_perm_b32 v214, v84, v80, s40
    v_perm_b32 v215, v92, v88, s40
    v_perm_b32 v222, v85, v81, s39
    v_perm_b32 v223, v93, v89, s39
    v_perm_b32 v230, v85, v81, s40
    v_perm_b32 v231, v93, v89, s40
    v_perm_b32 v238, v86, v82, s39
    v_perm_b32 v239, v94, v90, s39
    v_perm_b32 v246, v86, v82, s40
    v_perm_b32 v247, v94, v90, s40
    v_perm_b32 v108, v87, v83, s39
    v_perm_b32 v109, v95, v91, s39
    ds_write_b64 v5, v[108:109] offset:20488
    v_perm_b32 v110, v87, v83, s40
    v_perm_b32 v111, v95, v91, s40
    ds_write_b64 v5, v[110:111] offset:28680
    s_waitcnt lgkmcnt(0)
    s_waitcnt vmcnt(0)
    s_lshl_b32 s36, s23, 14
    s_lshl_b32 s25, s21, 11
    s_add_u32 s36, s36, s25
    s_add_u32 s36, s36, 16777216
    s_add_u32 s41, s25, 8192
    s_add_u32 s42, s25, 16384
    s_lshl_b32 s43, s23, 14
    s_add_u32 s43, s43, 16785408
    s_add_u32 s101, s25, 0
    s_mov_b32 s26, 0
    v_cmp_eq_u32 vcc, 32, v29
    s_ff0_i32_b64 s51, vcc
    s_cmp_ge_u32 s60, 64
    s_cselect_b32 s51, s51, 0
    s_cmp_lg_u32 s51, 0
    s_cbranch_scc1 L_kv0ok
    v_mov_b32 v41, 0
L_lnw:
    buffer_load_dword v40, v41, s[12:15], 0 offen offset:68 sc1
    s_waitcnt vmcnt(0)
    v_readfirstlane_b32 s27, v40
    s_add_u32 s26, s26, 1
    s_cmp_gt_u32 s26, 400000
    s_cbranch_scc1 L_team_end
    s_cmp_lt_u32 s27, 64
    s_cbranch_scc1 L_lnw
L_kvw0:
    v_lshlrev_b32 v40, 4, v2
    s_mov_b32 s25, 1179648
    buffer_load_dword v41, v40, s[8:11], s25 offen sc1
    s_waitcnt vmcnt(0)
    v_cmp_eq_u32 vcc, 32, v41
    s_ff0_i32_b64 s51, vcc
    s_add_u32 s26, s26, 1
    s_cmp_gt_u32 s26, 400000
    s_cbranch_scc1 L_team_end
    s_cmp_gt_u32 s51, 0
    s_cbranch_scc0 L_kvw0
L_kv0ok:
    buffer_load_dwordx4 v[248:251], v2, s[8:11], s36 offen offset:0 sc1
    buffer_load_dwordx4 v[252:255], v2, s[8:11], s36 offen offset:1024 sc1
    s_add_u32 s36, s36, 524288
    s_cmp_ge_u32 s61, 32
    s_cbranch_scc1 L_init_wait
    s_cmp_lg_u32 s21, 0
    s_cbranch_scc1 L_init_wait
    v_mov_b32 v41, 0
    s_mov_b32 s26, 0
L_init_poll:
    buffer_load_dword v40, v41, s[12:15], 0 offen offset:36 sc1
    s_waitcnt vmcnt(0)
    v_readfirstlane_b32 s25, v40
    s_add_u32 s26, s26, 1
    s_cmp_gt_u32 s26, 400000
    s_cbranch_scc1 L_init_wait
    s_cmp_lt_u32 s25, 32
    s_cbranch_scc1 L_init_poll
L_init_wait:
    s_waitcnt lgkmcnt(0)
    s_barrier
    s_mov_b32 s24, 0
    s_mov_b32 s26, 0
    s_mov_b32 s48, 0
    s_mov_b32 s49, 0
    s_mov_b32 s50, 0
    s_mov_b32 s38, 0x3e0293ee
    v_mov_b32 v125, 0
    v_mov_b32 v127, 0
    s_lshl_b32 s32, s21, 17
    s_lshl_b32 s25, s23, 12
    s_add_u32 s32, s32, s25
    s_mov_b32 s38, 0x3e0293ee
    ds_read_b128 v[64:67], v3 offset:32768
    ds_read_b128 v[68:71], v3 offset:36864
    ds_read_b128 v[72:75], v3 offset:40960
    ds_read_b128 v[76:79], v3 offset:45056
    ds_read_b128 v[96:99], v3 offset:49152
    ds_read_b128 v[100:103], v3 offset:53248
    ds_read_b128 v[104:107], v3 offset:57344
    ds_read_b128 v[108:111], v3 offset:61440
    ds_read_b128 v[88:91], v4 offset:8192
    ds_read_b128 v[92:95], v4 offset:12288
    ds_read_b128 v[80:83], v4 offset:0
    ds_read_b128 v[84:87], v4 offset:4096
    v_mov_b64 v[48:49], 0
    v_mov_b64 v[50:51], 0
    v_mov_b64 v[52:53], 0
    v_mov_b64 v[54:55], 0
    v_mov_b64 v[56:57], 0
    v_mov_b64 v[58:59], 0
    v_mov_b64 v[60:61], 0
    v_mov_b64 v[62:63], 0
    v_mov_b64 v[112:113], 0
    v_mov_b64 v[114:115], 0
    v_mov_b64 v[116:117], 0
    v_mov_b64 v[118:119], 0
    v_mov_b64 v[120:121], -1
    v_mov_b64 v[122:123], -1
    s_and_b32 s25, s24, 3
    s_lshl_b32 s28, s25, 13
    s_add_u32 s28, s28, 1048576
    s_add_u32 s29, s28, 4096
    s_mov_b32 s30, 0
    s_mov_b32 s31, 131072
    s_add_u32 s35, s33, 16384
    s_and_b32 s25, s21, 1
    s_lshl_b32 s32, s25, 17
    s_lshl_b32 s25, s23, 12
    s_add_u32 s32, s32, s25
    s_lshr_b32 s25, s21, 1
    s_lshl_b32 s25, s25, 11
    s_add_u32 s32, s32, s25
    s_mov_b32 s66, 0xcccccccc
    s_mov_b32 s67, 0xcccccccc
    s_mov_b32 s64, 0
    s_waitcnt vmcnt(0) lgkmcnt(0)
    v_add_u32 v0, s41, v2
    ds_write_b128 v0, v[248:251]
    ds_write_b128 v0, v[252:255] offset:1024
.p2align 6
    s_nop 0
L_step_0:
    v_mov_b64 v[48:49], 0
    v_mov_b64 v[50:51], 0
    v_mov_b64 v[52:53], 0
    v_mov_b64 v[54:55], 0
    v_mov_b64 v[56:57], 0
    v_mov_b64 v[58:59], 0
    v_mov_b64 v[60:61], 0
    v_mov_b64 v[62:63], 0
    v_mov_b64 v[112:113], 0
    v_mov_b64 v[114:115], 0
    v_mov_b64 v[116:117], 0
    v_mov_b64 v[118:119], 0
    v_mov_b64 v[120:121], -1
    v_mov_b64 v[122:123], -1
    buffer_load_dwordx4 v[16:19], v3, s[8:11], s28 offen sc1
    s_nop 1
    buffer_load_dwordx4 v[32:35], v3, s[8:11], s29 offen sc1
    s_nop 5
    buffer_load_dwordx4 v[16:19], v3, s[8:11], s28 offen sc1
    s_nop 1
    buffer_load_dwordx4 v[32:35], v3, s[8:11], s29 offen sc1
    s_xor_b32 s25, s30, 262144
    s_add_u32 s25, s25, s34
    buffer_store_dwordx4 v[120:123], v3, s[8:11], s25 offen
    s_add_u32 s25, s25, 131072
    buffer_store_dwordx4 v[120:123], v3, s[8:11], s25 offen
    buffer_store_dword v120, v14, s[8:11], s35 offen
L_pollA_0:
    s_waitcnt vmcnt(6)
L_pollA2_0:
    v_max3_u32 v0, v16, v17, v18
    v_max_u32 v0, v0, v19
    ds_write_b128 v3, v[16:19] offset:0
    v_smfmac_f32_16x16x64_bf16 v[48:51], v[16:19], a[0:7], v1
    s_waitcnt vmcnt(5)
    v_max3_u32 v0, v0, v32, v33
    v_max3_u32 v0, v0, v34, v35
    v_smfmac_f32_16x16x64_bf16 v[52:55], v[16:19], v[64:71], v1
    ds_write_b128 v3, v[32:35] offset:4096
    v_cmp_eq_u32 vcc, -1, v0
    v_smfmac_f32_16x16x64_bf16 v[56:59], v[16:19], v[72:79], v1
    v_smfmac_f32_16x16x64_bf16 v[60:63], v[16:19], a[104:111], v1
    s_cbranch_vccnz L_retryA_0
    v_smfmac_f32_16x16x64_bf16 v[112:115], v[16:19], a[208:215], v1
    v_smfmac_f32_16x16x64_bf16 v[116:119], v[16:19], a[216:223], v1
    s_waitcnt lgkmcnt(0)
    s_barrier
    ds_read_b128 v[20:23], v6 offset:0
L_okB_0:
    v_smfmac_f32_16x16x64_bf16 v[48:51], v[32:35], v[96:103], v1
    ds_read_b128 v[24:27], v7 offset:0
    v_smfmac_f32_16x16x64_bf16 v[52:55], v[32:35], a[48:55], v1
    ds_read_b128 v[28:31], v8 offset:0
    v_smfmac_f32_16x16x64_bf16 v[56:59], v[32:35], a[152:159], v1
    ds_read_b128 v[36:39], v6 offset:4096
    v_smfmac_f32_16x16x64_bf16 v[60:63], v[32:35], v[104:111], v1
    ds_read_b128 v[64:67], v2 offset:12288
    v_smfmac_f32_16x16x64_bf16 v[112:115], v[32:35], v[144:151], v1
    ds_read_b128 v[68:71], v2 offset:13312
    v_smfmac_f32_16x16x64_bf16 v[116:119], v[32:35], v[152:159], v1
    s_waitcnt lgkmcnt(5)
    v_smfmac_f32_16x16x64_bf16 v[48:51], v[20:23], a[8:15], v1
    ds_read_b128 v[40:43], v7 offset:4096
    buffer_load_dwordx4 v[16:19], v3, s[8:11], s43 offen sc1
    s_add_u32 s27, s43, 4096
    v_smfmac_f32_16x16x64_bf16 v[52:55], v[20:23], a[16:23], v1
    ds_read_b128 v[44:47], v8 offset:4096
    s_add_u32 s24, s24, 1
    v_smfmac_f32_16x16x64_bf16 v[56:59], v[20:23], a[112:119], v1
    buffer_load_dwordx4 v[32:35], v3, s[8:11], s27 offen sc1
    s_add_u32 s43, s43, 524288
    v_smfmac_f32_16x16x64_bf16 v[60:63], v[20:23], a[120:127], v1
    s_waitcnt lgkmcnt(5)
    v_smfmac_f32_16x16x64_bf16 v[48:51], v[24:27], a[24:31], v1
    ds_read_b128 v[72:75], v2 offset:14336
    v_smfmac_f32_16x16x64_bf16 v[52:55], v[24:27], a[32:39], v1
    ds_read_b128 v[76:79], v2 offset:15360
    v_smfmac_f32_16x16x64_bf16 v[56:59], v[24:27], v[80:87], v1
    s_add_u32 s100, s30, s32
    s_and_b32 s44, s24, 3
    v_smfmac_f32_16x16x64_bf16 v[60:63], v[24:27], a[128:135], v1
    ds_read_b128 v[96:99], v2 offset:8192
    v_smfmac_f32_16x16x64_bf16 v[52:55], v[28:31], v[88:95], v1
    ds_read_b128 v[100:103], v2 offset:9216
    v_smfmac_f32_16x16x64_bf16 v[56:59], v[28:31], a[136:143], v1
    v_cmp_eq_u32 vcc, 32, v124
    v_smfmac_f32_16x16x64_bf16 v[48:51], v[28:31], a[40:47], v1
    s_lshl_b32 s45, s44, 13
    s_add_u32 s28, s45, 1048576
    s_add_u32 s29, s28, 4096
    v_smfmac_f32_16x16x64_bf16 v[60:63], v[28:31], a[144:151], v1
    s_waitcnt lgkmcnt(4)
    ds_read_b128 v[104:107], v2 offset:10240
    v_smfmac_f32_16x16x64_bf16 v[48:51], v[36:39], a[56:63], v1
    s_and_b32 s25, vcc_lo, s64
    s_ff0_i32_b32 s25, s25
    s_add_u32 s51, s51, s25
    v_smfmac_f32_16x16x64_bf16 v[52:55], v[36:39], a[64:71], v1
    ds_read_b128 v[108:111], v2 offset:11264
    v_smfmac_f32_16x16x64_bf16 v[48:51], v[40:43], a[72:79], v1
    buffer_store_dword v15, v14, s[8:11], s37 offen sc1
    s_add_u32 s37, s37, 8192
    v_smfmac_f32_16x16x64_bf16 v[52:55], v[40:43], a[80:87], v1
    s_add_u32 s46, s45, s33
    s_xor_b32 s35, s45, 16384
    s_add_u32 s35, s35, s33
    v_smfmac_f32_16x16x64_bf16 v[48:51], v[44:47], a[88:95], v1
    s_add_u32 s25, s24, 5
    s_min_u32 s25, s25, 63
    v_smfmac_f32_16x16x64_bf16 v[52:55], v[44:47], a[96:103], v1
    s_cmp_gt_u32 s51, s25
    s_cselect_b32 s64, 0, 0xffff
    v_smfmac_f32_16x16x64_bf16 v[56:59], v[36:39], a[160:167], v1
    v_add_f32 v48, v48, v50
    v_smfmac_f32_16x16x64_bf16 v[56:59], v[40:43], a[176:183], v1
    v_add_f32 v49, v49, v51
    v_smfmac_f32_16x16x64_bf16 v[56:59], v[44:47], a[192:199], v1
    v_add_f32 v52, v52, v54
    v_smfmac_f32_16x16x64_bf16 v[60:63], v[36:39], a[168:175], v1
    v_add_f32 v53, v53, v55
    v_smfmac_f32_16x16x64_bf16 v[60:63], v[40:43], a[184:191], v1
    v_cvt_pk_bf16_f32 v48, v48, v52
    v_smfmac_f32_16x16x64_bf16 v[60:63], v[44:47], a[200:207], v1
    v_cvt_pk_bf16_f32 v49, v49, v53
    v_smfmac_f32_16x16x64_bf16 v[112:115], v[20:23], a[224:231], v1
    ds_write2_b32 v10, v48, v49 offset0:0 offset1:136
    v_add_f32 v56, v56, v58
    v_add_f32 v57, v57, v59
    v_smfmac_f32_16x16x64_bf16 v[116:119], v[20:23], a[232:239], v1
    v_add_f32 v60, v60, v62
    v_add_f32 v61, v61, v63
    v_smfmac_f32_16x16x64_bf16 v[112:115], v[24:27], a[240:247], v1
    v_cvt_pk_bf16_f32 v56, v56, v60
    v_cvt_pk_bf16_f32 v57, v57, v61
    ds_write2_b32 v10, v56, v57 offset0:64 offset1:200
    v_smfmac_f32_16x16x64_bf16 v[116:119], v[24:27], a[248:255], v1
    v_smfmac_f32_16x16x64_bf16 v[112:115], v[28:31], v[128:135], v1
    s_cmp_gt_u32 s51, s24
    s_cbranch_scc0 L_kvw_0
L_kvok_0:
    v_smfmac_f32_16x16x64_bf16 v[116:119], v[28:31], v[136:143], v1
    buffer_load_dwordx4 v[248:251], v2, s[8:11], s36 offen offset:0 sc1
    v_smfmac_f32_16x16x64_bf16 v[112:115], v[36:39], v[160:167], v1
    s_waitcnt lgkmcnt(0)
    s_barrier
    ds_read_b128 v[80:83], v11 offset:24576
    v_smfmac_f32_16x16x64_bf16 v[116:119], v[36:39], v[168:175], v1
    buffer_load_dwordx4 v[252:255], v2, s[8:11], s36 offen offset:1024 sc1
    s_add_u32 s36, s36, 524288
    ds_read_b128 v[84:87], v11 offset:24640
    v_mov_b32 v120, 0x3f803f80
    v_smfmac_f32_16x16x64_bf16 v[112:115], v[40:43], v[176:183], v1
    ds_read_b128 v[88:91], v11 offset:24704
    v_mov_b32 v121, 0x3f803f80
    v_smfmac_f32_16x16x64_bf16 v[116:119], v[40:43], v[184:191], v1
    ds_read_b128 v[92:95], v11 offset:24768
    v_mov_b32 v122, 0x3f803f80
    v_smfmac_f32_16x16x64_bf16 v[112:115], v[44:47], v[192:199], v1
    ds_read_b128 v[48:51], v11 offset:24832
    v_mov_b32 v123, 0x3f803f80
    v_smfmac_f32_16x16x64_bf16 v[116:119], v[44:47], v[200:207], v1
    ds_read_b128 v[56:59], v11 offset:24960
    ds_read_b128 v[52:55], v11 offset:24896
    s_waitcnt lgkmcnt(5)
    v_mfma_f32_16x16x32_bf16 v[20:23], v[96:99], v[80:83], 0
    ds_read_b128 v[60:63], v11 offset:25024
    v_mov_b64 v[46:47], 0
    v_mfma_f32_16x16x32_bf16 v[24:27], v[64:67], v[80:83], 0
    v_add_f32 v112, v112, v114
    v_add_f32 v113, v113, v115
    v_mfma_f32_16x16x32_bf16 v[20:23], v[100:103], v[84:87], v[20:23]
    v_cvt_pk_bf16_f32 v124, v112, v113
    v_add_f32 v116, v116, v118
    v_mfma_f32_16x16x32_bf16 v[24:27], v[68:71], v[84:87], v[24:27]
    s_waitcnt lgkmcnt(4)
    v_add_f32 v117, v117, v119
    v_mfma_f32_16x16x32_bf16 v[20:23], v[104:107], v[88:91], v[20:23]
    ds_read_b128 v[96:99], v4 offset:57344
    v_cvt_pk_bf16_f32 v126, v116, v117
    v_mfma_f32_16x16x32_bf16 v[24:27], v[72:75], v[88:91], v[24:27]
    ds_read_b128 v[100:103], v4 offset:61440
    v_mov_b64 v[42:43], 0
    v_mfma_f32_16x16x32_bf16 v[20:23], v[108:111], v[92:95], v[20:23]
    ds_read_b128 v[64:67], v4 offset:16384
    v_mov_b64 v[44:45], 0
    v_mfma_f32_16x16x32_bf16 v[24:27], v[76:79], v[92:95], v[24:27]
    s_waitcnt lgkmcnt(3)
    ds_read_b128 v[68:71], v4 offset:20480
    v_mfma_f32_16x16x32_bf16 v[28:31], v[48:51], v[80:83], 0
    ds_read_b128 v[104:107], v4 offset:24576
    v_max3_f32 v0, v20, v21, v22
    v_mfma_f32_16x16x32_bf16 v[28:31], v[52:55], v[84:87], v[28:31]
    v_max3_f32 v0, v0, v23, v24
    v_max3_f32 v0, v0, v25, v26
    v_mfma_f32_16x16x32_bf16 v[28:31], v[56:59], v[88:91], v[28:31]
    ds_read_b128 v[108:111], v4 offset:28672
    v_max_f32 v0, v0, v27
    v_mov_b32 v15, v0
    v_mfma_f32_16x16x32_bf16 v[28:31], v[60:63], v[92:95], v[28:31]
    ds_read_b128 v[112:115], v4 offset:40960
    v_permlane32_swap_b32 v0, v15
    v_max_f32 v0, v0, v15
    ds_read_b128 v[116:119], v4 offset:45056
    v_mov_b64 v[36:37], 0
    v_mov_b64 v[38:39], 0
    ds_read_b128 v[72:75], v4 offset:32768
    s_nop 0
    v_max3_f32 v0, v0, v28, v29
    v_max3_f32 v0, v0, v30, v31
    v_mov_b32 v30, v0
    ds_read_b128 v[76:79], v4 offset:36864
    v_mov_b64 v[40:41], 0
    v_permlane16_swap_b32 v0, v30
    v_max_f32 v0, v0, v30
    v_mul_f32 v30, s38, v0
    v_pk_fma_f32 v[28:29], v[28:29], s[38:39], v[30:31] op_sel_hi:[1,0,0] neg_lo:[0,0,1] neg_hi:[0,0,1]
    v_pk_fma_f32 v[20:21], v[20:21], s[38:39], v[30:31] op_sel_hi:[1,0,0] neg_lo:[0,0,1] neg_hi:[0,0,1]
    v_pk_fma_f32 v[22:23], v[22:23], s[38:39], v[30:31] op_sel_hi:[1,0,0] neg_lo:[0,0,1] neg_hi:[0,0,1]
    v_pk_fma_f32 v[24:25], v[24:25], s[38:39], v[30:31] op_sel_hi:[1,0,0] neg_lo:[0,0,1] neg_hi:[0,0,1]
    v_pk_fma_f32 v[26:27], v[26:27], s[38:39], v[30:31] op_sel_hi:[1,0,0] neg_lo:[0,0,1] neg_hi:[0,0,1]
    v_exp_f32 v28, v28
    v_exp_f32 v29, v29
    v_exp_f32 v20, v20
    v_cvt_pk_bf16_f32 v28, v28, v29
    v_mov_b32 v29, 0
    v_exp_f32 v21, v21
    v_exp_f32 v22, v22
    v_mfma_f32_16x16x16_bf16 v[88:91], v[120:121], v[28:29], 0
    v_exp_f32 v23, v23
    v_cvt_pk_bf16_f32 v20, v20, v21
    v_mfma_f32_16x16x16_bf16 v[80:83], v[124:125], v[28:29], 0
    v_exp_f32 v24, v24
    v_exp_f32 v25, v25
    v_mfma_f32_16x16x16_bf16 v[84:87], v[126:127], v[28:29], 0
    v_exp_f32 v26, v26
    v_exp_f32 v27, v27
    v_cvt_pk_bf16_f32 v21, v22, v23
    v_cvt_pk_bf16_f32 v22, v24, v25
    v_cvt_pk_bf16_f32 v23, v26, v27
    s_waitcnt vmcnt(3)
    s_nop 0
    v_mfma_f32_16x16x32_bf16 v[88:91], v[120:123], v[20:23], v[88:91]
    v_mov_b64 v[24:25], 0
    v_mfma_f32_16x16x32_bf16 v[80:83], v[16:19], v[20:23], v[80:83]
    v_mov_b64 v[26:27], 0
    v_mov_b64 v[28:29], 0
    v_mfma_f32_16x16x32_bf16 v[84:87], v[32:35], v[20:23], v[84:87]
    v_mov_b64 v[30:31], 0
    v_rcp_f32 v0, v88
    v_mov_b64 v[16:17], 0
    s_nop 0
    v_cndmask_b32 v80, v80, v82, s[66:67]
    v_cndmask_b32 v81, v81, v83, s[66:67]
    v_mul_f32 v80, v80, v0
    v_mul_f32 v81, v81, v0
    v_cndmask_b32 v84, v84, v86, s[66:67]
    v_cndmask_b32 v85, v85, v87, s[66:67]
    v_pk_mul_f32 v[84:85], v[84:85], v[0:1] op_sel_hi:[1,0]
    v_cvt_pk_bf16_f32 v80, v80, v84
    v_cvt_pk_bf16_f32 v81, v81, v85
    ds_write_b64 v12, v[80:81] offset:29184
    v_mov_b64 v[18:19], 0
    v_mov_b64 v[20:21], 0
    s_waitcnt lgkmcnt(0)
    s_barrier
    ds_read_b128 v[48:51], v13 offset:29184
    ds_read_b128 v[52:55], v13 offset:29312
    v_mov_b64 v[22:23], 0
    v_mov_b64 v[32:33], 0
    v_mov_b64 v[34:35], 0
    s_cmp_lg_u32 s64, 0
    s_cbranch_scc1 L_kfgo_0
L_nokf_0:
    s_waitcnt lgkmcnt(1)
    v_smfmac_f32_16x16x64_bf16 v[16:19], v[48:51], v[64:71], v1
    s_waitcnt lgkmcnt(0)
    ds_read_b128 v[56:59], v4 offset:49152
    v_smfmac_f32_16x16x64_bf16 v[16:19], v[52:55], v[104:111], v1
    ds_read_b128 v[60:63], v4 offset:53248
    v_smfmac_f32_16x16x64_bf16 v[20:23], v[48:51], v[72:79], v1
    ds_read_b128 v[88:91], v5 offset:0
    v_smfmac_f32_16x16x64_bf16 v[20:23], v[52:55], v[208:215], v1
    ds_read_b128 v[92:95], v5 offset:4096
    v_add_f32 v16, v16, v18
    v_smfmac_f32_16x16x64_bf16 v[24:27], v[48:51], v[112:119], v1
    ds_read_b128 v[64:67], v5 offset:8192
    v_add_f32 v17, v17, v19
    v_smfmac_f32_16x16x64_bf16 v[24:27], v[52:55], v[216:223], v1
    s_waitcnt lgkmcnt(3)
    ds_read_b128 v[68:71], v5 offset:12288
    v_add_f32 v20, v20, v22
    v_smfmac_f32_16x16x64_bf16 v[28:31], v[48:51], v[56:63], v1
    ds_read_b128 v[104:107], v5 offset:16384
    v_add_f32 v21, v21, v23
    v_smfmac_f32_16x16x64_bf16 v[28:31], v[52:55], v[224:231], v1
    ds_read_b128 v[108:111], v5 offset:20480
    v_cvt_pk_bf16_f32 v80, v16, v20
    v_cvt_pk_bf16_f32 v82, v17, v21
    v_smfmac_f32_16x16x64_bf16 v[32:35], v[48:51], v[96:103], v1
    ds_read_b128 v[112:115], v3 offset:16384
    v_add_f32 v24, v24, v26
    v_add_f32 v25, v25, v27
    v_smfmac_f32_16x16x64_bf16 v[32:35], v[52:55], v[232:239], v1
    s_waitcnt lgkmcnt(3)
    ds_read_b128 v[116:119], v3 offset:20480
    v_add_f32 v28, v28, v30
    v_add_f32 v29, v29, v31
    v_smfmac_f32_16x16x64_bf16 v[36:39], v[48:51], v[88:95], v1
    ds_read_b128 v[72:75], v5 offset:24576
    v_cvt_pk_bf16_f32 v81, v24, v28
    v_cvt_pk_bf16_f32 v83, v25, v29
    v_smfmac_f32_16x16x64_bf16 v[36:39], v[52:55], v[240:247], v1
    buffer_store_dwordx4 v[80:83], v9, s[8:11], s30 offen
    ds_read_b128 v[76:79], v5 offset:28672
    v_add_f32 v32, v32, v34
    v_smfmac_f32_16x16x64_bf16 v[40:43], v[48:51], v[64:71], v1
    s_waitcnt lgkmcnt(4)
    v_add_f32 v33, v33, v35
    v_smfmac_f32_16x16x64_bf16 v[40:43], v[52:55], v[104:111], v1
    s_waitcnt lgkmcnt(2)
    v_add_f32 v36, v36, v38
    v_smfmac_f32_16x16x64_bf16 v[44:47], v[48:51], v[112:119], v1
    s_waitcnt lgkmcnt(0)
    v_add_f32 v37, v37, v39
    v_smfmac_f32_16x16x64_bf16 v[44:47], v[52:55], v[72:79], v1
    v_cvt_pk_bf16_f32 v84, v32, v36
    v_cvt_pk_bf16_f32 v86, v33, v37
    v_add_f32 v40, v40, v42
    v_add_f32 v41, v41, v43
    s_nop 3
    v_add_f32 v44, v44, v46
    v_add_f32 v45, v45, v47
    v_cvt_pk_bf16_f32 v85, v40, v44
    v_cvt_pk_bf16_f32 v87, v41, v45
    buffer_store_dwordx4 v[84:87], v9, s[8:11], s31 offen
    s_barrier
    ds_read_b128 v[44:47], v2 offset:31744
    s_xor_b32 s30, s30, 262144
    s_xor_b32 s31, s31, 262144
    ds_read_b128 v[64:67], v3 offset:32768
    ds_read_b128 v[68:71], v3 offset:36864
    s_bitcmp1_b32 s21, 0
    s_cbranch_scc1 L_tailB_0
    ds_read_b128 v[72:75], v3 offset:40960
    ds_read_b128 v[76:79], v3 offset:45056
    ds_read_b128 v[96:99], v3 offset:49152
    ds_read_b128 v[100:103], v3 offset:53248
    s_nop 15
    s_nop 7
    buffer_load_dwordx4 v[36:39], v2, s[8:11], s100 offen offset:0 sc1
    buffer_load_dwordx4 v[40:43], v2, s[8:11], s100 offen offset:1024 sc1
    ds_read_b128 v[104:107], v3 offset:57344
    ds_read_b128 v[108:111], v3 offset:61440
    ds_read_b128 v[88:91], v4 offset:8192
    ds_read_b128 v[92:95], v4 offset:12288
    ds_read_b128 v[80:83], v4 offset:0
    ds_read_b128 v[84:87], v4 offset:4096
    s_nop 3
    buffer_load_dwordx4 v[36:39], v2, s[8:11], s100 offen offset:0 sc1
    buffer_load_dwordx4 v[40:43], v2, s[8:11], s100 offen offset:1024 sc1
    s_waitcnt vmcnt(6)
    v_add_u32 v0, s41, v2
    ds_write_b128 v0, v[248:251]
    ds_write_b128 v0, v[252:255] offset:1024
    s_waitcnt lgkmcnt(2)
L_pipe20_0:
    s_waitcnt vmcnt(3)
    v_max3_u32 v0, v36, v37, 0
    v_max3_u32 v0, v38, v39, v0
    v_mfma_f32_16x16x32_bf16 v[28:31], v[44:47], v[36:39], 0
    s_waitcnt vmcnt(2)
    v_max3_u32 v0, v40, v41, v0
    v_max3_u32 v0, v42, v43, v0
    v_mfma_f32_16x16x32_bf16 v[28:31], v[44:47], v[40:43], v[28:31]
    v_cmp_eq_u32 vcc, -1, v0
    s_nop 5
    s_cbranch_vccnz L_retryp0_0
    v_add_f32_dpp v28, v28, v28 row_ror:4 row_mask:0xf bank_mask:0xf
    v_add_f32_dpp v29, v29, v29 row_ror:4 row_mask:0xf bank_mask:0xf
    s_nop 0
    v_add_f32_dpp v28, v28, v28 row_ror:8 row_mask:0xf bank_mask:0xf
    v_add_f32_dpp v29, v29, v29 row_ror:8 row_mask:0xf bank_mask:0xf
    v_cvt_pk_bf16_f32 v15, v28, v29
    v_min_u32 v15, 0xfffffffe, v15
    buffer_store_dword v15, v14, s[8:11], s46 offen
    s_branch L_tailj_0
L_tailB_0:
    ds_read_b128 v[72:75], v3 offset:40960
    ds_read_b128 v[76:79], v3 offset:45056
    ds_read_b128 v[96:99], v3 offset:49152
    ds_read_b128 v[100:103], v3 offset:53248
    ds_read_b128 v[104:107], v3 offset:57344
    ds_read_b128 v[108:111], v3 offset:61440
    ds_read_b128 v[88:91], v4 offset:8192
    ds_read_b128 v[92:95], v4 offset:12288
    s_nop 15
    buffer_load_dwordx4 v[36:39], v2, s[8:11], s100 offen offset:0 sc1
    buffer_load_dwordx4 v[40:43], v2, s[8:11], s100 offen offset:1024 sc1
    ds_read_b128 v[80:83], v4 offset:0
    ds_read_b128 v[84:87], v4 offset:4096
    s_nop 11
    buffer_load_dwordx4 v[36:39], v2, s[8:11], s100 offen offset:0 sc1
    buffer_load_dwordx4 v[40:43], v2, s[8:11], s100 offen offset:1024 sc1
    s_waitcnt vmcnt(6)
    v_add_u32 v0, s41, v2
    ds_write_b128 v0, v[248:251]
    ds_write_b128 v0, v[252:255] offset:1024
    s_waitcnt lgkmcnt(2)
L_pipe21_0:
    s_waitcnt vmcnt(3)
    v_max3_u32 v0, v36, v37, 0
    v_max3_u32 v0, v38, v39, v0
    v_mfma_f32_16x16x32_bf16 v[28:31], v[44:47], v[36:39], 0
    s_waitcnt vmcnt(2)
    v_max3_u32 v0, v40, v41, v0
    v_max3_u32 v0, v42, v43, v0
    v_mfma_f32_16x16x32_bf16 v[28:31], v[44:47], v[40:43], v[28:31]
    v_cmp_eq_u32 vcc, -1, v0
    s_nop 5
    s_cbranch_vccnz L_retryp1_0
    v_add_f32_dpp v28, v28, v28 row_ror:4 row_mask:0xf bank_mask:0xf
    v_add_f32_dpp v29, v29, v29 row_ror:4 row_mask:0xf bank_mask:0xf
    s_nop 0
    v_add_f32_dpp v28, v28, v28 row_ror:8 row_mask:0xf bank_mask:0xf
    v_add_f32_dpp v29, v29, v29 row_ror:8 row_mask:0xf bank_mask:0xf
    v_cvt_pk_bf16_f32 v15, v28, v29
    v_min_u32 v15, 0xfffffffe, v15
    buffer_store_dword v15, v14, s[8:11], s46 offen
L_tailj_0:
    s_barrier
    s_cmp_eq_u32 s24, 63
    s_cbranch_scc1 L_last
L_step_1:
    v_mov_b64 v[48:49], 0
    v_mov_b64 v[50:51], 0
    v_mov_b64 v[52:53], 0
    v_mov_b64 v[54:55], 0
    v_mov_b64 v[56:57], 0
    v_mov_b64 v[58:59], 0
    v_mov_b64 v[60:61], 0
    v_mov_b64 v[62:63], 0
    v_mov_b64 v[112:113], 0
    v_mov_b64 v[114:115], 0
    v_mov_b64 v[116:117], 0
    v_mov_b64 v[118:119], 0
    v_mov_b64 v[120:121], -1
    v_mov_b64 v[122:123], -1
    buffer_load_dwordx4 v[16:19], v3, s[8:11], s28 offen sc1
    s_nop 1
    buffer_load_dwordx4 v[32:35], v3, s[8:11], s29 offen sc1
    s_nop 5
    buffer_load_dwordx4 v[16:19], v3, s[8:11], s28 offen sc1
    s_nop 1
    buffer_load_dwordx4 v[32:35], v3, s[8:11], s29 offen sc1
    s_xor_b32 s25, s30, 262144
    s_add_u32 s25, s25, s34
    buffer_store_dwordx4 v[120:123], v3, s[8:11], s25 offen
    s_add_u32 s25, s25, 131072
    buffer_store_dwordx4 v[120:123], v3, s[8:11], s25 offen
    buffer_store_dword v120, v14, s[8:11], s35 offen
L_pollA_1:
    s_waitcnt vmcnt(6)
L_pollA2_1:
    v_max3_u32 v0, v16, v17, v18
    v_max_u32 v0, v0, v19
    ds_write_b128 v3, v[16:19] offset:0
    v_smfmac_f32_16x16x64_bf16 v[48:51], v[16:19], a[0:7], v1
    s_waitcnt vmcnt(5)
    v_max3_u32 v0, v0, v32, v33
    v_max3_u32 v0, v0, v34, v35
    v_smfmac_f32_16x16x64_bf16 v[52:55], v[16:19], v[64:71], v1
    ds_write_b128 v3, v[32:35] offset:4096
    v_cmp_eq_u32 vcc, -1, v0
    v_smfmac_f32_16x16x64_bf16 v[56:59], v[16:19], v[72:79], v1
    v_smfmac_f32_16x16x64_bf16 v[60:63], v[16:19], a[104:111], v1
    s_cbranch_vccnz L_retryA_1
    v_smfmac_f32_16x16x64_bf16 v[112:115], v[16:19], a[208:215], v1
    v_smfmac_f32_16x16x64_bf16 v[116:119], v[16:19], a[216:223], v1
    s_waitcnt lgkmcnt(0)
    s_barrier
    ds_read_b128 v[20:23], v6 offset:0
L_okB_1:
    v_smfmac_f32_16x16x64_bf16 v[48:51], v[32:35], v[96:103], v1
    ds_read_b128 v[24:27], v7 offset:0
    v_smfmac_f32_16x16x64_bf16 v[52:55], v[32:35], a[48:55], v1
    ds_read_b128 v[28:31], v8 offset:0
    v_smfmac_f32_16x16x64_bf16 v[56:59], v[32:35], a[152:159], v1
    ds_read_b128 v[36:39], v6 offset:4096
    v_smfmac_f32_16x16x64_bf16 v[60:63], v[32:35], v[104:111], v1
    ds_read_b128 v[64:67], v2 offset:12288
    v_smfmac_f32_16x16x64_bf16 v[112:115], v[32:35], v[144:151], v1
    ds_read_b128 v[68:71], v2 offset:13312
    v_smfmac_f32_16x16x64_bf16 v[116:119], v[32:35], v[152:159], v1
    s_waitcnt lgkmcnt(5)
    v_smfmac_f32_16x16x64_bf16 v[48:51], v[20:23], a[8:15], v1
    ds_read_b128 v[40:43], v7 offset:4096
    buffer_load_dwordx4 v[16:19], v3, s[8:11], s43 offen sc1
    s_add_u32 s27, s43, 4096
    v_smfmac_f32_16x16x64_bf16 v[52:55], v[20:23], a[16:23], v1
    ds_read_b128 v[44:47], v8 offset:4096
    s_add_u32 s24, s24, 1
    v_smfmac_f32_16x16x64_bf16 v[56:59], v[20:23], a[112:119], v1
    buffer_load_dwordx4 v[32:35], v3, s[8:11], s27 offen sc1
    s_add_u32 s43, s43, 524288
    v_smfmac_f32_16x16x64_bf16 v[60:63], v[20:23], a[120:127], v1
    s_waitcnt lgkmcnt(5)
    v_smfmac_f32_16x16x64_bf16 v[48:51], v[24:27], a[24:31], v1
    ds_read_b128 v[72:75], v2 offset:14336
    v_smfmac_f32_16x16x64_bf16 v[52:55], v[24:27], a[32:39], v1
    ds_read_b128 v[76:79], v2 offset:15360
    v_smfmac_f32_16x16x64_bf16 v[56:59], v[24:27], v[80:87], v1
    s_add_u32 s100, s30, s32
    s_and_b32 s44, s24, 3
    v_smfmac_f32_16x16x64_bf16 v[60:63], v[24:27], a[128:135], v1
    ds_read_b128 v[96:99], v2 offset:8192
    v_smfmac_f32_16x16x64_bf16 v[52:55], v[28:31], v[88:95], v1
    ds_read_b128 v[100:103], v2 offset:9216
    v_smfmac_f32_16x16x64_bf16 v[56:59], v[28:31], a[136:143], v1
    v_cmp_eq_u32 vcc, 32, v124
    v_smfmac_f32_16x16x64_bf16 v[48:51], v[28:31], a[40:47], v1
    s_lshl_b32 s45, s44, 13
    s_add_u32 s28, s45, 1048576
    s_add_u32 s29, s28, 4096
    v_smfmac_f32_16x16x64_bf16 v[60:63], v[28:31], a[144:151], v1
    s_waitcnt lgkmcnt(4)
    ds_read_b128 v[104:107], v2 offset:10240
    v_smfmac_f32_16x16x64_bf16 v[48:51], v[36:39], a[56:63], v1
    s_and_b32 s25, vcc_lo, s64
    s_ff0_i32_b32 s25, s25
    s_add_u32 s51, s51, s25
    v_smfmac_f32_16x16x64_bf16 v[52:55], v[36:39], a[64:71], v1
    ds_read_b128 v[108:111], v2 offset:11264
    v_smfmac_f32_16x16x64_bf16 v[48:51], v[40:43], a[72:79], v1
    buffer_store_dword v15, v14, s[8:11], s37 offen sc1
    s_add_u32 s37, s37, 8192
    v_smfmac_f32_16x16x64_bf16 v[52:55], v[40:43], a[80:87], v1
    s_add_u32 s46, s45, s33
    s_xor_b32 s35, s45, 16384
    s_add_u32 s35, s35, s33
    v_smfmac_f32_16x16x64_bf16 v[48:51], v[44:47], a[88:95], v1
    s_add_u32 s25, s24, 5
    s_min_u32 s25, s25, 63
    v_smfmac_f32_16x16x64_bf16 v[52:55], v[44:47], a[96:103], v1
    s_cmp_gt_u32 s51, s25
    s_cselect_b32 s64, 0, 0xffff
    v_smfmac_f32_16x16x64_bf16 v[56:59], v[36:39], a[160:167], v1
    v_add_f32 v48, v48, v50
    v_smfmac_f32_16x16x64_bf16 v[56:59], v[40:43], a[176:183], v1
    v_add_f32 v49, v49, v51
    v_smfmac_f32_16x16x64_bf16 v[56:59], v[44:47], a[192:199], v1
    v_add_f32 v52, v52, v54
    v_smfmac_f32_16x16x64_bf16 v[60:63], v[36:39], a[168:175], v1
    v_add_f32 v53, v53, v55
    v_smfmac_f32_16x16x64_bf16 v[60:63], v[40:43], a[184:191], v1
    v_cvt_pk_bf16_f32 v48, v48, v52
    v_smfmac_f32_16x16x64_bf16 v[60:63], v[44:47], a[200:207], v1
    v_cvt_pk_bf16_f32 v49, v49, v53
    v_smfmac_f32_16x16x64_bf16 v[112:115], v[20:23], a[224:231], v1
    ds_write2_b32 v10, v48, v49 offset0:0 offset1:136
    v_add_f32 v56, v56, v58
    v_add_f32 v57, v57, v59
    v_smfmac_f32_16x16x64_bf16 v[116:119], v[20:23], a[232:239], v1
    v_add_f32 v60, v60, v62
    v_add_f32 v61, v61, v63
    v_smfmac_f32_16x16x64_bf16 v[112:115], v[24:27], a[240:247], v1
    v_cvt_pk_bf16_f32 v56, v56, v60
    v_cvt_pk_bf16_f32 v57, v57, v61
    ds_write2_b32 v10, v56, v57 offset0:64 offset1:200
    v_smfmac_f32_16x16x64_bf16 v[116:119], v[24:27], a[248:255], v1
    v_smfmac_f32_16x16x64_bf16 v[112:115], v[28:31], v[128:135], v1
    s_cmp_gt_u32 s51, s24
    s_cbranch_scc0 L_kvw_1
L_kvok_1:
    v_smfmac_f32_16x16x64_bf16 v[116:119], v[28:31], v[136:143], v1
    buffer_load_dwordx4 v[248:251], v2, s[8:11], s36 offen offset:0 sc1
    v_smfmac_f32_16x16x64_bf16 v[112:115], v[36:39], v[160:167], v1
    s_waitcnt lgkmcnt(0)
    s_barrier
    ds_read_b128 v[80:83], v11 offset:24576
    v_smfmac_f32_16x16x64_bf16 v[116:119], v[36:39], v[168:175], v1
    buffer_load_dwordx4 v[252:255], v2, s[8:11], s36 offen offset:1024 sc1
    s_add_u32 s36, s36, 524288
    ds_read_b128 v[84:87], v11 offset:24640
    v_mov_b32 v120, 0x3f803f80
    v_smfmac_f32_16x16x64_bf16 v[112:115], v[40:43], v[176:183], v1
    ds_read_b128 v[88:91], v11 offset:24704
    v_mov_b32 v121, 0x3f803f80
    v_smfmac_f32_16x16x64_bf16 v[116:119], v[40:43], v[184:191], v1
    ds_read_b128 v[92:95], v11 offset:24768
    v_mov_b32 v122, 0x3f803f80
    v_smfmac_f32_16x16x64_bf16 v[112:115], v[44:47], v[192:199], v1
    ds_read_b128 v[48:51], v11 offset:24832
    v_mov_b32 v123, 0x3f803f80
    v_smfmac_f32_16x16x64_bf16 v[116:119], v[44:47], v[200:207], v1
    ds_read_b128 v[56:59], v11 offset:24960
    ds_read_b128 v[52:55], v11 offset:24896
    s_waitcnt lgkmcnt(5)
    v_mfma_f32_16x16x32_bf16 v[20:23], v[96:99], v[80:83], 0
    ds_read_b128 v[60:63], v11 offset:25024
    v_mov_b64 v[46:47], 0
    v_mfma_f32_16x16x32_bf16 v[24:27], v[64:67], v[80:83], 0
    v_add_f32 v112, v112, v114
    v_add_f32 v113, v113, v115
    v_mfma_f32_16x16x32_bf16 v[20:23], v[100:103], v[84:87], v[20:23]
    v_cvt_pk_bf16_f32 v124, v112, v113
    v_add_f32 v116, v116, v118
    v_mfma_f32_16x16x32_bf16 v[24:27], v[68:71], v[84:87], v[24:27]
    s_waitcnt lgkmcnt(4)
    v_add_f32 v117, v117, v119
    v_mfma_f32_16x16x32_bf16 v[20:23], v[104:107], v[88:91], v[20:23]
    ds_read_b128 v[96:99], v4 offset:57344
    v_cvt_pk_bf16_f32 v126, v116, v117
    v_mfma_f32_16x16x32_bf16 v[24:27], v[72:75], v[88:91], v[24:27]
    ds_read_b128 v[100:103], v4 offset:61440
    v_mov_b64 v[42:43], 0
    v_mfma_f32_16x16x32_bf16 v[20:23], v[108:111], v[92:95], v[20:23]
    ds_read_b128 v[64:67], v4 offset:16384
    v_mov_b64 v[44:45], 0
    v_mfma_f32_16x16x32_bf16 v[24:27], v[76:79], v[92:95], v[24:27]
    s_waitcnt lgkmcnt(3)
    ds_read_b128 v[68:71], v4 offset:20480
    v_mfma_f32_16x16x32_bf16 v[28:31], v[48:51], v[80:83], 0
    ds_read_b128 v[104:107], v4 offset:24576
    v_max3_f32 v0, v20, v21, v22
    v_mfma_f32_16x16x32_bf16 v[28:31], v[52:55], v[84:87], v[28:31]
    v_max3_f32 v0, v0, v23, v24
    v_max3_f32 v0, v0, v25, v26
    v_mfma_f32_16x16x32_bf16 v[28:31], v[56:59], v[88:91], v[28:31]
    ds_read_b128 v[108:111], v4 offset:28672
    v_max_f32 v0, v0, v27
    v_mov_b32 v15, v0
    v_mfma_f32_16x16x32_bf16 v[28:31], v[60:63], v[92:95], v[28:31]
    ds_read_b128 v[112:115], v4 offset:40960
    v_permlane32_swap_b32 v0, v15
    v_max_f32 v0, v0, v15
    ds_read_b128 v[116:119], v4 offset:45056
    v_mov_b64 v[36:37], 0
    v_mov_b64 v[38:39], 0
    ds_read_b128 v[72:75], v4 offset:32768
    s_nop 0
    v_max3_f32 v0, v0, v28, v29
    v_max3_f32 v0, v0, v30, v31
    v_mov_b32 v30, v0
    ds_read_b128 v[76:79], v4 offset:36864
    v_mov_b64 v[40:41], 0
    v_permlane16_swap_b32 v0, v30
    v_max_f32 v0, v0, v30
    v_mul_f32 v30, s38, v0
    v_pk_fma_f32 v[28:29], v[28:29], s[38:39], v[30:31] op_sel_hi:[1,0,0] neg_lo:[0,0,1] neg_hi:[0,0,1]
    v_pk_fma_f32 v[20:21], v[20:21], s[38:39], v[30:31] op_sel_hi:[1,0,0] neg_lo:[0,0,1] neg_hi:[0,0,1]
    v_pk_fma_f32 v[22:23], v[22:23], s[38:39], v[30:31] op_sel_hi:[1,0,0] neg_lo:[0,0,1] neg_hi:[0,0,1]
    v_pk_fma_f32 v[24:25], v[24:25], s[38:39], v[30:31] op_sel_hi:[1,0,0] neg_lo:[0,0,1] neg_hi:[0,0,1]
    v_pk_fma_f32 v[26:27], v[26:27], s[38:39], v[30:31] op_sel_hi:[1,0,0] neg_lo:[0,0,1] neg_hi:[0,0,1]
    v_exp_f32 v28, v28
    v_exp_f32 v29, v29
    v_exp_f32 v20, v20
    v_cvt_pk_bf16_f32 v28, v28, v29
    v_mov_b32 v29, 0
    v_exp_f32 v21, v21
    v_exp_f32 v22, v22
    v_mfma_f32_16x16x16_bf16 v[88:91], v[120:121], v[28:29], 0
    v_exp_f32 v23, v23
    v_cvt_pk_bf16_f32 v20, v20, v21
    v_mfma_f32_16x16x16_bf16 v[80:83], v[124:125], v[28:29], 0
    v_exp_f32 v24, v24
    v_exp_f32 v25, v25
    v_mfma_f32_16x16x16_bf16 v[84:87], v[126:127], v[28:29], 0
    v_exp_f32 v26, v26
    v_exp_f32 v27, v27
    v_cvt_pk_bf16_f32 v21, v22, v23
    v_cvt_pk_bf16_f32 v22, v24, v25
    v_cvt_pk_bf16_f32 v23, v26, v27
    s_waitcnt vmcnt(3)
    s_nop 0
    v_mfma_f32_16x16x32_bf16 v[88:91], v[120:123], v[20:23], v[88:91]
    v_mov_b64 v[24:25], 0
    v_mfma_f32_16x16x32_bf16 v[80:83], v[16:19], v[20:23], v[80:83]
    v_mov_b64 v[26:27], 0
    v_mov_b64 v[28:29], 0
    v_mfma_f32_16x16x32_bf16 v[84:87], v[32:35], v[20:23], v[84:87]
    v_mov_b64 v[30:31], 0
    v_rcp_f32 v0, v88
    v_mov_b64 v[16:17], 0
    s_nop 0
    v_cndmask_b32 v80, v80, v82, s[66:67]
    v_cndmask_b32 v81, v81, v83, s[66:67]
    v_mul_f32 v80, v80, v0
    v_mul_f32 v81, v81, v0
    v_cndmask_b32 v84, v84, v86, s[66:67]
    v_cndmask_b32 v85, v85, v87, s[66:67]
    v_pk_mul_f32 v[84:85], v[84:85], v[0:1] op_sel_hi:[1,0]
    v_cvt_pk_bf16_f32 v80, v80, v84
    v_cvt_pk_bf16_f32 v81, v81, v85
    ds_write_b64 v12, v[80:81] offset:29184
    v_mov_b64 v[18:19], 0
    v_mov_b64 v[20:21], 0
    s_waitcnt lgkmcnt(0)
    s_barrier
    ds_read_b128 v[48:51], v13 offset:29184
    ds_read_b128 v[52:55], v13 offset:29312
    v_mov_b64 v[22:23], 0
    v_mov_b64 v[32:33], 0
    v_mov_b64 v[34:35], 0
    s_cmp_lg_u32 s64, 0
    s_cbranch_scc1 L_kfgo_1
L_nokf_1:
    s_waitcnt lgkmcnt(1)
    v_smfmac_f32_16x16x64_bf16 v[16:19], v[48:51], v[64:71], v1
    s_waitcnt lgkmcnt(0)
    ds_read_b128 v[56:59], v4 offset:49152
    v_smfmac_f32_16x16x64_bf16 v[16:19], v[52:55], v[104:111], v1
    ds_read_b128 v[60:63], v4 offset:53248
    v_smfmac_f32_16x16x64_bf16 v[20:23], v[48:51], v[72:79], v1
    ds_read_b128 v[88:91], v5 offset:0
    v_smfmac_f32_16x16x64_bf16 v[20:23], v[52:55], v[208:215], v1
    ds_read_b128 v[92:95], v5 offset:4096
    v_add_f32 v16, v16, v18
    v_smfmac_f32_16x16x64_bf16 v[24:27], v[48:51], v[112:119], v1
    ds_read_b128 v[64:67], v5 offset:8192
    v_add_f32 v17, v17, v19
    v_smfmac_f32_16x16x64_bf16 v[24:27], v[52:55], v[216:223], v1
    s_waitcnt lgkmcnt(3)
    ds_read_b128 v[68:71], v5 offset:12288
    v_add_f32 v20, v20, v22
    v_smfmac_f32_16x16x64_bf16 v[28:31], v[48:51], v[56:63], v1
    ds_read_b128 v[104:107], v5 offset:16384
    v_add_f32 v21, v21, v23
    v_smfmac_f32_16x16x64_bf16 v[28:31], v[52:55], v[224:231], v1
    ds_read_b128 v[108:111], v5 offset:20480
    v_cvt_pk_bf16_f32 v80, v16, v20
    v_cvt_pk_bf16_f32 v82, v17, v21
    v_smfmac_f32_16x16x64_bf16 v[32:35], v[48:51], v[96:103], v1
    ds_read_b128 v[112:115], v3 offset:16384
    v_add_f32 v24, v24, v26
    v_add_f32 v25, v25, v27
    v_smfmac_f32_16x16x64_bf16 v[32:35], v[52:55], v[232:239], v1
    s_waitcnt lgkmcnt(3)
    ds_read_b128 v[116:119], v3 offset:20480
    v_add_f32 v28, v28, v30
    v_add_f32 v29, v29, v31
    v_smfmac_f32_16x16x64_bf16 v[36:39], v[48:51], v[88:95], v1
    ds_read_b128 v[72:75], v5 offset:24576
    v_cvt_pk_bf16_f32 v81, v24, v28
    v_cvt_pk_bf16_f32 v83, v25, v29
    v_smfmac_f32_16x16x64_bf16 v[36:39], v[52:55], v[240:247], v1
    buffer_store_dwordx4 v[80:83], v9, s[8:11], s30 offen
    ds_read_b128 v[76:79], v5 offset:28672
    v_add_f32 v32, v32, v34
    v_smfmac_f32_16x16x64_bf16 v[40:43], v[48:51], v[64:71], v1
    s_waitcnt lgkmcnt(4)
    v_add_f32 v33, v33, v35
    v_smfmac_f32_16x16x64_bf16 v[40:43], v[52:55], v[104:111], v1
    s_waitcnt lgkmcnt(2)
    v_add_f32 v36, v36, v38
    v_smfmac_f32_16x16x64_bf16 v[44:47], v[48:51], v[112:119], v1
    s_waitcnt lgkmcnt(0)
    v_add_f32 v37, v37, v39
    v_smfmac_f32_16x16x64_bf16 v[44:47], v[52:55], v[72:79], v1
    v_cvt_pk_bf16_f32 v84, v32, v36
    v_cvt_pk_bf16_f32 v86, v33, v37
    v_add_f32 v40, v40, v42
    v_add_f32 v41, v41, v43
    s_nop 3
    v_add_f32 v44, v44, v46
    v_add_f32 v45, v45, v47
    v_cvt_pk_bf16_f32 v85, v40, v44
    v_cvt_pk_bf16_f32 v87, v41, v45
    buffer_store_dwordx4 v[84:87], v9, s[8:11], s31 offen
    s_barrier
    ds_read_b128 v[44:47], v2 offset:31744
    s_xor_b32 s30, s30, 262144
    s_xor_b32 s31, s31, 262144
    ds_read_b128 v[64:67], v3 offset:32768
    ds_read_b128 v[68:71], v3 offset:36864
    s_bitcmp1_b32 s21, 0
    s_cbranch_scc1 L_tailB_1
    ds_read_b128 v[72:75], v3 offset:40960
    ds_read_b128 v[76:79], v3 offset:45056
    ds_read_b128 v[96:99], v3 offset:49152
    ds_read_b128 v[100:103], v3 offset:53248
    s_nop 15
    s_nop 7
    buffer_load_dwordx4 v[36:39], v2, s[8:11], s100 offen offset:0 sc1
    buffer_load_dwordx4 v[40:43], v2, s[8:11], s100 offen offset:1024 sc1
    ds_read_b128 v[104:107], v3 offset:57344
    ds_read_b128 v[108:111], v3 offset:61440
    ds_read_b128 v[88:91], v4 offset:8192
    ds_read_b128 v[92:95], v4 offset:12288
    ds_read_b128 v[80:83], v4 offset:0
    ds_read_b128 v[84:87], v4 offset:4096
    s_nop 3
    buffer_load_dwordx4 v[36:39], v2, s[8:11], s100 offen offset:0 sc1
    buffer_load_dwordx4 v[40:43], v2, s[8:11], s100 offen offset:1024 sc1
    s_waitcnt vmcnt(6)
    v_add_u32 v0, s41, v2
    ds_write_b128 v0, v[248:251]
    ds_write_b128 v0, v[252:255] offset:1024
    s_waitcnt lgkmcnt(2)
L_pipe20_1:
    s_waitcnt vmcnt(3)
    v_max3_u32 v0, v36, v37, 0
    v_max3_u32 v0, v38, v39, v0
    v_mfma_f32_16x16x32_bf16 v[28:31], v[44:47], v[36:39], 0
    s_waitcnt vmcnt(2)
    v_max3_u32 v0, v40, v41, v0
    v_max3_u32 v0, v42, v43, v0
    v_mfma_f32_16x16x32_bf16 v[28:31], v[44:47], v[40:43], v[28:31]
    v_cmp_eq_u32 vcc, -1, v0
    s_nop 5
    s_cbranch_vccnz L_retryp0_1
    v_add_f32_dpp v28, v28, v28 row_ror:4 row_mask:0xf bank_mask:0xf
    v_add_f32_dpp v29, v29, v29 row_ror:4 row_mask:0xf bank_mask:0xf
    s_nop 0
    v_add_f32_dpp v28, v28, v28 row_ror:8 row_mask:0xf bank_mask:0xf
    v_add_f32_dpp v29, v29, v29 row_ror:8 row_mask:0xf bank_mask:0xf
    v_cvt_pk_bf16_f32 v15, v28, v29
    v_min_u32 v15, 0xfffffffe, v15
    buffer_store_dword v15, v14, s[8:11], s46 offen
    s_branch L_tailj_1
L_tailB_1:
    ds_read_b128 v[72:75], v3 offset:40960
    ds_read_b128 v[76:79], v3 offset:45056
    ds_read_b128 v[96:99], v3 offset:49152
    ds_read_b128 v[100:103], v3 offset:53248
    ds_read_b128 v[104:107], v3 offset:57344
    ds_read_b128 v[108:111], v3 offset:61440
    ds_read_b128 v[88:91], v4 offset:8192
    ds_read_b128 v[92:95], v4 offset:12288
    s_nop 15
    buffer_load_dwordx4 v[36:39], v2, s[8:11], s100 offen offset:0 sc1
    buffer_load_dwordx4 v[40:43], v2, s[8:11], s100 offen offset:1024 sc1
    ds_read_b128 v[80:83], v4 offset:0
    ds_read_b128 v[84:87], v4 offset:4096
    s_nop 11
    buffer_load_dwordx4 v[36:39], v2, s[8:11], s100 offen offset:0 sc1
    buffer_load_dwordx4 v[40:43], v2, s[8:11], s100 offen offset:1024 sc1
    s_waitcnt vmcnt(6)
    v_add_u32 v0, s41, v2
    ds_write_b128 v0, v[248:251]
    ds_write_b128 v0, v[252:255] offset:1024
    s_waitcnt lgkmcnt(2)
L_pipe21_1:
    s_waitcnt vmcnt(3)
    v_max3_u32 v0, v36, v37, 0
    v_max3_u32 v0, v38, v39, v0
    v_mfma_f32_16x16x32_bf16 v[28:31], v[44:47], v[36:39], 0
    s_waitcnt vmcnt(2)
    v_max3_u32 v0, v40, v41, v0
    v_max3_u32 v0, v42, v43, v0
    v_mfma_f32_16x16x32_bf16 v[28:31], v[44:47], v[40:43], v[28:31]
    v_cmp_eq_u32 vcc, -1, v0
    s_nop 5
    s_cbranch_vccnz L_retryp1_1
    v_add_f32_dpp v28, v28, v28 row_ror:4 row_mask:0xf bank_mask:0xf
    v_add_f32_dpp v29, v29, v29 row_ror:4 row_mask:0xf bank_mask:0xf
    s_nop 0
    v_add_f32_dpp v28, v28, v28 row_ror:8 row_mask:0xf bank_mask:0xf
    v_add_f32_dpp v29, v29, v29 row_ror:8 row_mask:0xf bank_mask:0xf
    v_cvt_pk_bf16_f32 v15, v28, v29
    v_min_u32 v15, 0xfffffffe, v15
    buffer_store_dword v15, v14, s[8:11], s46 offen
L_tailj_1:
    s_barrier
    s_branch L_step_0
L_retryA_0:
    s_mov_b64 exec, vcc
    buffer_load_dwordx4 v[16:19], v3, s[8:11], s28 offen sc1
    buffer_load_dwordx4 v[32:35], v3, s[8:11], s29 offen sc1
    s_mov_b64 exec, -1
    s_add_u32 s48, s48, 1
    s_add_u32 s26, s26, 1
    s_cmp_gt_u32 s26, 400000
    s_cbranch_scc1 L_team_end
L_rA2_0:
    s_nop 6
    v_mov_b64 v[48:49], 0
    v_mov_b64 v[50:51], 0
    v_mov_b64 v[52:53], 0
    v_mov_b64 v[54:55], 0
    v_mov_b64 v[56:57], 0
    v_mov_b64 v[58:59], 0
    v_mov_b64 v[60:61], 0
    v_mov_b64 v[62:63], 0
    s_waitcnt vmcnt(6)
    s_branch L_pollA2_0
L_retryp0_0:
    s_mov_b64 exec, vcc
    buffer_load_dwordx4 v[36:39], v2, s[8:11], s100 offen offset:0 sc1
    buffer_load_dwordx4 v[40:43], v2, s[8:11], s100 offen offset:1024 sc1
    s_mov_b64 exec, -1
    s_add_u32 s50, s50, 1
    s_add_u32 s26, s26, 1
    s_cmp_gt_u32 s26, 400000
    s_cbranch_scc1 L_team_end
    s_branch L_pipe20_0
L_retryp1_0:
    s_mov_b64 exec, vcc
    buffer_load_dwordx4 v[36:39], v2, s[8:11], s100 offen offset:0 sc1
    buffer_load_dwordx4 v[40:43], v2, s[8:11], s100 offen offset:1024 sc1
    s_mov_b64 exec, -1
    s_add_u32 s50, s50, 1
    s_add_u32 s26, s26, 1
    s_cmp_gt_u32 s26, 400000
    s_cbranch_scc1 L_team_end
    s_branch L_pipe21_0
L_kfgo_0:
    s_min_u32 s51, s51, 64
    s_lshl_b32 s25, s51, 8
    v_lshlrev_b32 v126, 4, v2
    s_add_u32 s25, s25, 1179648
    s_mov_b64 exec, 0xffff
    buffer_load_dword v124, v126, s[8:11], s25 offen sc1
    s_mov_b64 exec, -1
    s_branch L_nokf_0
L_kvw_0:
    v_lshlrev_b32 v0, 4, v2
    s_mov_b32 s25, 1179648
    buffer_load_dword v124, v0, s[8:11], s25 offen sc1
    s_waitcnt vmcnt(0)
    v_cmp_eq_u32 vcc, 32, v124
    s_ff0_i32_b64 s51, vcc
    s_add_u32 s26, s26, 1
    s_cmp_gt_u32 s26, 400000
    s_cbranch_scc1 L_team_end
    s_cmp_gt_u32 s51, s24
    s_cbranch_scc0 L_kvw_0
    s_branch L_kvok_0
L_retryA_1:
    s_mov_b64 exec, vcc
    buffer_load_dwordx4 v[16:19], v3, s[8:11], s28 offen sc1
    buffer_load_dwordx4 v[32:35], v3, s[8:11], s29 offen sc1
    s_mov_b64 exec, -1
    s_add_u32 s48, s48, 1
    s_add_u32 s26, s26, 1
    s_cmp_gt_u32 s26, 400000
    s_cbranch_scc1 L_team_end
L_rA2_1:
    s_nop 6
    v_mov_b64 v[48:49], 0
    v_mov_b64 v[50:51], 0
    v_mov_b64 v[52:53], 0
    v_mov_b64 v[54:55], 0
    v_mov_b64 v[56:57], 0
    v_mov_b64 v[58:59], 0
    v_mov_b64 v[60:61], 0
    v_mov_b64 v[62:63], 0
    s_waitcnt vmcnt(6)
    s_branch L_pollA2_1
L_retryp0_1:
    s_mov_b64 exec, vcc
    buffer_load_dwordx4 v[36:39], v2, s[8:11], s100 offen offset:0 sc1
    buffer_load_dwordx4 v[40:43], v2, s[8:11], s100 offen offset:1024 sc1
    s_mov_b64 exec, -1
    s_add_u32 s50, s50, 1
    s_add_u32 s26, s26, 1
    s_cmp_gt_u32 s26, 400000
    s_cbranch_scc1 L_team_end
    s_branch L_pipe20_1
L_retryp1_1:
    s_mov_b64 exec, vcc
    buffer_load_dwordx4 v[36:39], v2, s[8:11], s100 offen offset:0 sc1
    buffer_load_dwordx4 v[40:43], v2, s[8:11], s100 offen offset:1024 sc1
    s_mov_b64 exec, -1
    s_add_u32 s50, s50, 1
    s_add_u32 s26, s26, 1
    s_cmp_gt_u32 s26, 400000
    s_cbranch_scc1 L_team_end
    s_branch L_pipe21_1
L_kfgo_1:
    s_min_u32 s51, s51, 64
    s_lshl_b32 s25, s51, 8
    v_lshlrev_b32 v126, 4, v2
    s_add_u32 s25, s25, 1179648
    s_mov_b64 exec, 0xffff
    buffer_load_dword v124, v126, s[8:11], s25 offen sc1
    s_mov_b64 exec, -1
    s_branch L_nokf_1
L_kvw_1:
    v_lshlrev_b32 v0, 4, v2
    s_mov_b32 s25, 1179648
    buffer_load_dword v124, v0, s[8:11], s25 offen sc1
    s_waitcnt vmcnt(0)
    v_cmp_eq_u32 vcc, 32, v124
    s_ff0_i32_b64 s51, vcc
    s_add_u32 s26, s26, 1
    s_cmp_gt_u32 s26, 400000
    s_cbranch_scc1 L_team_end
    s_cmp_gt_u32 s51, s24
    s_cbranch_scc0 L_kvw_1
    s_branch L_kvok_1
L_last:
    buffer_store_dword v15, v14, s[8:11], s37 offen sc1
    s_waitcnt vmcnt(0) lgkmcnt(0)
L_team_end:
    s_waitcnt vmcnt(0)
L_end0:
    s_endpgm
L_worker:
    s_sub_u32 s24, s23, 32
    s_cmp_ge_u32 s24, 224
    s_cbranch_scc1 L_end
    v_and_b32 v5, 63, v0
    v_and_b32 v3, 15, v0
    v_lshrrev_b32 v4, 4, v5
    v_lshlrev_b32 v1, 4, v5
    v_lshlrev_b32 v2, 4, v0
    s_mov_b32 s39, 0x05040100
    s_mov_b32 s40, 0x07060302
    s_mov_b32 s26, 0
    s_waitcnt lgkmcnt(0)
    s_mov_b32 s44, s76
    s_and_b32 s45, s77, 0xffff
    s_mov_b32 s46, 0x200000
    s_mov_b32 s47, 0x00020000
    s_mov_b32 s48, s70
    s_and_b32 s49, s71, 0xffff
    s_mov_b32 s50, 0x200000
    s_mov_b32 s51, 0x00020000
    s_cmp_ge_u32 s24, 144
    s_cbranch_scc1 L_orole
    s_cmp_ge_u32 s24, 128
    s_cbranch_scc1 L_mrole
    s_lshr_b32 s28, s24, 2
    s_and_b32 s29, s24, 3
    v_lshlrev_b32 v5, 16, v4
    v_lshl_add_u32 v5, v3, 2, v5
    s_lshl_b32 s25, s28, 8
    s_lshl_b32 s27, s21, 6
    s_add_u32 s25, s25, s27
    v_add_u32 v5, s25, v5
    v_lshlrev_b32 v6, 10, v3
    v_lshl_add_u32 v6, v4, 4, v6
    s_lshr_b32 s25, s21, 1
    s_lshl_b32 s25, s25, 14
    s_and_b32 s27, s21, 1
    s_lshl_b32 s27, s27, 9
    s_add_u32 s25, s25, s27
    v_add_u32 v6, s25, v6
    v_add_u32 v7, 16384, v1
    v_lshlrev_b32 v12, 13, v4
    v_lshl_add_u32 v12, v3, 4, v12
    s_lshl_b32 s25, s28, 8
    s_lshl_b32 s27, s21, 17
    s_add_u32 s25, s25, s27
    v_add_u32 v12, s25, v12
    v_lshlrev_b32 v13, 11, v4
    v_lshl_add_u32 v13, v3, 2, v13
    s_lshl_b32 s25, s21, 6
    s_add_u32 s25, s25, 81920
    v_add_u32 v13, s25, v13
    v_add_u32 v14, 49152, v13
    s_lshl_b32 s36, s21, 12
    s_add_u32 s36, s36, 81920
    s_mov_b32 s16, s82
    s_and_b32 s17, s83, 0xffff
    s_mov_b32 s18, 0x400000
    s_mov_b32 s19, 0x00020000
    s_add_u32 m0, s36, 0
    s_mov_b32 s25, 0
    buffer_load_dwordx4 v12, s[16:19], s25 offen lds
    s_add_u32 m0, s36, 1024
    s_mov_b32 s25, 32768
    buffer_load_dwordx4 v12, s[16:19], s25 offen lds
    s_add_u32 m0, s36, 2048
    s_mov_b32 s25, 65536
    buffer_load_dwordx4 v12, s[16:19], s25 offen lds
    s_add_u32 m0, s36, 3072
    s_mov_b32 s25, 98304
    buffer_load_dwordx4 v12, s[16:19], s25 offen lds
    s_add_u32 m0, s36, 16384
    s_mov_b32 s25, 524288
    buffer_load_dwordx4 v12, s[16:19], s25 offen lds
    s_add_u32 m0, s36, 17408
    s_mov_b32 s25, 557056
    buffer_load_dwordx4 v12, s[16:19], s25 offen lds
    s_add_u32 m0, s36, 18432
    s_mov_b32 s25, 589824
    buffer_load_dwordx4 v12, s[16:19], s25 offen lds
    s_add_u32 m0, s36, 19456
    s_mov_b32 s25, 622592
    buffer_load_dwordx4 v12, s[16:19], s25 offen lds
    s_add_u32 m0, s36, 32768
    s_mov_b32 s25, 1048576
    buffer_load_dwordx4 v12, s[16:19], s25 offen lds
    s_add_u32 m0, s36, 33792
    s_mov_b32 s25, 1081344
    buffer_load_dwordx4 v12, s[16:19], s25 offen lds
    s_add_u32 m0, s36, 34816
    s_mov_b32 s25, 1114112
    buffer_load_dwordx4 v12, s[16:19], s25 offen lds
    s_add_u32 m0, s36, 35840
    s_mov_b32 s25, 1146880
    buffer_load_dwordx4 v12, s[16:19], s25 offen lds
    s_add_u32 m0, s36, 49152
    s_mov_b32 s25, 1572864
    buffer_load_dwordx4 v12, s[16:19], s25 offen lds
    s_add_u32 m0, s36, 50176
    s_mov_b32 s25, 1605632
    buffer_load_dwordx4 v12, s[16:19], s25 offen lds
    s_add_u32 m0, s36, 51200
    s_mov_b32 s25, 1638400
    buffer_load_dwordx4 v12, s[16:19], s25 offen lds
    s_add_u32 m0, s36, 52224
    s_mov_b32 s25, 1671168
    buffer_load_dwordx4 v12, s[16:19], s25 offen lds
    s_waitcnt vmcnt(12)
    s_barrier
    s_add_u32 m0, s36, 65536
    s_mov_b32 s25, 2097152
    buffer_load_dwordx4 v12, s[16:19], s25 offen lds
    s_add_u32 m0, s36, 66560
    s_mov_b32 s25, 2129920
    buffer_load_dwordx4 v12, s[16:19], s25 offen lds
    s_add_u32 m0, s36, 67584
    s_mov_b32 s25, 2162688
    buffer_load_dwordx4 v12, s[16:19], s25 offen lds
    s_add_u32 m0, s36, 68608
    s_mov_b32 s25, 2195456
    buffer_load_dwordx4 v12, s[16:19], s25 offen lds
    ds_read2st64_b32 v[16:17], v13 offset0:0 offset1:1
    ds_read2st64_b32 v[18:19], v13 offset0:2 offset1:3
    ds_read2st64_b32 v[20:21], v13 offset0:4 offset1:5
    ds_read2st64_b32 v[22:23], v13 offset0:6 offset1:7
    ds_read2st64_b32 v[24:25], v13 offset0:32 offset1:33
    ds_read2st64_b32 v[26:27], v13 offset0:34 offset1:35
    ds_read2st64_b32 v[28:29], v13 offset0:36 offset1:37
    ds_read2st64_b32 v[30:31], v13 offset0:38 offset1:39
    s_waitcnt lgkmcnt(6)
    v_perm_b32 v32, v17, v16, s39
    v_accvgpr_write_b32 a0, v32
    v_perm_b32 v33, v17, v16, s40
    v_accvgpr_write_b32 a4, v33
    v_perm_b32 v32, v19, v18, s39
    v_accvgpr_write_b32 a1, v32
    v_perm_b32 v33, v19, v18, s40
    v_accvgpr_write_b32 a5, v33
    s_waitcnt lgkmcnt(4)
    v_perm_b32 v32, v21, v20, s39
    v_accvgpr_write_b32 a2, v32
    v_perm_b32 v33, v21, v20, s40
    v_accvgpr_write_b32 a6, v33
    v_perm_b32 v32, v23, v22, s39
    v_accvgpr_write_b32 a3, v32
    v_perm_b32 v33, v23, v22, s40
    v_accvgpr_write_b32 a7, v33
    s_waitcnt lgkmcnt(2)
    v_perm_b32 v32, v25, v24, s39
    v_accvgpr_write_b32 a8, v32
    v_perm_b32 v33, v25, v24, s40
    v_accvgpr_write_b32 a12, v33
    v_perm_b32 v32, v27, v26, s39
    v_accvgpr_write_b32 a9, v32
    v_perm_b32 v33, v27, v26, s40
    v_accvgpr_write_b32 a13, v33
    s_waitcnt lgkmcnt(0)
    v_perm_b32 v32, v29, v28, s39
    v_accvgpr_write_b32 a10, v32
    v_perm_b32 v33, v29, v28, s40
    v_accvgpr_write_b32 a14, v33
    v_perm_b32 v32, v31, v30, s39
    v_accvgpr_write_b32 a11, v32
    v_perm_b32 v33, v31, v30, s40
    v_accvgpr_write_b32 a15, v33
    s_waitcnt vmcnt(12)
    s_barrier
    s_add_u32 m0, s36, 0
    s_mov_b32 s25, 2621440
    buffer_load_dwordx4 v12, s[16:19], s25 offen lds
    s_add_u32 m0, s36, 1024
    s_mov_b32 s25, 2654208
    buffer_load_dwordx4 v12, s[16:19], s25 offen lds
    s_add_u32 m0, s36, 2048
    s_mov_b32 s25, 2686976
    buffer_load_dwordx4 v12, s[16:19], s25 offen lds
    s_add_u32 m0, s36, 3072
    s_mov_b32 s25, 2719744
    buffer_load_dwordx4 v12, s[16:19], s25 offen lds
    ds_read2st64_b32 v[16:17], v13 offset0:64 offset1:65
    ds_read2st64_b32 v[18:19], v13 offset0:66 offset1:67
    ds_read2st64_b32 v[20:21], v13 offset0:68 offset1:69
    ds_read2st64_b32 v[22:23], v13 offset0:70 offset1:71
    ds_read2st64_b32 v[24:25], v13 offset0:96 offset1:97
    ds_read2st64_b32 v[26:27], v13 offset0:98 offset1:99
    ds_read2st64_b32 v[28:29], v13 offset0:100 offset1:101
    ds_read2st64_b32 v[30:31], v13 offset0:102 offset1:103
    s_waitcnt lgkmcnt(6)
    v_perm_b32 v32, v17, v16, s39
    v_accvgpr_write_b32 a16, v32
    v_perm_b32 v33, v17, v16, s40
    v_accvgpr_write_b32 a20, v33
    v_perm_b32 v32, v19, v18, s39
    v_accvgpr_write_b32 a17, v32
    v_perm_b32 v33, v19, v18, s40
    v_accvgpr_write_b32 a21, v33
    s_waitcnt lgkmcnt(4)
    v_perm_b32 v32, v21, v20, s39
    v_accvgpr_write_b32 a18, v32
    v_perm_b32 v33, v21, v20, s40
    v_accvgpr_write_b32 a22, v33
    v_perm_b32 v32, v23, v22, s39
    v_accvgpr_write_b32 a19, v32
    v_perm_b32 v33, v23, v22, s40
    v_accvgpr_write_b32 a23, v33
    s_waitcnt lgkmcnt(2)
    v_perm_b32 v32, v25, v24, s39
    v_accvgpr_write_b32 a24, v32
    v_perm_b32 v33, v25, v24, s40
    v_accvgpr_write_b32 a28, v33
    v_perm_b32 v32, v27, v26, s39
    v_accvgpr_write_b32 a25, v32
    v_perm_b32 v33, v27, v26, s40
    v_accvgpr_write_b32 a29, v33
    s_waitcnt lgkmcnt(0)
    v_perm_b32 v32, v29, v28, s39
    v_accvgpr_write_b32 a26, v32
    v_perm_b32 v33, v29, v28, s40
    v_accvgpr_write_b32 a30, v33
    v_perm_b32 v32, v31, v30, s39
    v_accvgpr_write_b32 a27, v32
    v_perm_b32 v33, v31, v30, s40
    v_accvgpr_write_b32 a31, v33
    s_waitcnt vmcnt(12)
    s_barrier
    s_add_u32 m0, s36, 16384
    s_mov_b32 s25, 3145728
    buffer_load_dwordx4 v12, s[16:19], s25 offen lds
    s_add_u32 m0, s36, 17408
    s_mov_b32 s25, 3178496
    buffer_load_dwordx4 v12, s[16:19], s25 offen lds
    s_add_u32 m0, s36, 18432
    s_mov_b32 s25, 3211264
    buffer_load_dwordx4 v12, s[16:19], s25 offen lds
    s_add_u32 m0, s36, 19456
    s_mov_b32 s25, 3244032
    buffer_load_dwordx4 v12, s[16:19], s25 offen lds
    ds_read2st64_b32 v[16:17], v13 offset0:128 offset1:129
    ds_read2st64_b32 v[18:19], v13 offset0:130 offset1:131
    ds_read2st64_b32 v[20:21], v13 offset0:132 offset1:133
    ds_read2st64_b32 v[22:23], v13 offset0:134 offset1:135
    ds_read2st64_b32 v[24:25], v13 offset0:160 offset1:161
    ds_read2st64_b32 v[26:27], v13 offset0:162 offset1:163
    ds_read2st64_b32 v[28:29], v13 offset0:164 offset1:165
    ds_read2st64_b32 v[30:31], v13 offset0:166 offset1:167
    s_waitcnt lgkmcnt(6)
    v_perm_b32 v32, v17, v16, s39
    v_accvgpr_write_b32 a32, v32
    v_perm_b32 v33, v17, v16, s40
    v_accvgpr_write_b32 a36, v33
    v_perm_b32 v32, v19, v18, s39
    v_accvgpr_write_b32 a33, v32
    v_perm_b32 v33, v19, v18, s40
    v_accvgpr_write_b32 a37, v33
    s_waitcnt lgkmcnt(4)
    v_perm_b32 v32, v21, v20, s39
    v_accvgpr_write_b32 a34, v32
    v_perm_b32 v33, v21, v20, s40
    v_accvgpr_write_b32 a38, v33
    v_perm_b32 v32, v23, v22, s39
    v_accvgpr_write_b32 a35, v32
    v_perm_b32 v33, v23, v22, s40
    v_accvgpr_write_b32 a39, v33
    s_waitcnt lgkmcnt(2)
    v_perm_b32 v32, v25, v24, s39
    v_accvgpr_write_b32 a40, v32
    v_perm_b32 v33, v25, v24, s40
    v_accvgpr_write_b32 a44, v33
    v_perm_b32 v32, v27, v26, s39
    v_accvgpr_write_b32 a41, v32
    v_perm_b32 v33, v27, v26, s40
    v_accvgpr_write_b32 a45, v33
    s_waitcnt lgkmcnt(0)
    v_perm_b32 v32, v29, v28, s39
    v_accvgpr_write_b32 a42, v32
    v_perm_b32 v33, v29, v28, s40
    v_accvgpr_write_b32 a46, v33
    v_perm_b32 v32, v31, v30, s39
    v_accvgpr_write_b32 a43, v32
    v_perm_b32 v33, v31, v30, s40
    v_accvgpr_write_b32 a47, v33
    s_waitcnt vmcnt(12)
    s_barrier
    s_add_u32 m0, s36, 32768
    s_mov_b32 s25, 3670016
    buffer_load_dwordx4 v12, s[16:19], s25 offen lds
    s_add_u32 m0, s36, 33792
    s_mov_b32 s25, 3702784
    buffer_load_dwordx4 v12, s[16:19], s25 offen lds
    s_add_u32 m0, s36, 34816
    s_mov_b32 s25, 3735552
    buffer_load_dwordx4 v12, s[16:19], s25 offen lds
    s_add_u32 m0, s36, 35840
    s_mov_b32 s25, 3768320
    buffer_load_dwordx4 v12, s[16:19], s25 offen lds
    ds_read2st64_b32 v[16:17], v14 offset0:0 offset1:1
    ds_read2st64_b32 v[18:19], v14 offset0:2 offset1:3
    ds_read2st64_b32 v[20:21], v14 offset0:4 offset1:5
    ds_read2st64_b32 v[22:23], v14 offset0:6 offset1:7
    ds_read2st64_b32 v[24:25], v14 offset0:32 offset1:33
    ds_read2st64_b32 v[26:27], v14 offset0:34 offset1:35
    ds_read2st64_b32 v[28:29], v14 offset0:36 offset1:37
    ds_read2st64_b32 v[30:31], v14 offset0:38 offset1:39
    s_waitcnt lgkmcnt(6)
    v_perm_b32 v32, v17, v16, s39
    v_accvgpr_write_b32 a48, v32
    v_perm_b32 v33, v17, v16, s40
    v_accvgpr_write_b32 a52, v33
    v_perm_b32 v32, v19, v18, s39
    v_accvgpr_write_b32 a49, v32
    v_perm_b32 v33, v19, v18, s40
    v_accvgpr_write_b32 a53, v33
    s_waitcnt lgkmcnt(4)
    v_perm_b32 v32, v21, v20, s39
    v_accvgpr_write_b32 a50, v32
    v_perm_b32 v33, v21, v20, s40
    v_accvgpr_write_b32 a54, v33
    v_perm_b32 v32, v23, v22, s39
    v_accvgpr_write_b32 a51, v32
    v_perm_b32 v33, v23, v22, s40
    v_accvgpr_write_b32 a55, v33
    s_waitcnt lgkmcnt(2)
    v_perm_b32 v32, v25, v24, s39
    v_accvgpr_write_b32 a56, v32
    v_perm_b32 v33, v25, v24, s40
    v_accvgpr_write_b32 a60, v33
    v_perm_b32 v32, v27, v26, s39
    v_accvgpr_write_b32 a57, v32
    v_perm_b32 v33, v27, v26, s40
    v_accvgpr_write_b32 a61, v33
    s_waitcnt lgkmcnt(0)
    v_perm_b32 v32, v29, v28, s39
    v_accvgpr_write_b32 a58, v32
    v_perm_b32 v33, v29, v28, s40
    v_accvgpr_write_b32 a62, v33
    v_perm_b32 v32, v31, v30, s39
    v_accvgpr_write_b32 a59, v32
    v_perm_b32 v33, v31, v30, s40
    v_accvgpr_write_b32 a63, v33
    s_waitcnt vmcnt(12)
    s_barrier
    s_mov_b32 s16, s84
    s_and_b32 s17, s85, 0xffff
    s_mov_b32 s18, 0x400000
    s_mov_b32 s19, 0x00020000
    s_add_u32 m0, s36, 49152
    s_mov_b32 s25, 0
    buffer_load_dwordx4 v12, s[16:19], s25 offen lds
    s_add_u32 m0, s36, 50176
    s_mov_b32 s25, 32768
    buffer_load_dwordx4 v12, s[16:19], s25 offen lds
    s_add_u32 m0, s36, 51200
    s_mov_b32 s25, 65536
    buffer_load_dwordx4 v12, s[16:19], s25 offen lds
    s_add_u32 m0, s36, 52224
    s_mov_b32 s25, 98304
    buffer_load_dwordx4 v12, s[16:19], s25 offen lds
    ds_read2st64_b32 v[16:17], v14 offset0:64 offset1:65
    ds_read2st64_b32 v[18:19], v14 offset0:66 offset1:67
    ds_read2st64_b32 v[20:21], v14 offset0:68 offset1:69
    ds_read2st64_b32 v[22:23], v14 offset0:70 offset1:71
    ds_read2st64_b32 v[24:25], v14 offset0:96 offset1:97
    ds_read2st64_b32 v[26:27], v14 offset0:98 offset1:99
    ds_read2st64_b32 v[28:29], v14 offset0:100 offset1:101
    ds_read2st64_b32 v[30:31], v14 offset0:102 offset1:103
    s_waitcnt lgkmcnt(6)
    v_perm_b32 v32, v17, v16, s39
    v_accvgpr_write_b32 a64, v32
    v_perm_b32 v33, v17, v16, s40
    v_accvgpr_write_b32 a68, v33
    v_perm_b32 v32, v19, v18, s39
    v_accvgpr_write_b32 a65, v32
    v_perm_b32 v33, v19, v18, s40
    v_accvgpr_write_b32 a69, v33
    s_waitcnt lgkmcnt(4)
    v_perm_b32 v32, v21, v20, s39
    v_accvgpr_write_b32 a66, v32
    v_perm_b32 v33, v21, v20, s40
    v_accvgpr_write_b32 a70, v33
    v_perm_b32 v32, v23, v22, s39
    v_accvgpr_write_b32 a67, v32
    v_perm_b32 v33, v23, v22, s40
    v_accvgpr_write_b32 a71, v33
    s_waitcnt lgkmcnt(2)
    v_perm_b32 v32, v25, v24, s39
    v_accvgpr_write_b32 a72, v32
    v_perm_b32 v33, v25, v24, s40
    v_accvgpr_write_b32 a76, v33
    v_perm_b32 v32, v27, v26, s39
    v_accvgpr_write_b32 a73, v32
    v_perm_b32 v33, v27, v26, s40
    v_accvgpr_write_b32 a77, v33
    s_waitcnt lgkmcnt(0)
    v_perm_b32 v32, v29, v28, s39
    v_accvgpr_write_b32 a74, v32
    v_perm_b32 v33, v29, v28, s40
    v_accvgpr_write_b32 a78, v33
    v_perm_b32 v32, v31, v30, s39
    v_accvgpr_write_b32 a75, v32
    v_perm_b32 v33, v31, v30, s40
    v_accvgpr_write_b32 a79, v33
    s_waitcnt vmcnt(12)
    s_barrier
    s_add_u32 m0, s36, 65536
    s_mov_b32 s25, 524288
    buffer_load_dwordx4 v12, s[16:19], s25 offen lds
    s_add_u32 m0, s36, 66560
    s_mov_b32 s25, 557056
    buffer_load_dwordx4 v12, s[16:19], s25 offen lds
    s_add_u32 m0, s36, 67584
    s_mov_b32 s25, 589824
    buffer_load_dwordx4 v12, s[16:19], s25 offen lds
    s_add_u32 m0, s36, 68608
    s_mov_b32 s25, 622592
    buffer_load_dwordx4 v12, s[16:19], s25 offen lds
    ds_read2st64_b32 v[16:17], v13 offset0:0 offset1:1
    ds_read2st64_b32 v[18:19], v13 offset0:2 offset1:3
    ds_read2st64_b32 v[20:21], v13 offset0:4 offset1:5
    ds_read2st64_b32 v[22:23], v13 offset0:6 offset1:7
    ds_read2st64_b32 v[24:25], v13 offset0:32 offset1:33
    ds_read2st64_b32 v[26:27], v13 offset0:34 offset1:35
    ds_read2st64_b32 v[28:29], v13 offset0:36 offset1:37
    ds_read2st64_b32 v[30:31], v13 offset0:38 offset1:39
    s_waitcnt lgkmcnt(6)
    v_perm_b32 v32, v17, v16, s39
    v_accvgpr_write_b32 a80, v32
    v_perm_b32 v33, v17, v16, s40
    v_accvgpr_write_b32 a84, v33
    v_perm_b32 v32, v19, v18, s39
    v_accvgpr_write_b32 a81, v32
    v_perm_b32 v33, v19, v18, s40
    v_accvgpr_write_b32 a85, v33
    s_waitcnt lgkmcnt(4)
    v_perm_b32 v32, v21, v20, s39
    v_accvgpr_write_b32 a82, v32
    v_perm_b32 v33, v21, v20, s40
    v_accvgpr_write_b32 a86, v33
    v_perm_b32 v32, v23, v22, s39
    v_accvgpr_write_b32 a83, v32
    v_perm_b32 v33, v23, v22, s40
    v_accvgpr_write_b32 a87, v33
    s_waitcnt lgkmcnt(2)
    v_perm_b32 v32, v25, v24, s39
    v_accvgpr_write_b32 a88, v32
    v_perm_b32 v33, v25, v24, s40
    v_accvgpr_write_b32 a92, v33
    v_perm_b32 v32, v27, v26, s39
    v_accvgpr_write_b32 a89, v32
    v_perm_b32 v33, v27, v26, s40
    v_accvgpr_write_b32 a93, v33
    s_waitcnt lgkmcnt(0)
    v_perm_b32 v32, v29, v28, s39
    v_accvgpr_write_b32 a90, v32
    v_perm_b32 v33, v29, v28, s40
    v_accvgpr_write_b32 a94, v33
    v_perm_b32 v32, v31, v30, s39
    v_accvgpr_write_b32 a91, v32
    v_perm_b32 v33, v31, v30, s40
    v_accvgpr_write_b32 a95, v33
    s_waitcnt vmcnt(12)
    s_barrier
    s_add_u32 m0, s36, 0
    s_mov_b32 s25, 1048576
    buffer_load_dwordx4 v12, s[16:19], s25 offen lds
    s_add_u32 m0, s36, 1024
    s_mov_b32 s25, 1081344
    buffer_load_dwordx4 v12, s[16:19], s25 offen lds
    s_add_u32 m0, s36, 2048
    s_mov_b32 s25, 1114112
    buffer_load_dwordx4 v12, s[16:19], s25 offen lds
    s_add_u32 m0, s36, 3072
    s_mov_b32 s25, 1146880
    buffer_load_dwordx4 v12, s[16:19], s25 offen lds
    ds_read2st64_b32 v[16:17], v13 offset0:64 offset1:65
    ds_read2st64_b32 v[18:19], v13 offset0:66 offset1:67
    ds_read2st64_b32 v[20:21], v13 offset0:68 offset1:69
    ds_read2st64_b32 v[22:23], v13 offset0:70 offset1:71
    ds_read2st64_b32 v[24:25], v13 offset0:96 offset1:97
    ds_read2st64_b32 v[26:27], v13 offset0:98 offset1:99
    ds_read2st64_b32 v[28:29], v13 offset0:100 offset1:101
    ds_read2st64_b32 v[30:31], v13 offset0:102 offset1:103
    s_waitcnt lgkmcnt(6)
    v_perm_b32 v32, v17, v16, s39
    v_accvgpr_write_b32 a96, v32
    v_perm_b32 v33, v17, v16, s40
    v_accvgpr_write_b32 a100, v33
    v_perm_b32 v32, v19, v18, s39
    v_accvgpr_write_b32 a97, v32
    v_perm_b32 v33, v19, v18, s40
    v_accvgpr_write_b32 a101, v33
    s_waitcnt lgkmcnt(4)
    v_perm_b32 v32, v21, v20, s39
    v_accvgpr_write_b32 a98, v32
    v_perm_b32 v33, v21, v20, s40
    v_accvgpr_write_b32 a102, v33
    v_perm_b32 v32, v23, v22, s39
    v_accvgpr_write_b32 a99, v32
    v_perm_b32 v33, v23, v22, s40
    v_accvgpr_write_b32 a103, v33
    s_waitcnt lgkmcnt(2)
    v_perm_b32 v32, v25, v24, s39
    v_accvgpr_write_b32 a104, v32
    v_perm_b32 v33, v25, v24, s40
    v_accvgpr_write_b32 a108, v33
    v_perm_b32 v32, v27, v26, s39
    v_accvgpr_write_b32 a105, v32
    v_perm_b32 v33, v27, v26, s40
    v_accvgpr_write_b32 a109, v33
    s_waitcnt lgkmcnt(0)
    v_perm_b32 v32, v29, v28, s39
    v_accvgpr_write_b32 a106, v32
    v_perm_b32 v33, v29, v28, s40
    v_accvgpr_write_b32 a110, v33
    v_perm_b32 v32, v31, v30, s39
    v_accvgpr_write_b32 a107, v32
    v_perm_b32 v33, v31, v30, s40
    v_accvgpr_write_b32 a111, v33
    s_waitcnt vmcnt(12)
    s_barrier
    s_add_u32 m0, s36, 16384
    s_mov_b32 s25, 1572864
    buffer_load_dwordx4 v12, s[16:19], s25 offen lds
    s_add_u32 m0, s36, 17408
    s_mov_b32 s25, 1605632
    buffer_load_dwordx4 v12, s[16:19], s25 offen lds
    s_add_u32 m0, s36, 18432
    s_mov_b32 s25, 1638400
    buffer_load_dwordx4 v12, s[16:19], s25 offen lds
    s_add_u32 m0, s36, 19456
    s_mov_b32 s25, 1671168
    buffer_load_dwordx4 v12, s[16:19], s25 offen lds
    ds_read2st64_b32 v[16:17], v13 offset0:128 offset1:129
    ds_read2st64_b32 v[18:19], v13 offset0:130 offset1:131
    ds_read2st64_b32 v[20:21], v13 offset0:132 offset1:133
    ds_read2st64_b32 v[22:23], v13 offset0:134 offset1:135
    ds_read2st64_b32 v[24:25], v13 offset0:160 offset1:161
    ds_read2st64_b32 v[26:27], v13 offset0:162 offset1:163
    ds_read2st64_b32 v[28:29], v13 offset0:164 offset1:165
    ds_read2st64_b32 v[30:31], v13 offset0:166 offset1:167
    s_waitcnt lgkmcnt(6)
    v_perm_b32 v32, v17, v16, s39
    v_accvgpr_write_b32 a112, v32
    v_perm_b32 v33, v17, v16, s40
    v_accvgpr_write_b32 a116, v33
    v_perm_b32 v32, v19, v18, s39
    v_accvgpr_write_b32 a113, v32
    v_perm_b32 v33, v19, v18, s40
    v_accvgpr_write_b32 a117, v33
    s_waitcnt lgkmcnt(4)
    v_perm_b32 v32, v21, v20, s39
    v_accvgpr_write_b32 a114, v32
    v_perm_b32 v33, v21, v20, s40
    v_accvgpr_write_b32 a118, v33
    v_perm_b32 v32, v23, v22, s39
    v_accvgpr_write_b32 a115, v32
    v_perm_b32 v33, v23, v22, s40
    v_accvgpr_write_b32 a119, v33
    s_waitcnt lgkmcnt(2)
    v_perm_b32 v32, v25, v24, s39
    v_accvgpr_write_b32 a120, v32
    v_perm_b32 v33, v25, v24, s40
    v_accvgpr_write_b32 a124, v33
    v_perm_b32 v32, v27, v26, s39
    v_accvgpr_write_b32 a121, v32
    v_perm_b32 v33, v27, v26, s40
    v_accvgpr_write_b32 a125, v33
    s_waitcnt lgkmcnt(0)
    v_perm_b32 v32, v29, v28, s39
    v_accvgpr_write_b32 a122, v32
    v_perm_b32 v33, v29, v28, s40
    v_accvgpr_write_b32 a126, v33
    v_perm_b32 v32, v31, v30, s39
    v_accvgpr_write_b32 a123, v32
    v_perm_b32 v33, v31, v30, s40
    v_accvgpr_write_b32 a127, v33
    s_waitcnt vmcnt(12)
    s_barrier
    s_add_u32 m0, s36, 32768
    s_mov_b32 s25, 2097152
    buffer_load_dwordx4 v12, s[16:19], s25 offen lds
    s_add_u32 m0, s36, 33792
    s_mov_b32 s25, 2129920
    buffer_load_dwordx4 v12, s[16:19], s25 offen lds
    s_add_u32 m0, s36, 34816
    s_mov_b32 s25, 2162688
    buffer_load_dwordx4 v12, s[16:19], s25 offen lds
    s_add_u32 m0, s36, 35840
    s_mov_b32 s25, 2195456
    buffer_load_dwordx4 v12, s[16:19], s25 offen lds
    ds_read2st64_b32 v[16:17], v14 offset0:0 offset1:1
    ds_read2st64_b32 v[18:19], v14 offset0:2 offset1:3
    ds_read2st64_b32 v[20:21], v14 offset0:4 offset1:5
    ds_read2st64_b32 v[22:23], v14 offset0:6 offset1:7
    ds_read2st64_b32 v[24:25], v14 offset0:32 offset1:33
    ds_read2st64_b32 v[26:27], v14 offset0:34 offset1:35
    ds_read2st64_b32 v[28:29], v14 offset0:36 offset1:37
    ds_read2st64_b32 v[30:31], v14 offset0:38 offset1:39
    s_waitcnt lgkmcnt(6)
    v_perm_b32 v32, v17, v16, s39
    v_accvgpr_write_b32 a128, v32
    v_perm_b32 v33, v17, v16, s40
    v_accvgpr_write_b32 a132, v33
    v_perm_b32 v32, v19, v18, s39
    v_accvgpr_write_b32 a129, v32
    v_perm_b32 v33, v19, v18, s40
    v_accvgpr_write_b32 a133, v33
    s_waitcnt lgkmcnt(4)
    v_perm_b32 v32, v21, v20, s39
    v_accvgpr_write_b32 a130, v32
    v_perm_b32 v33, v21, v20, s40
    v_accvgpr_write_b32 a134, v33
    v_perm_b32 v32, v23, v22, s39
    v_accvgpr_write_b32 a131, v32
    v_perm_b32 v33, v23, v22, s40
    v_accvgpr_write_b32 a135, v33
    s_waitcnt lgkmcnt(2)
    v_perm_b32 v32, v25, v24, s39
    v_accvgpr_write_b32 a136, v32
    v_perm_b32 v33, v25, v24, s40
    v_accvgpr_write_b32 a140, v33
    v_perm_b32 v32, v27, v26, s39
    v_accvgpr_write_b32 a137, v32
    v_perm_b32 v33, v27, v26, s40
    v_accvgpr_write_b32 a141, v33
    s_waitcnt lgkmcnt(0)
    v_perm_b32 v32, v29, v28, s39
    v_accvgpr_write_b32 a138, v32
    v_perm_b32 v33, v29, v28, s40
    v_accvgpr_write_b32 a142, v33
    v_perm_b32 v32, v31, v30, s39
    v_accvgpr_write_b32 a139, v32
    v_perm_b32 v33, v31, v30, s40
    v_accvgpr_write_b32 a143, v33
    s_waitcnt vmcnt(12)
    s_barrier
    s_add_u32 m0, s36, 49152
    s_mov_b32 s25, 2621440
    buffer_load_dwordx4 v12, s[16:19], s25 offen lds
    s_add_u32 m0, s36, 50176
    s_mov_b32 s25, 2654208
    buffer_load_dwordx4 v12, s[16:19], s25 offen lds
    s_add_u32 m0, s36, 51200
    s_mov_b32 s25, 2686976
    buffer_load_dwordx4 v12, s[16:19], s25 offen lds
    s_add_u32 m0, s36, 52224
    s_mov_b32 s25, 2719744
    buffer_load_dwordx4 v12, s[16:19], s25 offen lds
    ds_read2st64_b32 v[16:17], v14 offset0:64 offset1:65
    ds_read2st64_b32 v[18:19], v14 offset0:66 offset1:67
    ds_read2st64_b32 v[20:21], v14 offset0:68 offset1:69
    ds_read2st64_b32 v[22:23], v14 offset0:70 offset1:71
    ds_read2st64_b32 v[24:25], v14 offset0:96 offset1:97
    ds_read2st64_b32 v[26:27], v14 offset0:98 offset1:99
    ds_read2st64_b32 v[28:29], v14 offset0:100 offset1:101
    ds_read2st64_b32 v[30:31], v14 offset0:102 offset1:103
    s_waitcnt lgkmcnt(6)
    v_perm_b32 v32, v17, v16, s39
    v_accvgpr_write_b32 a144, v32
    v_perm_b32 v33, v17, v16, s40
    v_accvgpr_write_b32 a148, v33
    v_perm_b32 v32, v19, v18, s39
    v_accvgpr_write_b32 a145, v32
    v_perm_b32 v33, v19, v18, s40
    v_accvgpr_write_b32 a149, v33
    s_waitcnt lgkmcnt(4)
    v_perm_b32 v32, v21, v20, s39
    v_accvgpr_write_b32 a146, v32
    v_perm_b32 v33, v21, v20, s40
    v_accvgpr_write_b32 a150, v33
    v_perm_b32 v32, v23, v22, s39
    v_accvgpr_write_b32 a147, v32
    v_perm_b32 v33, v23, v22, s40
    v_accvgpr_write_b32 a151, v33
    s_waitcnt lgkmcnt(2)
    v_perm_b32 v32, v25, v24, s39
    v_accvgpr_write_b32 a152, v32
    v_perm_b32 v33, v25, v24, s40
    v_accvgpr_write_b32 a156, v33
    v_perm_b32 v32, v27, v26, s39
    v_accvgpr_write_b32 a153, v32
    v_perm_b32 v33, v27, v26, s40
    v_accvgpr_write_b32 a157, v33
    s_waitcnt lgkmcnt(0)
    v_perm_b32 v32, v29, v28, s39
    v_accvgpr_write_b32 a154, v32
    v_perm_b32 v33, v29, v28, s40
    v_accvgpr_write_b32 a158, v33
    v_perm_b32 v32, v31, v30, s39
    v_accvgpr_write_b32 a155, v32
    v_perm_b32 v33, v31, v30, s40
    v_accvgpr_write_b32 a159, v33
    s_waitcnt vmcnt(12)
    s_barrier
    s_add_u32 m0, s36, 65536
    s_mov_b32 s25, 3145728
    buffer_load_dwordx4 v12, s[16:19], s25 offen lds
    s_add_u32 m0, s36, 66560
    s_mov_b32 s25, 3178496
    buffer_load_dwordx4 v12, s[16:19], s25 offen lds
    s_add_u32 m0, s36, 67584
    s_mov_b32 s25, 3211264
    buffer_load_dwordx4 v12, s[16:19], s25 offen lds
    s_add_u32 m0, s36, 68608
    s_mov_b32 s25, 3244032
    buffer_load_dwordx4 v12, s[16:19], s25 offen lds
    ds_read2st64_b32 v[16:17], v13 offset0:0 offset1:1
    ds_read2st64_b32 v[18:19], v13 offset0:2 offset1:3
    ds_read2st64_b32 v[20:21], v13 offset0:4 offset1:5
    ds_read2st64_b32 v[22:23], v13 offset0:6 offset1:7
    ds_read2st64_b32 v[24:25], v13 offset0:32 offset1:33
    ds_read2st64_b32 v[26:27], v13 offset0:34 offset1:35
    ds_read2st64_b32 v[28:29], v13 offset0:36 offset1:37
    ds_read2st64_b32 v[30:31], v13 offset0:38 offset1:39
    s_waitcnt lgkmcnt(6)
    v_perm_b32 v32, v17, v16, s39
    v_accvgpr_write_b32 a160, v32
    v_perm_b32 v33, v17, v16, s40
    v_accvgpr_write_b32 a164, v33
    v_perm_b32 v32, v19, v18, s39
    v_accvgpr_write_b32 a161, v32
    v_perm_b32 v33, v19, v18, s40
    v_accvgpr_write_b32 a165, v33
    s_waitcnt lgkmcnt(4)
    v_perm_b32 v32, v21, v20, s39
    v_accvgpr_write_b32 a162, v32
    v_perm_b32 v33, v21, v20, s40
    v_accvgpr_write_b32 a166, v33
    v_perm_b32 v32, v23, v22, s39
    v_accvgpr_write_b32 a163, v32
    v_perm_b32 v33, v23, v22, s40
    v_accvgpr_write_b32 a167, v33
    s_waitcnt lgkmcnt(2)
    v_perm_b32 v32, v25, v24, s39
    v_accvgpr_write_b32 a168, v32
    v_perm_b32 v33, v25, v24, s40
    v_accvgpr_write_b32 a172, v33
    v_perm_b32 v32, v27, v26, s39
    v_accvgpr_write_b32 a169, v32
    v_perm_b32 v33, v27, v26, s40
    v_accvgpr_write_b32 a173, v33
    s_waitcnt lgkmcnt(0)
    v_perm_b32 v32, v29, v28, s39
    v_accvgpr_write_b32 a170, v32
    v_perm_b32 v33, v29, v28, s40
    v_accvgpr_write_b32 a174, v33
    v_perm_b32 v32, v31, v30, s39
    v_accvgpr_write_b32 a171, v32
    v_perm_b32 v33, v31, v30, s40
    v_accvgpr_write_b32 a175, v33
    s_waitcnt vmcnt(12)
    s_barrier
    s_add_u32 m0, s36, 0
    s_mov_b32 s25, 3670016
    buffer_load_dwordx4 v12, s[16:19], s25 offen lds
    s_add_u32 m0, s36, 1024
    s_mov_b32 s25, 3702784
    buffer_load_dwordx4 v12, s[16:19], s25 offen lds
    s_add_u32 m0, s36, 2048
    s_mov_b32 s25, 3735552
    buffer_load_dwordx4 v12, s[16:19], s25 offen lds
    s_add_u32 m0, s36, 3072
    s_mov_b32 s25, 3768320
    buffer_load_dwordx4 v12, s[16:19], s25 offen lds
    ds_read2st64_b32 v[16:17], v13 offset0:64 offset1:65
    ds_read2st64_b32 v[18:19], v13 offset0:66 offset1:67
    ds_read2st64_b32 v[20:21], v13 offset0:68 offset1:69
    ds_read2st64_b32 v[22:23], v13 offset0:70 offset1:71
    ds_read2st64_b32 v[24:25], v13 offset0:96 offset1:97
    ds_read2st64_b32 v[26:27], v13 offset0:98 offset1:99
    ds_read2st64_b32 v[28:29], v13 offset0:100 offset1:101
    ds_read2st64_b32 v[30:31], v13 offset0:102 offset1:103
    s_waitcnt lgkmcnt(6)
    v_perm_b32 v32, v17, v16, s39
    v_accvgpr_write_b32 a176, v32
    v_perm_b32 v33, v17, v16, s40
    v_accvgpr_write_b32 a180, v33
    v_perm_b32 v32, v19, v18, s39
    v_accvgpr_write_b32 a177, v32
    v_perm_b32 v33, v19, v18, s40
    v_accvgpr_write_b32 a181, v33
    s_waitcnt lgkmcnt(4)
    v_perm_b32 v32, v21, v20, s39
    v_accvgpr_write_b32 a178, v32
    v_perm_b32 v33, v21, v20, s40
    v_accvgpr_write_b32 a182, v33
    v_perm_b32 v32, v23, v22, s39
    v_accvgpr_write_b32 a179, v32
    v_perm_b32 v33, v23, v22, s40
    v_accvgpr_write_b32 a183, v33
    s_waitcnt lgkmcnt(2)
    v_perm_b32 v32, v25, v24, s39
    v_accvgpr_write_b32 a184, v32
    v_perm_b32 v33, v25, v24, s40
    v_accvgpr_write_b32 a188, v33
    v_perm_b32 v32, v27, v26, s39
    v_accvgpr_write_b32 a185, v32
    v_perm_b32 v33, v27, v26, s40
    v_accvgpr_write_b32 a189, v33
    s_waitcnt lgkmcnt(0)
    v_perm_b32 v32, v29, v28, s39
    v_accvgpr_write_b32 a186, v32
    v_perm_b32 v33, v29, v28, s40
    v_accvgpr_write_b32 a190, v33
    v_perm_b32 v32, v31, v30, s39
    v_accvgpr_write_b32 a187, v32
    v_perm_b32 v33, v31, v30, s40
    v_accvgpr_write_b32 a191, v33
    s_waitcnt vmcnt(12)
    s_barrier
    ds_read2st64_b32 v[16:17], v13 offset0:128 offset1:129
    ds_read2st64_b32 v[18:19], v13 offset0:130 offset1:131
    ds_read2st64_b32 v[20:21], v13 offset0:132 offset1:133
    ds_read2st64_b32 v[22:23], v13 offset0:134 offset1:135
    ds_read2st64_b32 v[24:25], v13 offset0:160 offset1:161
    ds_read2st64_b32 v[26:27], v13 offset0:162 offset1:163
    ds_read2st64_b32 v[28:29], v13 offset0:164 offset1:165
    ds_read2st64_b32 v[30:31], v13 offset0:166 offset1:167
    s_waitcnt lgkmcnt(6)
    v_perm_b32 v32, v17, v16, s39
    v_accvgpr_write_b32 a192, v32
    v_perm_b32 v33, v17, v16, s40
    v_accvgpr_write_b32 a196, v33
    v_perm_b32 v32, v19, v18, s39
    v_accvgpr_write_b32 a193, v32
    v_perm_b32 v33, v19, v18, s40
    v_accvgpr_write_b32 a197, v33
    s_waitcnt lgkmcnt(4)
    v_perm_b32 v32, v21, v20, s39
    v_accvgpr_write_b32 a194, v32
    v_perm_b32 v33, v21, v20, s40
    v_accvgpr_write_b32 a198, v33
    v_perm_b32 v32, v23, v22, s39
    v_accvgpr_write_b32 a195, v32
    v_perm_b32 v33, v23, v22, s40
    v_accvgpr_write_b32 a199, v33
    s_waitcnt lgkmcnt(2)
    v_perm_b32 v32, v25, v24, s39
    v_accvgpr_write_b32 a200, v32
    v_perm_b32 v33, v25, v24, s40
    v_accvgpr_write_b32 a204, v33
    v_perm_b32 v32, v27, v26, s39
    v_accvgpr_write_b32 a201, v32
    v_perm_b32 v33, v27, v26, s40
    v_accvgpr_write_b32 a205, v33
    s_waitcnt lgkmcnt(0)
    v_perm_b32 v32, v29, v28, s39
    v_accvgpr_write_b32 a202, v32
    v_perm_b32 v33, v29, v28, s40
    v_accvgpr_write_b32 a206, v33
    v_perm_b32 v32, v31, v30, s39
    v_accvgpr_write_b32 a203, v32
    v_perm_b32 v33, v31, v30, s40
    v_accvgpr_write_b32 a207, v33
    s_waitcnt vmcnt(8)
    s_barrier
    ds_read2st64_b32 v[16:17], v14 offset0:0 offset1:1
    ds_read2st64_b32 v[18:19], v14 offset0:2 offset1:3
    ds_read2st64_b32 v[20:21], v14 offset0:4 offset1:5
    ds_read2st64_b32 v[22:23], v14 offset0:6 offset1:7
    ds_read2st64_b32 v[24:25], v14 offset0:32 offset1:33
    ds_read2st64_b32 v[26:27], v14 offset0:34 offset1:35
    ds_read2st64_b32 v[28:29], v14 offset0:36 offset1:37
    ds_read2st64_b32 v[30:31], v14 offset0:38 offset1:39
    s_waitcnt lgkmcnt(6)
    v_perm_b32 v32, v17, v16, s39
    v_accvgpr_write_b32 a208, v32
    v_perm_b32 v33, v17, v16, s40
    v_accvgpr_write_b32 a212, v33
    v_perm_b32 v32, v19, v18, s39
    v_accvgpr_write_b32 a209, v32
    v_perm_b32 v33, v19, v18, s40
    v_accvgpr_write_b32 a213, v33
    s_waitcnt lgkmcnt(4)
    v_perm_b32 v32, v21, v20, s39
    v_accvgpr_write_b32 a210, v32
    v_perm_b32 v33, v21, v20, s40
    v_accvgpr_write_b32 a214, v33
    v_perm_b32 v32, v23, v22, s39
    v_accvgpr_write_b32 a211, v32
    v_perm_b32 v33, v23, v22, s40
    v_accvgpr_write_b32 a215, v33
    s_waitcnt lgkmcnt(2)
    v_perm_b32 v32, v25, v24, s39
    v_accvgpr_write_b32 a216, v32
    v_perm_b32 v33, v25, v24, s40
    v_accvgpr_write_b32 a220, v33
    v_perm_b32 v32, v27, v26, s39
    v_accvgpr_write_b32 a217, v32
    v_perm_b32 v33, v27, v26, s40
    v_accvgpr_write_b32 a221, v33
    s_waitcnt lgkmcnt(0)
    v_perm_b32 v32, v29, v28, s39
    v_accvgpr_write_b32 a218, v32
    v_perm_b32 v33, v29, v28, s40
    v_accvgpr_write_b32 a222, v33
    v_perm_b32 v32, v31, v30, s39
    v_accvgpr_write_b32 a219, v32
    v_perm_b32 v33, v31, v30, s40
    v_accvgpr_write_b32 a223, v33
    s_waitcnt vmcnt(4)
    s_barrier
    ds_read2st64_b32 v[16:17], v14 offset0:64 offset1:65
    ds_read2st64_b32 v[18:19], v14 offset0:66 offset1:67
    ds_read2st64_b32 v[20:21], v14 offset0:68 offset1:69
    ds_read2st64_b32 v[22:23], v14 offset0:70 offset1:71
    ds_read2st64_b32 v[24:25], v14 offset0:96 offset1:97
    ds_read2st64_b32 v[26:27], v14 offset0:98 offset1:99
    ds_read2st64_b32 v[28:29], v14 offset0:100 offset1:101
    ds_read2st64_b32 v[30:31], v14 offset0:102 offset1:103
    s_waitcnt lgkmcnt(6)
    v_perm_b32 v32, v17, v16, s39
    v_accvgpr_write_b32 a224, v32
    v_perm_b32 v33, v17, v16, s40
    v_accvgpr_write_b32 a228, v33
    v_perm_b32 v32, v19, v18, s39
    v_accvgpr_write_b32 a225, v32
    v_perm_b32 v33, v19, v18, s40
    v_accvgpr_write_b32 a229, v33
    s_waitcnt lgkmcnt(4)
    v_perm_b32 v32, v21, v20, s39
    v_accvgpr_write_b32 a226, v32
    v_perm_b32 v33, v21, v20, s40
    v_accvgpr_write_b32 a230, v33
    v_perm_b32 v32, v23, v22, s39
    v_accvgpr_write_b32 a227, v32
    v_perm_b32 v33, v23, v22, s40
    v_accvgpr_write_b32 a231, v33
    s_waitcnt lgkmcnt(2)
    v_perm_b32 v32, v25, v24, s39
    v_accvgpr_write_b32 a232, v32
    v_perm_b32 v33, v25, v24, s40
    v_accvgpr_write_b32 a236, v33
    v_perm_b32 v32, v27, v26, s39
    v_accvgpr_write_b32 a233, v32
    v_perm_b32 v33, v27, v26, s40
    v_accvgpr_write_b32 a237, v33
    s_waitcnt lgkmcnt(0)
    v_perm_b32 v32, v29, v28, s39
    v_accvgpr_write_b32 a234, v32
    v_perm_b32 v33, v29, v28, s40
    v_accvgpr_write_b32 a238, v33
    v_perm_b32 v32, v31, v30, s39
    v_accvgpr_write_b32 a235, v32
    v_perm_b32 v33, v31, v30, s40
    v_accvgpr_write_b32 a239, v33
    s_waitcnt vmcnt(0)
    s_barrier
    ds_read2st64_b32 v[16:17], v13 offset0:0 offset1:1
    ds_read2st64_b32 v[18:19], v13 offset0:2 offset1:3
    ds_read2st64_b32 v[20:21], v13 offset0:4 offset1:5
    ds_read2st64_b32 v[22:23], v13 offset0:6 offset1:7
    ds_read2st64_b32 v[24:25], v13 offset0:32 offset1:33
    ds_read2st64_b32 v[26:27], v13 offset0:34 offset1:35
    ds_read2st64_b32 v[28:29], v13 offset0:36 offset1:37
    ds_read2st64_b32 v[30:31], v13 offset0:38 offset1:39
    s_waitcnt lgkmcnt(6)
    v_perm_b32 v32, v17, v16, s39
    v_accvgpr_write_b32 a240, v32
    v_perm_b32 v33, v17, v16, s40
    v_accvgpr_write_b32 a244, v33
    v_perm_b32 v32, v19, v18, s39
    v_accvgpr_write_b32 a241, v32
    v_perm_b32 v33, v19, v18, s40
    v_accvgpr_write_b32 a245, v33
    s_waitcnt lgkmcnt(4)
    v_perm_b32 v32, v21, v20, s39
    v_accvgpr_write_b32 a242, v32
    v_perm_b32 v33, v21, v20, s40
    v_accvgpr_write_b32 a246, v33
    v_perm_b32 v32, v23, v22, s39
    v_accvgpr_write_b32 a243, v32
    v_perm_b32 v33, v23, v22, s40
    v_accvgpr_write_b32 a247, v33
    s_waitcnt lgkmcnt(2)
    v_perm_b32 v32, v25, v24, s39
    v_accvgpr_write_b32 a248, v32
    v_perm_b32 v33, v25, v24, s40
    v_accvgpr_write_b32 a252, v33
    v_perm_b32 v32, v27, v26, s39
    v_accvgpr_write_b32 a249, v32
    v_perm_b32 v33, v27, v26, s40
    v_accvgpr_write_b32 a253, v33
    s_waitcnt lgkmcnt(0)
    v_perm_b32 v32, v29, v28, s39
    v_accvgpr_write_b32 a250, v32
    v_perm_b32 v33, v29, v28, s40
    v_accvgpr_write_b32 a254, v33
    v_perm_b32 v32, v31, v30, s39
    v_accvgpr_write_b32 a251, v32
    v_perm_b32 v33, v31, v30, s40
    v_accvgpr_write_b32 a255, v33
    s_cmp_lg_u32 s21, 0
    s_cbranch_scc1 L_wdln_ok
    v_mov_b32 v8, 0
L_wdln:
    buffer_load_dword v9, v8, s[12:15], 0 offen offset:68 sc1
    s_waitcnt vmcnt(0)
    v_readfirstlane_b32 s25, v9
    s_cmp_ge_u32 s25, 64
    s_cbranch_scc1 L_wdln_ok
    s_sleep 2
    s_add_u32 s26, s26, 1
    s_cmp_lt_u32 s26, 400000
    s_cbranch_scc1 L_wdln
L_wdln_ok:
    s_barrier
    s_nop 1
    s_lshl_b32 s35, s21, 13
    s_mov_b32 s30, s29
    s_mov_b32 s31, 64
    s_lshl_b32 s25, s30, 15
    s_add_u32 s25, s25, 2097152
    s_add_u32 m0, s35, 16384
    s_nop 0
    buffer_load_dwordx4 v6, s[8:11], s25 offen offset:0 sc1 lds
    s_add_u32 m0, m0, 960
    s_nop 0
    buffer_load_dwordx4 v6, s[8:11], s25 offen offset:64 sc1 lds
    s_add_u32 m0, m0, 960
    s_nop 0
    buffer_load_dwordx4 v6, s[8:11], s25 offen offset:128 sc1 lds
    s_add_u32 m0, m0, 960
    s_nop 0
    buffer_load_dwordx4 v6, s[8:11], s25 offen offset:192 sc1 lds
    s_add_u32 m0, m0, 960
    s_nop 0
    buffer_load_dwordx4 v6, s[8:11], s25 offen offset:256 sc1 lds
    s_add_u32 m0, m0, 960
    s_nop 0
    buffer_load_dwordx4 v6, s[8:11], s25 offen offset:320 sc1 lds
    s_add_u32 m0, m0, 960
    s_nop 0
    buffer_load_dwordx4 v6, s[8:11], s25 offen offset:384 sc1 lds
    s_add_u32 m0, m0, 960
    s_nop 0
    buffer_load_dwordx4 v6, s[8:11], s25 offen offset:448 sc1 lds
    s_xor_b32 s35, s35, 32768
    s_mov_b32 s16, s80
    s_and_b32 s17, s81, 0xffff
    s_mov_b32 s18, 0x400000
    s_mov_b32 s19, 0x00020000
    s_add_u32 m0, s36, 16384
    s_mov_b32 s25, 0
    buffer_load_dwordx4 v12, s[16:19], s25 offen lds
    s_add_u32 m0, s36, 17408
    s_mov_b32 s25, 32768
    buffer_load_dwordx4 v12, s[16:19], s25 offen lds
    s_add_u32 m0, s36, 18432
    s_mov_b32 s25, 65536
    buffer_load_dwordx4 v12, s[16:19], s25 offen lds
    s_add_u32 m0, s36, 19456
    s_mov_b32 s25, 98304
    buffer_load_dwordx4 v12, s[16:19], s25 offen lds
    s_add_u32 m0, s36, 32768
    s_mov_b32 s25, 524288
    buffer_load_dwordx4 v12, s[16:19], s25 offen lds
    s_add_u32 m0, s36, 33792
    s_mov_b32 s25, 557056
    buffer_load_dwordx4 v12, s[16:19], s25 offen lds
    s_add_u32 m0, s36, 34816
    s_mov_b32 s25, 589824
    buffer_load_dwordx4 v12, s[16:19], s25 offen lds
    s_add_u32 m0, s36, 35840
    s_mov_b32 s25, 622592
    buffer_load_dwordx4 v12, s[16:19], s25 offen lds
    s_waitcnt vmcnt(8)
L_p1:
    s_barrier
L_p1b:
    s_add_u32 s32, s30, 4
    s_cmp_ge_u32 s32, 64
    s_cselect_b32 s32, s29, s32
    s_lshl_b32 s25, s32, 15
    s_add_u32 s25, s25, 2097152
    s_add_u32 m0, s35, 16384
    s_nop 0
    buffer_load_dwordx4 v6, s[8:11], s25 offen offset:0 sc1 lds
    s_add_u32 m0, m0, 960
    s_nop 0
    buffer_load_dwordx4 v6, s[8:11], s25 offen offset:64 sc1 lds
    s_add_u32 m0, m0, 960
    s_nop 0
    buffer_load_dwordx4 v6, s[8:11], s25 offen offset:128 sc1 lds
    s_add_u32 m0, m0, 960
    s_nop 0
    buffer_load_dwordx4 v6, s[8:11], s25 offen offset:192 sc1 lds
    s_add_u32 m0, m0, 960
    s_nop 0
    buffer_load_dwordx4 v6, s[8:11], s25 offen offset:256 sc1 lds
    s_add_u32 m0, m0, 960
    s_nop 0
    buffer_load_dwordx4 v6, s[8:11], s25 offen offset:320 sc1 lds
    s_add_u32 m0, m0, 960
    s_nop 0
    buffer_load_dwordx4 v6, s[8:11], s25 offen offset:384 sc1 lds
    s_add_u32 m0, m0, 960
    s_nop 0
    buffer_load_dwordx4 v6, s[8:11], s25 offen offset:448 sc1 lds
    s_xor_b32 s35, s35, 32768
    ds_read_b128 v[64:67], v7 offset:0
    ds_read_b128 v[68:71], v7 offset:1024
    ds_read_b128 v[72:75], v7 offset:2048
    s_lshl_b32 s32, s30, 5
    s_add_u32 s32, s32, s28
    s_lshl_b32 s33, s32, 13
    s_add_u32 s33, s33, 52428800
    s_lshl_b32 s32, s32, 14
    s_add_u32 s32, s32, 16777216
    s_waitcnt lgkmcnt(2)
    v_mfma_f32_16x16x32_bf16 v[16:19], a[0:3], v[64:67], 0
    ds_read_b128 v[76:79], v7 offset:3072
    v_mfma_f32_16x16x32_bf16 v[20:23], a[4:7], v[64:67], 0
    v_mfma_f32_16x16x32_bf16 v[24:27], v[64:67], a[128:131], 0
    v_mfma_f32_16x16x32_bf16 v[28:31], v[64:67], a[132:135], 0
    s_waitcnt lgkmcnt(2)
    v_mfma_f32_16x16x32_bf16 v[16:19], a[8:11], v[68:71], v[16:19]
    ds_read_b128 v[64:67], v7 offset:4096
    v_mfma_f32_16x16x32_bf16 v[20:23], a[12:15], v[68:71], v[20:23]
    v_mfma_f32_16x16x32_bf16 v[24:27], v[68:71], a[136:139], v[24:27]
    v_mfma_f32_16x16x32_bf16 v[28:31], v[68:71], a[140:143], v[28:31]
    s_waitcnt lgkmcnt(2)
    v_mfma_f32_16x16x32_bf16 v[16:19], a[16:19], v[72:75], v[16:19]
    ds_read_b128 v[68:71], v7 offset:5120
    v_mfma_f32_16x16x32_bf16 v[20:23], a[20:23], v[72:75], v[20:23]
    v_mfma_f32_16x16x32_bf16 v[24:27], v[72:75], a[144:147], v[24:27]
    v_mfma_f32_16x16x32_bf16 v[28:31], v[72:75], a[148:151], v[28:31]
    s_waitcnt lgkmcnt(2)
    v_mfma_f32_16x16x32_bf16 v[16:19], a[24:27], v[76:79], v[16:19]
    ds_read_b128 v[72:75], v7 offset:6144
    v_mfma_f32_16x16x32_bf16 v[20:23], a[28:31], v[76:79], v[20:23]
    v_mfma_f32_16x16x32_bf16 v[24:27], v[76:79], a[152:155], v[24:27]
    v_mfma_f32_16x16x32_bf16 v[28:31], v[76:79], a[156:159], v[28:31]
    s_waitcnt lgkmcnt(2)
    v_mfma_f32_16x16x32_bf16 v[16:19], a[32:35], v[64:67], v[16:19]
    ds_read_b128 v[76:79], v7 offset:7168
    v_mfma_f32_16x16x32_bf16 v[20:23], a[36:39], v[64:67], v[20:23]
    v_mfma_f32_16x16x32_bf16 v[24:27], v[64:67], a[160:163], v[24:27]
    v_mfma_f32_16x16x32_bf16 v[28:31], v[64:67], a[164:167], v[28:31]
    s_waitcnt lgkmcnt(2)
    v_mfma_f32_16x16x32_bf16 v[16:19], a[40:43], v[68:71], v[16:19]
    ds_read_b128 v[64:67], v7 offset:8192
    v_mfma_f32_16x16x32_bf16 v[20:23], a[44:47], v[68:71], v[20:23]
    v_mfma_f32_16x16x32_bf16 v[24:27], v[68:71], a[168:171], v[24:27]
    v_mfma_f32_16x16x32_bf16 v[28:31], v[68:71], a[172:175], v[28:31]
    s_waitcnt lgkmcnt(2)
    v_mfma_f32_16x16x32_bf16 v[16:19], a[48:51], v[72:75], v[16:19]
    ds_read_b128 v[68:71], v7 offset:9216
    v_mfma_f32_16x16x32_bf16 v[20:23], a[52:55], v[72:75], v[20:23]
    v_mfma_f32_16x16x32_bf16 v[24:27], v[72:75], a[176:179], v[24:27]
    v_mfma_f32_16x16x32_bf16 v[28:31], v[72:75], a[180:183], v[28:31]
    s_waitcnt lgkmcnt(2)
    v_mfma_f32_16x16x32_bf16 v[16:19], a[56:59], v[76:79], v[16:19]
    ds_read_b128 v[72:75], v7 offset:10240
    v_mfma_f32_16x16x32_bf16 v[20:23], a[60:63], v[76:79], v[20:23]
    v_mfma_f32_16x16x32_bf16 v[24:27], v[76:79], a[184:187], v[24:27]
    v_mfma_f32_16x16x32_bf16 v[28:31], v[76:79], a[188:191], v[28:31]
    s_waitcnt lgkmcnt(2)
    v_mfma_f32_16x16x32_bf16 v[16:19], a[64:67], v[64:67], v[16:19]
    ds_read_b128 v[76:79], v7 offset:11264
    v_mfma_f32_16x16x32_bf16 v[20:23], a[68:71], v[64:67], v[20:23]
    v_mfma_f32_16x16x32_bf16 v[24:27], v[64:67], a[192:195], v[24:27]
    v_mfma_f32_16x16x32_bf16 v[28:31], v[64:67], a[196:199], v[28:31]
    s_waitcnt lgkmcnt(2)
    v_mfma_f32_16x16x32_bf16 v[16:19], a[72:75], v[68:71], v[16:19]
    ds_read_b128 v[64:67], v7 offset:12288
    v_mfma_f32_16x16x32_bf16 v[20:23], a[76:79], v[68:71], v[20:23]
    v_mfma_f32_16x16x32_bf16 v[24:27], v[68:71], a[200:203], v[24:27]
    v_mfma_f32_16x16x32_bf16 v[28:31], v[68:71], a[204:207], v[28:31]
    s_waitcnt lgkmcnt(2)
    v_mfma_f32_16x16x32_bf16 v[16:19], a[80:83], v[72:75], v[16:19]
    ds_read_b128 v[68:71], v7 offset:13312
    v_mfma_f32_16x16x32_bf16 v[20:23], a[84:87], v[72:75], v[20:23]
    v_mfma_f32_16x16x32_bf16 v[24:27], v[72:75], a[208:211], v[24:27]
    v_mfma_f32_16x16x32_bf16 v[28:31], v[72:75], a[212:215], v[28:31]
    s_waitcnt lgkmcnt(2)
    v_mfma_f32_16x16x32_bf16 v[16:19], a[88:91], v[76:79], v[16:19]
    ds_read_b128 v[72:75], v7 offset:14336
    v_mfma_f32_16x16x32_bf16 v[20:23], a[92:95], v[76:79], v[20:23]
    v_mfma_f32_16x16x32_bf16 v[24:27], v[76:79], a[216:219], v[24:27]
    v_mfma_f32_16x16x32_bf16 v[28:31], v[76:79], a[220:223], v[28:31]
    s_waitcnt lgkmcnt(2)
    v_mfma_f32_16x16x32_bf16 v[16:19], a[96:99], v[64:67], v[16:19]
    ds_read_b128 v[76:79], v7 offset:15360
    v_mfma_f32_16x16x32_bf16 v[20:23], a[100:103], v[64:67], v[20:23]
    v_mfma_f32_16x16x32_bf16 v[24:27], v[64:67], a[224:227], v[24:27]
    v_mfma_f32_16x16x32_bf16 v[28:31], v[64:67], a[228:231], v[28:31]
    s_waitcnt lgkmcnt(2)
    v_mfma_f32_16x16x32_bf16 v[16:19], a[104:107], v[68:71], v[16:19]
    ds_read_b128 v[64:67], v7 offset:16384
    v_mfma_f32_16x16x32_bf16 v[20:23], a[108:111], v[68:71], v[20:23]
    v_mfma_f32_16x16x32_bf16 v[24:27], v[68:71], a[232:235], v[24:27]
    v_mfma_f32_16x16x32_bf16 v[28:31], v[68:71], a[236:239], v[28:31]
    s_waitcnt lgkmcnt(2)
    v_mfma_f32_16x16x32_bf16 v[16:19], a[112:115], v[72:75], v[16:19]
    ds_read_b128 v[68:71], v7 offset:17408
    v_mfma_f32_16x16x32_bf16 v[20:23], a[116:119], v[72:75], v[20:23]
    v_mfma_f32_16x16x32_bf16 v[24:27], v[72:75], a[240:243], v[24:27]
    v_mfma_f32_16x16x32_bf16 v[28:31], v[72:75], a[244:247], v[28:31]
    s_waitcnt lgkmcnt(2)
    v_mfma_f32_16x16x32_bf16 v[16:19], a[120:123], v[76:79], v[16:19]
    ds_read_b128 v[72:75], v7 offset:18432
    v_mfma_f32_16x16x32_bf16 v[20:23], a[124:127], v[76:79], v[20:23]
    v_mfma_f32_16x16x32_bf16 v[24:27], v[76:79], a[248:251], v[24:27]
    v_mfma_f32_16x16x32_bf16 v[28:31], v[76:79], a[252:255], v[28:31]
    s_waitcnt lgkmcnt(2)
    v_mfma_f32_16x16x32_bf16 v[40:43], a[0:3], v[64:67], 0
    ds_read_b128 v[76:79], v7 offset:19456
    v_mfma_f32_16x16x32_bf16 v[44:47], a[4:7], v[64:67], 0
    v_mfma_f32_16x16x32_bf16 v[48:51], v[64:67], a[128:131], 0
    v_mfma_f32_16x16x32_bf16 v[52:55], v[64:67], a[132:135], 0
    s_waitcnt lgkmcnt(2)
    v_mfma_f32_16x16x32_bf16 v[40:43], a[8:11], v[68:71], v[40:43]
    ds_read_b128 v[64:67], v7 offset:20480
    v_mfma_f32_16x16x32_bf16 v[44:47], a[12:15], v[68:71], v[44:47]
    v_mfma_f32_16x16x32_bf16 v[48:51], v[68:71], a[136:139], v[48:51]
    v_mfma_f32_16x16x32_bf16 v[52:55], v[68:71], a[140:143], v[52:55]
    v_cvt_pk_bf16_f32 v80, v16, v20
    v_cvt_pk_bf16_f32 v81, v17, v21
    v_cvt_pk_bf16_f32 v82, v18, v22
    v_cvt_pk_bf16_f32 v83, v19, v23
    s_add_u32 s25, s32, 0
    buffer_store_dwordx4 v[80:83], v2, s[8:11], s25 offen sc1
    s_waitcnt lgkmcnt(2)
    v_mfma_f32_16x16x32_bf16 v[40:43], a[16:19], v[72:75], v[40:43]
    ds_read_b128 v[68:71], v7 offset:21504
    v_mfma_f32_16x16x32_bf16 v[44:47], a[20:23], v[72:75], v[44:47]
    v_mfma_f32_16x16x32_bf16 v[48:51], v[72:75], a[144:147], v[48:51]
    v_mfma_f32_16x16x32_bf16 v[52:55], v[72:75], a[148:151], v[52:55]
    s_waitcnt lgkmcnt(2)
    v_mfma_f32_16x16x32_bf16 v[40:43], a[24:27], v[76:79], v[40:43]
    ds_read_b128 v[72:75], v7 offset:22528
    v_mfma_f32_16x16x32_bf16 v[44:47], a[28:31], v[76:79], v[44:47]
    v_mfma_f32_16x16x32_bf16 v[48:51], v[76:79], a[152:155], v[48:51]
    v_mfma_f32_16x16x32_bf16 v[52:55], v[76:79], a[156:159], v[52:55]
    s_waitcnt lgkmcnt(2)
    v_mfma_f32_16x16x32_bf16 v[40:43], a[32:35], v[64:67], v[40:43]
    ds_read_b128 v[76:79], v7 offset:23552
    v_mfma_f32_16x16x32_bf16 v[44:47], a[36:39], v[64:67], v[44:47]
    v_mfma_f32_16x16x32_bf16 v[48:51], v[64:67], a[160:163], v[48:51]
    v_mfma_f32_16x16x32_bf16 v[52:55], v[64:67], a[164:167], v[52:55]
    s_waitcnt lgkmcnt(2)
    v_mfma_f32_16x16x32_bf16 v[40:43], a[40:43], v[68:71], v[40:43]
    ds_read_b128 v[64:67], v7 offset:24576
    v_mfma_f32_16x16x32_bf16 v[44:47], a[44:47], v[68:71], v[44:47]
    v_mfma_f32_16x16x32_bf16 v[48:51], v[68:71], a[168:171], v[48:51]
    v_mfma_f32_16x16x32_bf16 v[52:55], v[68:71], a[172:175], v[52:55]
    s_waitcnt lgkmcnt(2)
    v_mfma_f32_16x16x32_bf16 v[40:43], a[48:51], v[72:75], v[40:43]
    ds_read_b128 v[68:71], v7 offset:25600
    v_mfma_f32_16x16x32_bf16 v[44:47], a[52:55], v[72:75], v[44:47]
    v_mfma_f32_16x16x32_bf16 v[48:51], v[72:75], a[176:179], v[48:51]
    v_mfma_f32_16x16x32_bf16 v[52:55], v[72:75], a[180:183], v[52:55]
    s_waitcnt lgkmcnt(2)
    v_mfma_f32_16x16x32_bf16 v[40:43], a[56:59], v[76:79], v[40:43]
    ds_read_b128 v[72:75], v7 offset:26624
    v_mfma_f32_16x16x32_bf16 v[44:47], a[60:63], v[76:79], v[44:47]
    v_mfma_f32_16x16x32_bf16 v[48:51], v[76:79], a[184:187], v[48:51]
    v_mfma_f32_16x16x32_bf16 v[52:55], v[76:79], a[188:191], v[52:55]
    s_waitcnt lgkmcnt(2)
    v_mfma_f32_16x16x32_bf16 v[40:43], a[64:67], v[64:67], v[40:43]
    ds_read_b128 v[76:79], v7 offset:27648
    v_mfma_f32_16x16x32_bf16 v[44:47], a[68:71], v[64:67], v[44:47]
    v_mfma_f32_16x16x32_bf16 v[48:51], v[64:67], a[192:195], v[48:51]
    v_mfma_f32_16x16x32_bf16 v[52:55], v[64:67], a[196:199], v[52:55]
    s_waitcnt lgkmcnt(2)
    v_mfma_f32_16x16x32_bf16 v[40:43], a[72:75], v[68:71], v[40:43]
    ds_read_b128 v[64:67], v7 offset:28672
    v_mfma_f32_16x16x32_bf16 v[44:47], a[76:79], v[68:71], v[44:47]
    v_mfma_f32_16x16x32_bf16 v[48:51], v[68:71], a[200:203], v[48:51]
    v_mfma_f32_16x16x32_bf16 v[52:55], v[68:71], a[204:207], v[52:55]
    s_waitcnt lgkmcnt(2)
    v_mfma_f32_16x16x32_bf16 v[40:43], a[80:83], v[72:75], v[40:43]
    ds_read_b128 v[68:71], v7 offset:29696
    v_mfma_f32_16x16x32_bf16 v[44:47], a[84:87], v[72:75], v[44:47]
    v_mfma_f32_16x16x32_bf16 v[48:51], v[72:75], a[208:211], v[48:51]
    v_mfma_f32_16x16x32_bf16 v[52:55], v[72:75], a[212:215], v[52:55]
    s_waitcnt lgkmcnt(2)
    v_mfma_f32_16x16x32_bf16 v[40:43], a[88:91], v[76:79], v[40:43]
    ds_read_b128 v[72:75], v7 offset:30720
    v_mfma_f32_16x16x32_bf16 v[44:47], a[92:95], v[76:79], v[44:47]
    v_mfma_f32_16x16x32_bf16 v[48:51], v[76:79], a[216:219], v[48:51]
    v_mfma_f32_16x16x32_bf16 v[52:55], v[76:79], a[220:223], v[52:55]
    s_waitcnt lgkmcnt(2)
    v_mfma_f32_16x16x32_bf16 v[40:43], a[96:99], v[64:67], v[40:43]
    ds_read_b128 v[76:79], v7 offset:31744
    v_mfma_f32_16x16x32_bf16 v[44:47], a[100:103], v[64:67], v[44:47]
    v_mfma_f32_16x16x32_bf16 v[48:51], v[64:67], a[224:227], v[48:51]
    v_mfma_f32_16x16x32_bf16 v[52:55], v[64:67], a[228:231], v[52:55]
    s_waitcnt lgkmcnt(2)
    v_mfma_f32_16x16x32_bf16 v[40:43], a[104:107], v[68:71], v[40:43]
    ds_read_b128 v[64:67], v7 offset:0
    v_mfma_f32_16x16x32_bf16 v[44:47], a[108:111], v[68:71], v[44:47]
    v_mfma_f32_16x16x32_bf16 v[48:51], v[68:71], a[232:235], v[48:51]
    v_mfma_f32_16x16x32_bf16 v[52:55], v[68:71], a[236:239], v[52:55]
    s_waitcnt lgkmcnt(2)
    v_mfma_f32_16x16x32_bf16 v[40:43], a[112:115], v[72:75], v[40:43]
    ds_read_b128 v[68:71], v7 offset:1024
    v_mfma_f32_16x16x32_bf16 v[44:47], a[116:119], v[72:75], v[44:47]
    v_mfma_f32_16x16x32_bf16 v[48:51], v[72:75], a[240:243], v[48:51]
    v_mfma_f32_16x16x32_bf16 v[52:55], v[72:75], a[244:247], v[52:55]
    s_waitcnt lgkmcnt(2)
    v_mfma_f32_16x16x32_bf16 v[40:43], a[120:123], v[76:79], v[40:43]
    ds_read_b128 v[72:75], v7 offset:2048
    v_mfma_f32_16x16x32_bf16 v[44:47], a[124:127], v[76:79], v[44:47]
    v_mfma_f32_16x16x32_bf16 v[48:51], v[76:79], a[248:251], v[48:51]
    v_mfma_f32_16x16x32_bf16 v[52:55], v[76:79], a[252:255], v[52:55]
    v_cvt_pk_bf16_f32 v88, v40, v44
    v_cvt_pk_bf16_f32 v89, v41, v45
    v_cvt_pk_bf16_f32 v90, v42, v46
    v_cvt_pk_bf16_f32 v91, v43, v47
    s_add_u32 s25, s32, 4096
    buffer_store_dwordx4 v[88:91], v2, s[8:11], s25 offen sc1
    v_cvt_pk_bf16_f32 v92, v24, v25
    v_cvt_pk_bf16_f32 v93, v26, v27
    v_cvt_pk_bf16_f32 v94, v48, v49
    v_cvt_pk_bf16_f32 v95, v50, v51
    s_add_u32 s25, s32, 8192
    buffer_store_dwordx4 v[92:95], v2, s[8:11], s25 offen sc1
    v_cvt_pk_bf16_f32 v96, v28, v29
    v_cvt_pk_bf16_f32 v97, v30, v31
    v_cvt_pk_bf16_f32 v98, v52, v53
    v_cvt_pk_bf16_f32 v99, v54, v55
    s_add_u32 s25, s32, 12288
    buffer_store_dwordx4 v[96:99], v2, s[8:11], s25 offen sc1
    s_cmp_lt_u32 s30, 4
    s_cbranch_scc1 L_qload
L_qload_ret:
    s_waitcnt lgkmcnt(2)
    v_mfma_f32_16x16x32_bf16 v[32:35], v[128:131], v[64:67], 0
    ds_read_b128 v[76:79], v7 offset:3072
    v_mfma_f32_16x16x32_bf16 v[36:39], v[132:135], v[64:67], 0
    s_waitcnt lgkmcnt(2)
    v_mfma_f32_16x16x32_bf16 v[32:35], v[136:139], v[68:71], v[32:35]
    ds_read_b128 v[64:67], v7 offset:4096
    v_mfma_f32_16x16x32_bf16 v[36:39], v[140:143], v[68:71], v[36:39]
    s_waitcnt lgkmcnt(2)
    v_mfma_f32_16x16x32_bf16 v[32:35], v[144:147], v[72:75], v[32:35]
    ds_read_b128 v[68:71], v7 offset:5120
    v_mfma_f32_16x16x32_bf16 v[36:39], v[148:151], v[72:75], v[36:39]
    s_waitcnt lgkmcnt(2)
    v_mfma_f32_16x16x32_bf16 v[32:35], v[152:155], v[76:79], v[32:35]
    ds_read_b128 v[72:75], v7 offset:6144
    v_mfma_f32_16x16x32_bf16 v[36:39], v[156:159], v[76:79], v[36:39]
    s_waitcnt lgkmcnt(2)
    v_mfma_f32_16x16x32_bf16 v[32:35], v[160:163], v[64:67], v[32:35]
    ds_read_b128 v[76:79], v7 offset:7168
    v_mfma_f32_16x16x32_bf16 v[36:39], v[164:167], v[64:67], v[36:39]
    s_waitcnt lgkmcnt(2)
    v_mfma_f32_16x16x32_bf16 v[32:35], v[168:171], v[68:71], v[32:35]
    ds_read_b128 v[64:67], v7 offset:8192
    v_mfma_f32_16x16x32_bf16 v[36:39], v[172:175], v[68:71], v[36:39]
    s_waitcnt lgkmcnt(2)
    v_mfma_f32_16x16x32_bf16 v[32:35], v[176:179], v[72:75], v[32:35]
    ds_read_b128 v[68:71], v7 offset:9216
    v_mfma_f32_16x16x32_bf16 v[36:39], v[180:183], v[72:75], v[36:39]
    s_waitcnt lgkmcnt(2)
    v_mfma_f32_16x16x32_bf16 v[32:35], v[184:187], v[76:79], v[32:35]
    ds_read_b128 v[72:75], v7 offset:10240
    v_mfma_f32_16x16x32_bf16 v[36:39], v[188:191], v[76:79], v[36:39]
    s_waitcnt lgkmcnt(2)
    v_mfma_f32_16x16x32_bf16 v[32:35], v[192:195], v[64:67], v[32:35]
    ds_read_b128 v[76:79], v7 offset:11264
    v_mfma_f32_16x16x32_bf16 v[36:39], v[196:199], v[64:67], v[36:39]
    s_waitcnt lgkmcnt(2)
    v_mfma_f32_16x16x32_bf16 v[32:35], v[200:203], v[68:71], v[32:35]
    ds_read_b128 v[64:67], v7 offset:12288
    v_mfma_f32_16x16x32_bf16 v[36:39], v[204:207], v[68:71], v[36:39]
    s_waitcnt lgkmcnt(2)
    v_mfma_f32_16x16x32_bf16 v[32:35], v[208:211], v[72:75], v[32:35]
    ds_read_b128 v[68:71], v7 offset:13312
    v_mfma_f32_16x16x32_bf16 v[36:39], v[212:215], v[72:75], v[36:39]
    s_waitcnt lgkmcnt(2)
    v_mfma_f32_16x16x32_bf16 v[32:35], v[216:219], v[76:79], v[32:35]
    ds_read_b128 v[72:75], v7 offset:14336
    v_mfma_f32_16x16x32_bf16 v[36:39], v[220:223], v[76:79], v[36:39]
    s_waitcnt lgkmcnt(2)
    v_mfma_f32_16x16x32_bf16 v[32:35], v[224:227], v[64:67], v[32:35]
    ds_read_b128 v[76:79], v7 offset:15360
    v_mfma_f32_16x16x32_bf16 v[36:39], v[228:231], v[64:67], v[36:39]
    s_waitcnt lgkmcnt(2)
    v_mfma_f32_16x16x32_bf16 v[32:35], v[232:235], v[68:71], v[32:35]
    ds_read_b128 v[64:67], v7 offset:16384
    v_mfma_f32_16x16x32_bf16 v[36:39], v[236:239], v[68:71], v[36:39]
    s_waitcnt lgkmcnt(2)
    v_mfma_f32_16x16x32_bf16 v[32:35], v[240:243], v[72:75], v[32:35]
    ds_read_b128 v[68:71], v7 offset:17408
    v_mfma_f32_16x16x32_bf16 v[36:39], v[244:247], v[72:75], v[36:39]
    s_waitcnt lgkmcnt(2)
    v_mfma_f32_16x16x32_bf16 v[32:35], v[248:251], v[76:79], v[32:35]
    ds_read_b128 v[72:75], v7 offset:18432
    v_mfma_f32_16x16x32_bf16 v[36:39], v[252:255], v[76:79], v[36:39]
    s_waitcnt lgkmcnt(2)
    v_mfma_f32_16x16x32_bf16 v[56:59], v[128:131], v[64:67], 0
    ds_read_b128 v[76:79], v7 offset:19456
    v_mfma_f32_16x16x32_bf16 v[60:63], v[132:135], v[64:67], 0
    s_waitcnt lgkmcnt(2)
    v_mfma_f32_16x16x32_bf16 v[56:59], v[136:139], v[68:71], v[56:59]
    ds_read_b128 v[64:67], v7 offset:20480
    v_mfma_f32_16x16x32_bf16 v[60:63], v[140:143], v[68:71], v[60:63]
    v_cvt_pk_bf16_f32 v84, v32, v36
    v_cvt_pk_bf16_f32 v85, v33, v37
    v_cvt_pk_bf16_f32 v86, v34, v38
    v_cvt_pk_bf16_f32 v87, v35, v39
    s_add_u32 s25, s33, 0
    buffer_store_dwordx4 v[84:87], v2, s[8:11], s25 offen
    s_waitcnt lgkmcnt(2)
    v_mfma_f32_16x16x32_bf16 v[56:59], v[144:147], v[72:75], v[56:59]
    ds_read_b128 v[68:71], v7 offset:21504
    v_mfma_f32_16x16x32_bf16 v[60:63], v[148:151], v[72:75], v[60:63]
    s_waitcnt lgkmcnt(2)
    v_mfma_f32_16x16x32_bf16 v[56:59], v[152:155], v[76:79], v[56:59]
    ds_read_b128 v[72:75], v7 offset:22528
    v_mfma_f32_16x16x32_bf16 v[60:63], v[156:159], v[76:79], v[60:63]
    s_waitcnt lgkmcnt(2)
    v_mfma_f32_16x16x32_bf16 v[56:59], v[160:163], v[64:67], v[56:59]
    ds_read_b128 v[76:79], v7 offset:23552
    v_mfma_f32_16x16x32_bf16 v[60:63], v[164:167], v[64:67], v[60:63]
    s_waitcnt lgkmcnt(2)
    v_mfma_f32_16x16x32_bf16 v[56:59], v[168:171], v[68:71], v[56:59]
    ds_read_b128 v[64:67], v7 offset:24576
    v_mfma_f32_16x16x32_bf16 v[60:63], v[172:175], v[68:71], v[60:63]
    s_waitcnt lgkmcnt(2)
    v_mfma_f32_16x16x32_bf16 v[56:59], v[176:179], v[72:75], v[56:59]
    ds_read_b128 v[68:71], v7 offset:25600
    v_mfma_f32_16x16x32_bf16 v[60:63], v[180:183], v[72:75], v[60:63]
    s_waitcnt lgkmcnt(2)
    v_mfma_f32_16x16x32_bf16 v[56:59], v[184:187], v[76:79], v[56:59]
    ds_read_b128 v[72:75], v7 offset:26624
    v_mfma_f32_16x16x32_bf16 v[60:63], v[188:191], v[76:79], v[60:63]
    s_waitcnt lgkmcnt(2)
    v_mfma_f32_16x16x32_bf16 v[56:59], v[192:195], v[64:67], v[56:59]
    ds_read_b128 v[76:79], v7 offset:27648
    v_mfma_f32_16x16x32_bf16 v[60:63], v[196:199], v[64:67], v[60:63]
    s_waitcnt lgkmcnt(2)
    v_mfma_f32_16x16x32_bf16 v[56:59], v[200:203], v[68:71], v[56:59]
    ds_read_b128 v[64:67], v7 offset:28672
    v_mfma_f32_16x16x32_bf16 v[60:63], v[204:207], v[68:71], v[60:63]
    s_waitcnt lgkmcnt(2)
    v_mfma_f32_16x16x32_bf16 v[56:59], v[208:211], v[72:75], v[56:59]
    ds_read_b128 v[68:71], v7 offset:29696
    v_mfma_f32_16x16x32_bf16 v[60:63], v[212:215], v[72:75], v[60:63]
    s_waitcnt lgkmcnt(2)
    v_mfma_f32_16x16x32_bf16 v[56:59], v[216:219], v[76:79], v[56:59]
    ds_read_b128 v[72:75], v7 offset:30720
    v_mfma_f32_16x16x32_bf16 v[60:63], v[220:223], v[76:79], v[60:63]
    s_waitcnt lgkmcnt(2)
    v_mfma_f32_16x16x32_bf16 v[56:59], v[224:227], v[64:67], v[56:59]
    ds_read_b128 v[76:79], v7 offset:31744
    v_mfma_f32_16x16x32_bf16 v[60:63], v[228:231], v[64:67], v[60:63]
    s_waitcnt lgkmcnt(2)
    v_mfma_f32_16x16x32_bf16 v[56:59], v[232:235], v[68:71], v[56:59]
    v_mfma_f32_16x16x32_bf16 v[60:63], v[236:239], v[68:71], v[60:63]
    s_waitcnt lgkmcnt(1)
    v_mfma_f32_16x16x32_bf16 v[56:59], v[240:243], v[72:75], v[56:59]
    v_mfma_f32_16x16x32_bf16 v[60:63], v[244:247], v[72:75], v[60:63]
    s_waitcnt lgkmcnt(0)
    v_mfma_f32_16x16x32_bf16 v[56:59], v[248:251], v[76:79], v[56:59]
    v_mfma_f32_16x16x32_bf16 v[60:63], v[252:255], v[76:79], v[60:63]
    s_nop 7
    v_cvt_pk_bf16_f32 v100, v56, v60
    v_cvt_pk_bf16_f32 v101, v57, v61
    v_cvt_pk_bf16_f32 v102, v58, v62
    v_cvt_pk_bf16_f32 v103, v59, v63
    s_add_u32 s25, s33, 4096
    buffer_store_dwordx4 v[100:103], v2, s[8:11], s25 offen
    v_xor_b32 v7, 0x8000, v7
    s_waitcnt vmcnt(2)
    s_barrier
    s_sub_u32 s25, s30, 4
    s_cmp_ge_u32 s25, 60
    s_cbranch_scc1 L_sigkv2
    s_cmp_lg_u32 s21, 0
    s_cbranch_scc1 L_sigkv2
    s_mov_b64 exec, 1
    s_lshl_b32 s25, s30, 8
    s_add_u32 s25, s25, 1179648
    v_mov_b32 v8, s25
    v_mov_b32 v9, 1
    buffer_atomic_add v9, v8, s[8:11], 0 offen
    s_mov_b64 exec, -1
L_sigkv2:
    s_add_u32 s30, s30, 4
    s_cmp_lt_u32 s30, 24
    s_cbranch_scc1 L_p1b
    s_cmp_lt_u32 s30, 64
    s_cbranch_scc1 L_p1_more
    s_waitcnt vmcnt(0)
    s_barrier
L_p1_more:
    s_cmp_ge_u32 s30, 28
    s_cbranch_scc1 L_p2
    v_lshrrev_b32 v10, 2, v3
    v_and_b32 v11, 1, v3
    v_lshl_add_u32 v10, v10, 1, v11
    v_mul_u32_u24 v10, 1056, v10
    v_lshl_add_u32 v13, v4, 4, v10
    v_lshl_add_u32 v5, v4, 6, v10
    v_and_b32 v11, 2, v3
    v_lshl_add_u32 v5, v11, 4, v5
    s_lshl_b32 s25, s21, 8
    v_add_u32 v5, s25, v5
    v_mov_b32 v14, 0xff800000
    v_lshrrev_b32 v124, 1, v2
    v_lshrrev_b32 v15, 1, v1
    s_and_b32 s25, s21, 2
    s_lshl_b32 s37, s25, 10
    s_lshl_b32 s25, s25, 9
    v_add_u32 v15, s25, v15
    s_and_b32 s25, s21, 1
    s_lshl_b32 s36, s25, 12
    s_lshl_b32 s38, s25, 17
    s_add_u32 s38, s38, s37
    s_lshl_b32 s27, s28, 12
    s_add_u32 s38, s38, s27
    s_add_u32 s38, s38, 71303168
    s_lshl_b32 s25, s25, 4
    v_lshlrev_b32 v10, 2, v4
    v_sub_u32 v10, v3, v10
    v_add_u32 v10, s25, v10
    s_mov_b32 s34, 0x3e0293ee
    v_cmp_le_i32 s[52:53], 0, v10
    v_cmp_le_i32 s[54:55], 1, v10
    v_cmp_le_i32 s[56:57], 2, v10
    v_cmp_le_i32 s[58:59], 3, v10
    v_cmp_le_i32 s[60:61], 16, v10
    v_cmp_le_i32 s[62:63], 17, v10
    v_cmp_le_i32 s[64:65], 18, v10
    v_cmp_le_i32 s[66:67], 19, v10
    s_cmp_lg_u32 s21, 0
    s_cbranch_scc1 L_wdinit_ok
    v_mov_b32 v10, 0
L_wdinit:
    buffer_load_dword v11, v10, s[12:15], 0 offen offset:36 sc1
    s_waitcnt vmcnt(0)
    v_readfirstlane_b32 s25, v11
    s_cmp_ge_u32 s25, 32
    s_cbranch_scc1 L_wdinit_ok
    s_sleep 2
    s_add_u32 s26, s26, 1
    s_cmp_lt_u32 s26, 400000
    s_cbranch_scc1 L_wdinit
L_wdinit_ok:
    s_barrier
    s_nop 1
    s_mov_b32 s41, s29
L_p2:
    s_lshl_b32 s32, s41, 5
    s_add_u32 s32, s32, s28
    s_lshl_b32 s33, s32, 13
    s_add_u32 s33, s33, 52428800
    s_add_u32 s33, s33, s36
    s_lshl_b32 s32, s32, 14
    s_add_u32 s32, s32, 16777216
    buffer_load_dwordx4 v[16:19], v1, s[8:11], s33 offen offset:0 sc1
    buffer_load_dwordx4 v[20:23], v1, s[8:11], s33 offen offset:1024 sc1
    buffer_load_dwordx4 v[24:27], v1, s[8:11], s33 offen offset:2048 sc1
    buffer_load_dwordx4 v[28:31], v1, s[8:11], s33 offen offset:3072 sc1
    buffer_load_dwordx4 v[32:35], v1, s[8:11], s32 offen offset:0 sc1
    buffer_load_dwordx4 v[36:39], v1, s[8:11], s32 offen offset:1024 sc1
    buffer_load_dwordx4 v[40:43], v1, s[8:11], s32 offen offset:2048 sc1
    buffer_load_dwordx4 v[44:47], v1, s[8:11], s32 offen offset:3072 sc1
    s_add_u32 s32, s32, 4096
    buffer_load_dwordx4 v[48:51], v1, s[8:11], s32 offen offset:0 sc1
    buffer_load_dwordx4 v[52:55], v1, s[8:11], s32 offen offset:1024 sc1
    buffer_load_dwordx4 v[56:59], v1, s[8:11], s32 offen offset:2048 sc1
    buffer_load_dwordx4 v[60:63], v1, s[8:11], s32 offen offset:3072 sc1
    s_add_u32 s32, s32, s37
    s_add_u32 s32, s32, 4096
    buffer_load_dwordx4 v[64:67], v1, s[8:11], s32 offen offset:0 sc1
    buffer_load_dwordx4 v[72:75], v1, s[8:11], s32 offen offset:1024 sc1
    s_add_u32 s32, s32, 4096
    buffer_load_dwordx4 v[68:71], v1, s[8:11], s32 offen offset:0 sc1
    buffer_load_dwordx4 v[76:79], v1, s[8:11], s32 offen offset:1024 sc1
    s_waitcnt vmcnt(4)
    v_mfma_f32_16x16x32_bf16 v[80:83], v[32:35], v[16:19], 0
    v_mfma_f32_16x16x32_bf16 v[84:87], v[48:51], v[16:19], 0
    v_mfma_f32_16x16x32_bf16 v[80:83], v[36:39], v[20:23], v[80:83]
    v_mfma_f32_16x16x32_bf16 v[84:87], v[52:55], v[20:23], v[84:87]
    v_mfma_f32_16x16x32_bf16 v[80:83], v[40:43], v[24:27], v[80:83]
    v_mfma_f32_16x16x32_bf16 v[84:87], v[56:59], v[24:27], v[84:87]
    v_mfma_f32_16x16x32_bf16 v[80:83], v[44:47], v[28:31], v[80:83]
    v_mfma_f32_16x16x32_bf16 v[84:87], v[60:63], v[28:31], v[84:87]
    s_lshl_b32 s32, s41, 13
    s_add_u32 s32, s32, 1572864
    s_add_u32 s33, s32, 4096
    s_nop 0
    v_cndmask_b32 v80, v14, v80, s[52:53]
    v_cndmask_b32 v81, v14, v81, s[54:55]
    v_cndmask_b32 v82, v14, v82, s[56:57]
    v_cndmask_b32 v83, v14, v83, s[58:59]
    v_cndmask_b32 v84, v14, v84, s[60:61]
    v_cndmask_b32 v85, v14, v85, s[62:63]
    v_cndmask_b32 v86, v14, v86, s[64:65]
    v_cndmask_b32 v87, v14, v87, s[66:67]
    v_max3_f32 v12, v80, v81, v82
    v_max3_f32 v12, v12, v83, v84
    v_max3_f32 v12, v12, v85, v86
    v_max_f32 v12, v12, v87
    s_cmp_lg_u32 s21, 0
    s_cbranch_scc1 L_p2_pre_ok
    v_mov_b32 v11, 0
    s_sub_u32 s31, s32, 4096
    s_max_u32 s31, s31, 1572864
L_p2_pre:
    buffer_load_dword v10, v11, s[8:11], s31 offen sc1
    s_waitcnt vmcnt(0)
    v_cmp_eq_u32 vcc, -1, v10
    s_cbranch_vccz L_p2_pre_ok
    s_sleep 8
    s_add_u32 s26, s26, 1
    s_cmp_lt_u32 s26, 400000
    s_cbranch_scc1 L_p2_pre
L_p2_pre_ok:
    s_barrier
L_p2_poll:
    buffer_load_dwordx4 v[108:111], v2, s[8:11], s32 offen sc1
    buffer_load_dwordx4 v[112:115], v2, s[8:11], s33 offen sc1
    s_waitcnt vmcnt(0)
    v_max3_u32 v10, v108, v109, v110
    v_max3_u32 v10, v10, v111, v112
    v_max3_u32 v10, v10, v113, v114
    v_max_u32 v10, v10, v115
    v_cmp_eq_u32 vcc, -1, v10
    s_cbranch_vccz L_p2_got
    s_sleep 2
    s_add_u32 s26, s26, 1
    s_cmp_lt_u32 s26, 400000
    s_cbranch_scc1 L_p2_poll
    s_branch L_end
L_p2_got:
    ds_write2_b64 v5, v[108:109], v[110:111] offset0:0 offset1:2
    ds_write2_b64 v5, v[112:113], v[114:115] offset0:1 offset1:3
    s_waitcnt lgkmcnt(0)
    s_barrier
    ds_read_b128 v[108:111], v13 offset:0
    ds_read_b128 v[112:115], v13 offset:64
    ds_read_b128 v[116:119], v13 offset:128
    s_waitcnt lgkmcnt(2)
    v_mfma_f32_16x16x32_bf16 v[92:95], a[0:3], v[108:111], 0
    ds_read_b128 v[120:123], v13 offset:192
    v_mfma_f32_16x16x32_bf16 v[96:99], a[4:7], v[108:111], 0
    v_mfma_f32_16x16x32_bf16 v[100:103], v[108:111], a[128:131], 0
    v_mfma_f32_16x16x32_bf16 v[104:107], v[108:111], a[132:135], 0
    s_waitcnt lgkmcnt(2)
    v_mfma_f32_16x16x32_bf16 v[92:95], a[8:11], v[112:115], v[92:95]
    ds_read_b128 v[108:111], v13 offset:256
    v_mfma_f32_16x16x32_bf16 v[96:99], a[12:15], v[112:115], v[96:99]
    v_mfma_f32_16x16x32_bf16 v[100:103], v[112:115], a[136:139], v[100:103]
    v_mfma_f32_16x16x32_bf16 v[104:107], v[112:115], a[140:143], v[104:107]
    s_waitcnt lgkmcnt(2)
    v_mfma_f32_16x16x32_bf16 v[92:95], a[16:19], v[116:119], v[92:95]
    ds_read_b128 v[112:115], v13 offset:320
    v_mfma_f32_16x16x32_bf16 v[96:99], a[20:23], v[116:119], v[96:99]
    v_mfma_f32_16x16x32_bf16 v[100:103], v[116:119], a[144:147], v[100:103]
    v_mfma_f32_16x16x32_bf16 v[104:107], v[116:119], a[148:151], v[104:107]
    s_waitcnt lgkmcnt(2)
    v_mfma_f32_16x16x32_bf16 v[92:95], a[24:27], v[120:123], v[92:95]
    ds_read_b128 v[116:119], v13 offset:384
    v_mfma_f32_16x16x32_bf16 v[96:99], a[28:31], v[120:123], v[96:99]
    v_mfma_f32_16x16x32_bf16 v[100:103], v[120:123], a[152:155], v[100:103]
    v_mfma_f32_16x16x32_bf16 v[104:107], v[120:123], a[156:159], v[104:107]
    s_waitcnt lgkmcnt(2)
    v_mfma_f32_16x16x32_bf16 v[92:95], a[32:35], v[108:111], v[92:95]
    ds_read_b128 v[120:123], v13 offset:448
    v_mfma_f32_16x16x32_bf16 v[96:99], a[36:39], v[108:111], v[96:99]
    v_mfma_f32_16x16x32_bf16 v[100:103], v[108:111], a[160:163], v[100:103]
    v_mfma_f32_16x16x32_bf16 v[104:107], v[108:111], a[164:167], v[104:107]
    s_waitcnt lgkmcnt(2)
    v_mfma_f32_16x16x32_bf16 v[92:95], a[40:43], v[112:115], v[92:95]
    ds_read_b128 v[108:111], v13 offset:512
    v_mfma_f32_16x16x32_bf16 v[96:99], a[44:47], v[112:115], v[96:99]
    v_mfma_f32_16x16x32_bf16 v[100:103], v[112:115], a[168:171], v[100:103]
    v_mfma_f32_16x16x32_bf16 v[104:107], v[112:115], a[172:175], v[104:107]
    s_waitcnt lgkmcnt(2)
    v_mfma_f32_16x16x32_bf16 v[92:95], a[48:51], v[116:119], v[92:95]
    ds_read_b128 v[112:115], v13 offset:576
    v_mfma_f32_16x16x32_bf16 v[96:99], a[52:55], v[116:119], v[96:99]
    v_mfma_f32_16x16x32_bf16 v[100:103], v[116:119], a[176:179], v[100:103]
    v_mfma_f32_16x16x32_bf16 v[104:107], v[116:119], a[180:183], v[104:107]
    s_waitcnt lgkmcnt(2)
    v_mfma_f32_16x16x32_bf16 v[92:95], a[56:59], v[120:123], v[92:95]
    ds_read_b128 v[116:119], v13 offset:640
    v_mfma_f32_16x16x32_bf16 v[96:99], a[60:63], v[120:123], v[96:99]
    v_mfma_f32_16x16x32_bf16 v[100:103], v[120:123], a[184:187], v[100:103]
    v_mfma_f32_16x16x32_bf16 v[104:107], v[120:123], a[188:191], v[104:107]
    s_waitcnt lgkmcnt(2)
    v_mfma_f32_16x16x32_bf16 v[92:95], a[64:67], v[108:111], v[92:95]
    ds_read_b128 v[120:123], v13 offset:704
    v_mfma_f32_16x16x32_bf16 v[96:99], a[68:71], v[108:111], v[96:99]
    v_mfma_f32_16x16x32_bf16 v[100:103], v[108:111], a[192:195], v[100:103]
    v_mfma_f32_16x16x32_bf16 v[104:107], v[108:111], a[196:199], v[104:107]
    s_waitcnt lgkmcnt(2)
    v_mfma_f32_16x16x32_bf16 v[92:95], a[72:75], v[112:115], v[92:95]
    ds_read_b128 v[108:111], v13 offset:768
    v_mfma_f32_16x16x32_bf16 v[96:99], a[76:79], v[112:115], v[96:99]
    v_mfma_f32_16x16x32_bf16 v[100:103], v[112:115], a[200:203], v[100:103]
    v_mfma_f32_16x16x32_bf16 v[104:107], v[112:115], a[204:207], v[104:107]
    s_waitcnt lgkmcnt(2)
    v_mfma_f32_16x16x32_bf16 v[92:95], a[80:83], v[116:119], v[92:95]
    ds_read_b128 v[112:115], v13 offset:832
    v_mfma_f32_16x16x32_bf16 v[96:99], a[84:87], v[116:119], v[96:99]
    v_mfma_f32_16x16x32_bf16 v[100:103], v[116:119], a[208:211], v[100:103]
    v_mfma_f32_16x16x32_bf16 v[104:107], v[116:119], a[212:215], v[104:107]
    s_waitcnt lgkmcnt(2)
    v_mfma_f32_16x16x32_bf16 v[92:95], a[88:91], v[120:123], v[92:95]
    ds_read_b128 v[116:119], v13 offset:896
    v_mfma_f32_16x16x32_bf16 v[96:99], a[92:95], v[120:123], v[96:99]
    v_mfma_f32_16x16x32_bf16 v[100:103], v[120:123], a[216:219], v[100:103]
    v_mfma_f32_16x16x32_bf16 v[104:107], v[120:123], a[220:223], v[104:107]
    s_waitcnt lgkmcnt(2)
    v_mfma_f32_16x16x32_bf16 v[92:95], a[96:99], v[108:111], v[92:95]
    ds_read_b128 v[120:123], v13 offset:960
    v_mfma_f32_16x16x32_bf16 v[96:99], a[100:103], v[108:111], v[96:99]
    v_mfma_f32_16x16x32_bf16 v[100:103], v[108:111], a[224:227], v[100:103]
    v_mfma_f32_16x16x32_bf16 v[104:107], v[108:111], a[228:231], v[104:107]
    s_waitcnt lgkmcnt(2)
    v_mfma_f32_16x16x32_bf16 v[92:95], a[104:107], v[112:115], v[92:95]
    v_mfma_f32_16x16x32_bf16 v[96:99], a[108:111], v[112:115], v[96:99]
    v_mfma_f32_16x16x32_bf16 v[100:103], v[112:115], a[232:235], v[100:103]
    v_mfma_f32_16x16x32_bf16 v[104:107], v[112:115], a[236:239], v[104:107]
    s_waitcnt lgkmcnt(1)
    v_mfma_f32_16x16x32_bf16 v[92:95], a[112:115], v[116:119], v[92:95]
    v_mfma_f32_16x16x32_bf16 v[96:99], a[116:119], v[116:119], v[96:99]
    v_mfma_f32_16x16x32_bf16 v[100:103], v[116:119], a[240:243], v[100:103]
    v_mfma_f32_16x16x32_bf16 v[104:107], v[116:119], a[244:247], v[104:107]
    s_waitcnt lgkmcnt(0)
    v_mfma_f32_16x16x32_bf16 v[92:95], a[120:123], v[120:123], v[92:95]
    v_mfma_f32_16x16x32_bf16 v[96:99], a[124:127], v[120:123], v[96:99]
    v_mfma_f32_16x16x32_bf16 v[100:103], v[120:123], a[248:251], v[100:103]
    v_mfma_f32_16x16x32_bf16 v[104:107], v[120:123], a[252:255], v[104:107]
    v_cvt_pk_bf16_f32 v92, v92, v96
    v_cvt_pk_bf16_f32 v93, v93, v97
    v_cvt_pk_bf16_f32 v94, v94, v98
    v_cvt_pk_bf16_f32 v95, v95, v99
    ds_write_b128 v2, v[92:95] offset:8704
    v_cvt_pk_bf16_f32 v100, v100, v101
    s_nop 1
    v_cvt_pk_bf16_f32 v101, v104, v105
    ds_write_b64 v124, v[100:101] offset:12800
    v_mov_b32 v56, 0x3f803f80
    v_mov_b32 v57, 0x3f803f80
    v_mov_b32 v58, 0x3f803f80
    v_mov_b32 v59, 0x3f803f80
    s_waitcnt lgkmcnt(0)
    s_barrier
    ds_read_b128 v[32:35], v1 offset:8704
    ds_read_b128 v[36:39], v1 offset:9728
    ds_read_b128 v[40:43], v1 offset:10752
    ds_read_b128 v[44:47], v1 offset:11776
    ds_read_b32 v48, v15 offset:12800
    v_mov_b32 v49, 0
    ds_read_b32 v50, v15 offset:12804
    v_mov_b32 v51, 0
    ds_read_b32 v52, v15 offset:13312
    v_mov_b32 v53, 0
    ds_read_b32 v54, v15 offset:13316
    v_mov_b32 v55, 0
    s_waitcnt lgkmcnt(7)
    v_mfma_f32_16x16x32_bf16 v[88:91], v[32:35], v[16:19], 0
    s_waitcnt lgkmcnt(6)
    v_mfma_f32_16x16x32_bf16 v[88:91], v[36:39], v[20:23], v[88:91]
    s_waitcnt lgkmcnt(5)
    v_mfma_f32_16x16x32_bf16 v[88:91], v[40:43], v[24:27], v[88:91]
    s_waitcnt lgkmcnt(4)
    v_mfma_f32_16x16x32_bf16 v[88:91], v[44:47], v[28:31], v[88:91]
    s_nop 7
    v_max3_f32 v10, v12, v88, v89
    v_mov_b32 v11, v10
    s_nop 1
    v_permlane32_swap_b32 v10, v11
    v_max_f32 v10, v10, v11
    v_mov_b32 v11, v10
    s_nop 1
    v_permlane16_swap_b32 v10, v11
    v_max_f32 v10, v10, v11
    v_mul_f32 v10, s34, v10
    v_fma_f32 v80, v80, s34, -v10
    v_fma_f32 v81, v81, s34, -v10
    v_fma_f32 v82, v82, s34, -v10
    v_fma_f32 v83, v83, s34, -v10
    v_fma_f32 v84, v84, s34, -v10
    v_fma_f32 v85, v85, s34, -v10
    v_fma_f32 v86, v86, s34, -v10
    v_fma_f32 v87, v87, s34, -v10
    v_fma_f32 v88, v88, s34, -v10
    v_fma_f32 v89, v89, s34, -v10
    v_exp_f32 v80, v80
    v_exp_f32 v81, v81
    v_exp_f32 v82, v82
    v_exp_f32 v83, v83
    v_exp_f32 v84, v84
    v_exp_f32 v85, v85
    v_exp_f32 v86, v86
    v_exp_f32 v87, v87
    v_exp_f32 v88, v88
    v_exp_f32 v89, v89
    v_cvt_pk_bf16_f32 v80, v80, v81
    v_cvt_pk_bf16_f32 v81, v82, v83
    v_cvt_pk_bf16_f32 v82, v84, v85
    v_cvt_pk_bf16_f32 v83, v86, v87
    v_cvt_pk_bf16_f32 v88, v88, v89
    v_mov_b32 v89, 0
    s_waitcnt lgkmcnt(0)
    v_mfma_f32_16x16x32_bf16 v[108:111], v[56:59], v[80:83], 0
    v_mfma_f32_16x16x32_bf16 v[92:95], v[64:67], v[80:83], 0
    v_mfma_f32_16x16x32_bf16 v[96:99], v[68:71], v[80:83], 0
    v_mfma_f32_16x16x32_bf16 v[100:103], v[72:75], v[80:83], 0
    v_mfma_f32_16x16x32_bf16 v[104:107], v[76:79], v[80:83], 0
    v_mfma_f32_16x16x16_bf16 v[108:111], v[56:57], v[88:89], v[108:111]
    v_mfma_f32_16x16x16_bf16 v[92:95], v[48:49], v[88:89], v[92:95]
    v_mfma_f32_16x16x16_bf16 v[96:99], v[50:51], v[88:89], v[96:99]
    v_mfma_f32_16x16x16_bf16 v[100:103], v[52:53], v[88:89], v[100:103]
    v_mfma_f32_16x16x16_bf16 v[104:107], v[54:55], v[88:89], v[104:107]
    v_rcp_f32 v10, v108
    s_lshl_b32 s32, s41, 18
    s_add_u32 s32, s32, s38
    v_mul_f32 v92, v92, v10
    v_mul_f32 v93, v93, v10
    v_mul_f32 v94, v94, v10
    v_mul_f32 v95, v95, v10
    v_mul_f32 v96, v96, v10
    v_mul_f32 v97, v97, v10
    v_mul_f32 v98, v98, v10
    v_mul_f32 v99, v99, v10
    v_cvt_pk_bf16_f32 v92, v92, v96
    v_cvt_pk_bf16_f32 v93, v93, v97
    v_cvt_pk_bf16_f32 v94, v94, v98
    v_cvt_pk_bf16_f32 v95, v95, v99
    buffer_store_dwordx4 v[92:95], v1, s[8:11], s32 offen offset:0 sc1
    v_mul_f32 v100, v100, v10
    v_mul_f32 v101, v101, v10
    v_mul_f32 v102, v102, v10
    v_mul_f32 v103, v103, v10
    v_mul_f32 v104, v104, v10
    v_mul_f32 v105, v105, v10
    v_mul_f32 v106, v106, v10
    v_mul_f32 v107, v107, v10
    v_cvt_pk_bf16_f32 v100, v100, v104
    v_cvt_pk_bf16_f32 v101, v101, v105
    v_cvt_pk_bf16_f32 v102, v102, v106
    v_cvt_pk_bf16_f32 v103, v103, v107
    buffer_store_dwordx4 v[100:103], v1, s[8:11], s32 offen offset:1024 sc1
    s_waitcnt vmcnt(0)
    s_barrier
    s_cmp_lg_u32 s21, 0
    s_cbranch_scc1 L_sigo
    s_mov_b64 exec, 1
    s_lshl_b32 s25, s41, 8
    s_add_u32 s25, s25, 1179776
    v_mov_b32 v10, s25
    v_mov_b32 v11, 1
    buffer_atomic_add v11, v10, s[8:11], 0 offen
    s_mov_b64 exec, -1
L_sigo:
    s_add_u32 s41, s41, 4
    s_cmp_lt_u32 s30, 64
    s_cbranch_scc1 L_p1b
    s_cmp_lt_u32 s41, 64
    s_cbranch_scc1 L_p2
    s_branch L_end
L_qload:
    s_add_u32 m0, s36, 49152
    s_mov_b32 s25, 1048576
    buffer_load_dwordx4 v12, s[16:19], s25 offen lds
    s_add_u32 m0, s36, 50176
    s_mov_b32 s25, 1081344
    buffer_load_dwordx4 v12, s[16:19], s25 offen lds
    s_add_u32 m0, s36, 51200
    s_mov_b32 s25, 1114112
    buffer_load_dwordx4 v12, s[16:19], s25 offen lds
    s_add_u32 m0, s36, 52224
    s_mov_b32 s25, 1146880
    buffer_load_dwordx4 v12, s[16:19], s25 offen lds
    s_add_u32 m0, s36, 65536
    s_mov_b32 s25, 1572864
    buffer_load_dwordx4 v12, s[16:19], s25 offen lds
    s_add_u32 m0, s36, 66560
    s_mov_b32 s25, 1605632
    buffer_load_dwordx4 v12, s[16:19], s25 offen lds
    s_add_u32 m0, s36, 67584
    s_mov_b32 s25, 1638400
    buffer_load_dwordx4 v12, s[16:19], s25 offen lds
    s_add_u32 m0, s36, 68608
    s_mov_b32 s25, 1671168
    buffer_load_dwordx4 v12, s[16:19], s25 offen lds
    s_add_u32 m0, s36, 0
    s_mov_b32 s25, 2097152
    buffer_load_dwordx4 v12, s[16:19], s25 offen lds
    s_add_u32 m0, s36, 1024
    s_mov_b32 s25, 2129920
    buffer_load_dwordx4 v12, s[16:19], s25 offen lds
    s_add_u32 m0, s36, 2048
    s_mov_b32 s25, 2162688
    buffer_load_dwordx4 v12, s[16:19], s25 offen lds
    s_add_u32 m0, s36, 3072
    s_mov_b32 s25, 2195456
    buffer_load_dwordx4 v12, s[16:19], s25 offen lds
    s_waitcnt vmcnt(12) lgkmcnt(0)
    s_barrier
    s_cmp_lg_u32 s21, 0
    s_cbranch_scc1 L_sigkv3
    s_mov_b64 exec, 1
    s_lshl_b32 s25, s30, 8
    s_add_u32 s25, s25, 1179648
    v_mov_b32 v8, s25
    v_mov_b32 v9, 1
    buffer_atomic_add v9, v8, s[8:11], 0 offen
    s_mov_b64 exec, -1
L_sigkv3:
    s_barrier
    ds_read2st64_b32 v[16:17], v13 offset0:64 offset1:65
    ds_read2st64_b32 v[18:19], v13 offset0:66 offset1:67
    ds_read2st64_b32 v[20:21], v13 offset0:68 offset1:69
    ds_read2st64_b32 v[22:23], v13 offset0:70 offset1:71
    ds_read2st64_b32 v[24:25], v13 offset0:96 offset1:97
    ds_read2st64_b32 v[26:27], v13 offset0:98 offset1:99
    ds_read2st64_b32 v[28:29], v13 offset0:100 offset1:101
    ds_read2st64_b32 v[30:31], v13 offset0:102 offset1:103
    s_waitcnt lgkmcnt(6)
    v_perm_b32 v128, v17, v16, s39
    v_perm_b32 v132, v17, v16, s40
    v_perm_b32 v129, v19, v18, s39
    v_perm_b32 v133, v19, v18, s40
    s_waitcnt lgkmcnt(4)
    v_perm_b32 v130, v21, v20, s39
    v_perm_b32 v134, v21, v20, s40
    v_perm_b32 v131, v23, v22, s39
    v_perm_b32 v135, v23, v22, s40
    s_waitcnt lgkmcnt(2)
    v_perm_b32 v136, v25, v24, s39
    v_perm_b32 v140, v25, v24, s40
    v_perm_b32 v137, v27, v26, s39
    v_perm_b32 v141, v27, v26, s40
    s_waitcnt lgkmcnt(0)
    v_perm_b32 v138, v29, v28, s39
    v_perm_b32 v142, v29, v28, s40
    v_perm_b32 v139, v31, v30, s39
    v_perm_b32 v143, v31, v30, s40
    s_barrier
    s_add_u32 m0, s36, 16384
    s_mov_b32 s25, 2621440
    buffer_load_dwordx4 v12, s[16:19], s25 offen lds
    s_add_u32 m0, s36, 17408
    s_mov_b32 s25, 2654208
    buffer_load_dwordx4 v12, s[16:19], s25 offen lds
    s_add_u32 m0, s36, 18432
    s_mov_b32 s25, 2686976
    buffer_load_dwordx4 v12, s[16:19], s25 offen lds
    s_add_u32 m0, s36, 19456
    s_mov_b32 s25, 2719744
    buffer_load_dwordx4 v12, s[16:19], s25 offen lds
    ds_read2st64_b32 v[16:17], v13 offset0:128 offset1:129
    ds_read2st64_b32 v[18:19], v13 offset0:130 offset1:131
    ds_read2st64_b32 v[20:21], v13 offset0:132 offset1:133
    ds_read2st64_b32 v[22:23], v13 offset0:134 offset1:135
    ds_read2st64_b32 v[24:25], v13 offset0:160 offset1:161
    ds_read2st64_b32 v[26:27], v13 offset0:162 offset1:163
    ds_read2st64_b32 v[28:29], v13 offset0:164 offset1:165
    ds_read2st64_b32 v[30:31], v13 offset0:166 offset1:167
    s_waitcnt lgkmcnt(6)
    v_perm_b32 v144, v17, v16, s39
    v_perm_b32 v148, v17, v16, s40
    v_perm_b32 v145, v19, v18, s39
    v_perm_b32 v149, v19, v18, s40
    s_waitcnt lgkmcnt(4)
    v_perm_b32 v146, v21, v20, s39
    v_perm_b32 v150, v21, v20, s40
    v_perm_b32 v147, v23, v22, s39
    v_perm_b32 v151, v23, v22, s40
    s_waitcnt lgkmcnt(2)
    v_perm_b32 v152, v25, v24, s39
    v_perm_b32 v156, v25, v24, s40
    v_perm_b32 v153, v27, v26, s39
    v_perm_b32 v157, v27, v26, s40
    s_waitcnt lgkmcnt(0)
    v_perm_b32 v154, v29, v28, s39
    v_perm_b32 v158, v29, v28, s40
    v_perm_b32 v155, v31, v30, s39
    v_perm_b32 v159, v31, v30, s40
    s_waitcnt vmcnt(12)
    s_barrier
    s_add_u32 m0, s36, 32768
    s_mov_b32 s25, 3145728
    buffer_load_dwordx4 v12, s[16:19], s25 offen lds
    s_add_u32 m0, s36, 33792
    s_mov_b32 s25, 3178496
    buffer_load_dwordx4 v12, s[16:19], s25 offen lds
    s_add_u32 m0, s36, 34816
    s_mov_b32 s25, 3211264
    buffer_load_dwordx4 v12, s[16:19], s25 offen lds
    s_add_u32 m0, s36, 35840
    s_mov_b32 s25, 3244032
    buffer_load_dwordx4 v12, s[16:19], s25 offen lds
    ds_read2st64_b32 v[16:17], v14 offset0:0 offset1:1
    ds_read2st64_b32 v[18:19], v14 offset0:2 offset1:3
    ds_read2st64_b32 v[20:21], v14 offset0:4 offset1:5
    ds_read2st64_b32 v[22:23], v14 offset0:6 offset1:7
    ds_read2st64_b32 v[24:25], v14 offset0:32 offset1:33
    ds_read2st64_b32 v[26:27], v14 offset0:34 offset1:35
    ds_read2st64_b32 v[28:29], v14 offset0:36 offset1:37
    ds_read2st64_b32 v[30:31], v14 offset0:38 offset1:39
    s_waitcnt lgkmcnt(6)
    v_perm_b32 v160, v17, v16, s39
    v_perm_b32 v164, v17, v16, s40
    v_perm_b32 v161, v19, v18, s39
    v_perm_b32 v165, v19, v18, s40
    s_waitcnt lgkmcnt(4)
    v_perm_b32 v162, v21, v20, s39
    v_perm_b32 v166, v21, v20, s40
    v_perm_b32 v163, v23, v22, s39
    v_perm_b32 v167, v23, v22, s40
    s_waitcnt lgkmcnt(2)
    v_perm_b32 v168, v25, v24, s39
    v_perm_b32 v172, v25, v24, s40
    v_perm_b32 v169, v27, v26, s39
    v_perm_b32 v173, v27, v26, s40
    s_waitcnt lgkmcnt(0)
    v_perm_b32 v170, v29, v28, s39
    v_perm_b32 v174, v29, v28, s40
    v_perm_b32 v171, v31, v30, s39
    v_perm_b32 v175, v31, v30, s40
    s_waitcnt vmcnt(12)
    s_barrier
    s_add_u32 m0, s36, 49152
    s_mov_b32 s25, 3670016
    buffer_load_dwordx4 v12, s[16:19], s25 offen lds
    s_add_u32 m0, s36, 50176
    s_mov_b32 s25, 3702784
    buffer_load_dwordx4 v12, s[16:19], s25 offen lds
    s_add_u32 m0, s36, 51200
    s_mov_b32 s25, 3735552
    buffer_load_dwordx4 v12, s[16:19], s25 offen lds
    s_add_u32 m0, s36, 52224
    s_mov_b32 s25, 3768320
    buffer_load_dwordx4 v12, s[16:19], s25 offen lds
    ds_read2st64_b32 v[16:17], v14 offset0:64 offset1:65
    ds_read2st64_b32 v[18:19], v14 offset0:66 offset1:67
    ds_read2st64_b32 v[20:21], v14 offset0:68 offset1:69
    ds_read2st64_b32 v[22:23], v14 offset0:70 offset1:71
    ds_read2st64_b32 v[24:25], v14 offset0:96 offset1:97
    ds_read2st64_b32 v[26:27], v14 offset0:98 offset1:99
    ds_read2st64_b32 v[28:29], v14 offset0:100 offset1:101
    ds_read2st64_b32 v[30:31], v14 offset0:102 offset1:103
    s_waitcnt lgkmcnt(6)
    v_perm_b32 v176, v17, v16, s39
    v_perm_b32 v180, v17, v16, s40
    v_perm_b32 v177, v19, v18, s39
    v_perm_b32 v181, v19, v18, s40
    s_waitcnt lgkmcnt(4)
    v_perm_b32 v178, v21, v20, s39
    v_perm_b32 v182, v21, v20, s40
    v_perm_b32 v179, v23, v22, s39
    v_perm_b32 v183, v23, v22, s40
    s_waitcnt lgkmcnt(2)
    v_perm_b32 v184, v25, v24, s39
    v_perm_b32 v188, v25, v24, s40
    v_perm_b32 v185, v27, v26, s39
    v_perm_b32 v189, v27, v26, s40
    s_waitcnt lgkmcnt(0)
    v_perm_b32 v186, v29, v28, s39
    v_perm_b32 v190, v29, v28, s40
    v_perm_b32 v187, v31, v30, s39
    v_perm_b32 v191, v31, v30, s40
    s_waitcnt vmcnt(12)
    s_barrier
    ds_read2st64_b32 v[16:17], v13 offset0:0 offset1:1
    ds_read2st64_b32 v[18:19], v13 offset0:2 offset1:3
    ds_read2st64_b32 v[20:21], v13 offset0:4 offset1:5
    ds_read2st64_b32 v[22:23], v13 offset0:6 offset1:7
    ds_read2st64_b32 v[24:25], v13 offset0:32 offset1:33
    ds_read2st64_b32 v[26:27], v13 offset0:34 offset1:35
    ds_read2st64_b32 v[28:29], v13 offset0:36 offset1:37
    ds_read2st64_b32 v[30:31], v13 offset0:38 offset1:39
    s_waitcnt lgkmcnt(6)
    v_perm_b32 v192, v17, v16, s39
    v_perm_b32 v196, v17, v16, s40
    v_perm_b32 v193, v19, v18, s39
    v_perm_b32 v197, v19, v18, s40
    s_waitcnt lgkmcnt(4)
    v_perm_b32 v194, v21, v20, s39
    v_perm_b32 v198, v21, v20, s40
    v_perm_b32 v195, v23, v22, s39
    v_perm_b32 v199, v23, v22, s40
    s_waitcnt lgkmcnt(2)
    v_perm_b32 v200, v25, v24, s39
    v_perm_b32 v204, v25, v24, s40
    v_perm_b32 v201, v27, v26, s39
    v_perm_b32 v205, v27, v26, s40
    s_waitcnt lgkmcnt(0)
    v_perm_b32 v202, v29, v28, s39
    v_perm_b32 v206, v29, v28, s40
    v_perm_b32 v203, v31, v30, s39
    v_perm_b32 v207, v31, v30, s40
    s_waitcnt vmcnt(8)
    s_barrier
    ds_read2st64_b32 v[16:17], v13 offset0:64 offset1:65
    ds_read2st64_b32 v[18:19], v13 offset0:66 offset1:67
    ds_read2st64_b32 v[20:21], v13 offset0:68 offset1:69
    ds_read2st64_b32 v[22:23], v13 offset0:70 offset1:71
    ds_read2st64_b32 v[24:25], v13 offset0:96 offset1:97
    ds_read2st64_b32 v[26:27], v13 offset0:98 offset1:99
    ds_read2st64_b32 v[28:29], v13 offset0:100 offset1:101
    ds_read2st64_b32 v[30:31], v13 offset0:102 offset1:103
    s_waitcnt lgkmcnt(6)
    v_perm_b32 v208, v17, v16, s39
    v_perm_b32 v212, v17, v16, s40
    v_perm_b32 v209, v19, v18, s39
    v_perm_b32 v213, v19, v18, s40
    s_waitcnt lgkmcnt(4)
    v_perm_b32 v210, v21, v20, s39
    v_perm_b32 v214, v21, v20, s40
    v_perm_b32 v211, v23, v22, s39
    v_perm_b32 v215, v23, v22, s40
    s_waitcnt lgkmcnt(2)
    v_perm_b32 v216, v25, v24, s39
    v_perm_b32 v220, v25, v24, s40
    v_perm_b32 v217, v27, v26, s39
    v_perm_b32 v221, v27, v26, s40
    s_waitcnt lgkmcnt(0)
    v_perm_b32 v218, v29, v28, s39
    v_perm_b32 v222, v29, v28, s40
    v_perm_b32 v219, v31, v30, s39
    v_perm_b32 v223, v31, v30, s40
    s_waitcnt vmcnt(4)
    s_barrier
    ds_read2st64_b32 v[16:17], v13 offset0:128 offset1:129
    ds_read2st64_b32 v[18:19], v13 offset0:130 offset1:131
    ds_read2st64_b32 v[20:21], v13 offset0:132 offset1:133
    ds_read2st64_b32 v[22:23], v13 offset0:134 offset1:135
    ds_read2st64_b32 v[24:25], v13 offset0:160 offset1:161
    ds_read2st64_b32 v[26:27], v13 offset0:162 offset1:163
    ds_read2st64_b32 v[28:29], v13 offset0:164 offset1:165
    ds_read2st64_b32 v[30:31], v13 offset0:166 offset1:167
    s_waitcnt lgkmcnt(6)
    v_perm_b32 v224, v17, v16, s39
    v_perm_b32 v228, v17, v16, s40
    v_perm_b32 v225, v19, v18, s39
    v_perm_b32 v229, v19, v18, s40
    s_waitcnt lgkmcnt(4)
    v_perm_b32 v226, v21, v20, s39
    v_perm_b32 v230, v21, v20, s40
    v_perm_b32 v227, v23, v22, s39
    v_perm_b32 v231, v23, v22, s40
    s_waitcnt lgkmcnt(2)
    v_perm_b32 v232, v25, v24, s39
    v_perm_b32 v236, v25, v24, s40
    v_perm_b32 v233, v27, v26, s39
    v_perm_b32 v237, v27, v26, s40
    s_waitcnt lgkmcnt(0)
    v_perm_b32 v234, v29, v28, s39
    v_perm_b32 v238, v29, v28, s40
    v_perm_b32 v235, v31, v30, s39
    v_perm_b32 v239, v31, v30, s40
    s_waitcnt vmcnt(0)
    s_barrier
    ds_read2st64_b32 v[16:17], v14 offset0:0 offset1:1
    ds_read2st64_b32 v[18:19], v14 offset0:2 offset1:3
    ds_read2st64_b32 v[20:21], v14 offset0:4 offset1:5
    ds_read2st64_b32 v[22:23], v14 offset0:6 offset1:7
    ds_read2st64_b32 v[24:25], v14 offset0:32 offset1:33
    ds_read2st64_b32 v[26:27], v14 offset0:34 offset1:35
    ds_read2st64_b32 v[28:29], v14 offset0:36 offset1:37
    ds_read2st64_b32 v[30:31], v14 offset0:38 offset1:39
    s_waitcnt lgkmcnt(6)
    v_perm_b32 v240, v17, v16, s39
    v_perm_b32 v244, v17, v16, s40
    v_perm_b32 v241, v19, v18, s39
    v_perm_b32 v245, v19, v18, s40
    s_waitcnt lgkmcnt(4)
    v_perm_b32 v242, v21, v20, s39
    v_perm_b32 v246, v21, v20, s40
    v_perm_b32 v243, v23, v22, s39
    v_perm_b32 v247, v23, v22, s40
    s_waitcnt lgkmcnt(2)
    v_perm_b32 v248, v25, v24, s39
    v_perm_b32 v252, v25, v24, s40
    v_perm_b32 v249, v27, v26, s39
    v_perm_b32 v253, v27, v26, s40
    s_waitcnt lgkmcnt(0)
    v_perm_b32 v250, v29, v28, s39
    v_perm_b32 v254, v29, v28, s40
    v_perm_b32 v251, v31, v30, s39
    v_perm_b32 v255, v31, v30, s40
    s_branch L_qload_ret
L_orole:
    s_cmp_lt_u32 s24, 208
    s_cbranch_scc1 L_ln_go
    s_sub_u32 s25, s24, 192
    s_lshl_b32 s25, s25, 17
    s_mov_b32 s52, s86
    s_and_b32 s53, s87, 0xffff
    s_mov_b32 s54, 0x400000
    s_mov_b32 s55, 0x00020000
    buffer_load_dwordx4 v[128:131], v2, s[52:55], s25 offen
    s_add_u32 s25, s25, 4096
    buffer_load_dwordx4 v[132:135], v2, s[52:55], s25 offen
    s_add_u32 s25, s25, 4096
    buffer_load_dwordx4 v[136:139], v2, s[52:55], s25 offen
    s_add_u32 s25, s25, 4096
    buffer_load_dwordx4 v[140:143], v2, s[52:55], s25 offen
    s_add_u32 s25, s25, 4096
    buffer_load_dwordx4 v[144:147], v2, s[52:55], s25 offen
    s_add_u32 s25, s25, 4096
    buffer_load_dwordx4 v[148:151], v2, s[52:55], s25 offen
    s_add_u32 s25, s25, 4096
    buffer_load_dwordx4 v[152:155], v2, s[52:55], s25 offen
    s_add_u32 s25, s25, 4096
    buffer_load_dwordx4 v[156:159], v2, s[52:55], s25 offen
    s_add_u32 s25, s25, 4096
    buffer_load_dwordx4 v[128:131], v2, s[52:55], s25 offen
    s_add_u32 s25, s25, 4096
    buffer_load_dwordx4 v[132:135], v2, s[52:55], s25 offen
    s_add_u32 s25, s25, 4096
    buffer_load_dwordx4 v[136:139], v2, s[52:55], s25 offen
    s_add_u32 s25, s25, 4096
    buffer_load_dwordx4 v[140:143], v2, s[52:55], s25 offen
    s_add_u32 s25, s25, 4096
    buffer_load_dwordx4 v[144:147], v2, s[52:55], s25 offen
    s_add_u32 s25, s25, 4096
    buffer_load_dwordx4 v[148:151], v2, s[52:55], s25 offen
    s_add_u32 s25, s25, 4096
    buffer_load_dwordx4 v[152:155], v2, s[52:55], s25 offen
    s_add_u32 s25, s25, 4096
    buffer_load_dwordx4 v[156:159], v2, s[52:55], s25 offen
    s_add_u32 s25, s25, 4096
    buffer_load_dwordx4 v[128:131], v2, s[52:55], s25 offen
    s_add_u32 s25, s25, 4096
    buffer_load_dwordx4 v[132:135], v2, s[52:55], s25 offen
    s_add_u32 s25, s25, 4096
    buffer_load_dwordx4 v[136:139], v2, s[52:55], s25 offen
    s_add_u32 s25, s25, 4096
    buffer_load_dwordx4 v[140:143], v2, s[52:55], s25 offen
    s_add_u32 s25, s25, 4096
    buffer_load_dwordx4 v[144:147], v2, s[52:55], s25 offen
    s_add_u32 s25, s25, 4096
    buffer_load_dwordx4 v[148:151], v2, s[52:55], s25 offen
    s_add_u32 s25, s25, 4096
    buffer_load_dwordx4 v[152:155], v2, s[52:55], s25 offen
    s_add_u32 s25, s25, 4096
    buffer_load_dwordx4 v[156:159], v2, s[52:55], s25 offen
    s_add_u32 s25, s25, 4096
    buffer_load_dwordx4 v[128:131], v2, s[52:55], s25 offen
    s_add_u32 s25, s25, 4096
    buffer_load_dwordx4 v[132:135], v2, s[52:55], s25 offen
    s_add_u32 s25, s25, 4096
    buffer_load_dwordx4 v[136:139], v2, s[52:55], s25 offen
    s_add_u32 s25, s25, 4096
    buffer_load_dwordx4 v[140:143], v2, s[52:55], s25 offen
    s_add_u32 s25, s25, 4096
    buffer_load_dwordx4 v[144:147], v2, s[52:55], s25 offen
    s_add_u32 s25, s25, 4096
    buffer_load_dwordx4 v[148:151], v2, s[52:55], s25 offen
    s_add_u32 s25, s25, 4096
    buffer_load_dwordx4 v[152:155], v2, s[52:55], s25 offen
    s_add_u32 s25, s25, 4096
    buffer_load_dwordx4 v[156:159], v2, s[52:55], s25 offen
    s_add_u32 s25, s25, 4096
    s_branch L_ln_done
L_ln_go:
    s_mov_b32 s16, s88
    s_and_b32 s17, s89, 0xffff
    s_mov_b32 s18, 0x400
    s_mov_b32 s19, 0x00020000
    s_sub_u32 s32, s24, 144
    s_lshl_b32 s32, s32, 3
    s_add_u32 s32, s32, s21
    s_lshl_b32 s33, s32, 4
    s_lshl_b32 s32, s32, 12
    buffer_load_dwordx4 v[32:35], v1, s[16:19], 0 offen
    buffer_load_dwordx4 v[16:19], v1, s[44:47], s32 offen offset:0
    buffer_load_dwordx4 v[20:23], v1, s[44:47], s32 offen offset:1024
    buffer_load_dwordx4 v[24:27], v1, s[44:47], s32 offen offset:2048
    buffer_load_dwordx4 v[28:31], v1, s[44:47], s32 offen offset:3072
    s_add_u32 s25, s32, 16384
    buffer_load_dwordx4 v[100:103], v1, s[44:47], s25 offen offset:0
    buffer_load_dwordx4 v[104:107], v1, s[44:47], s25 offen offset:1024
    buffer_load_dwordx4 v[108:111], v1, s[44:47], s25 offen offset:2048
    buffer_load_dwordx4 v[112:115], v1, s[44:47], s25 offen offset:3072
    s_sub_u32 s25, s24, 144
    s_lshl_b32 s25, s25, 8
    s_add_u32 s25, s25, 1179648
    v_lshrrev_b32 v5, 2, v1
    v_mov_b32 v6, 0
    buffer_store_dword v6, v5, s[8:11], s25 offen sc1
    s_mov_b32 s30, 0
    s_sub_u32 s27, s24, 144
    s_lshl_b32 s27, s27, 16
    s_mov_b32 s52, s80
    s_and_b32 s53, s81, 0xffff
    s_mov_b32 s54, 0x400000
    s_mov_b32 s55, 0x00020000
    s_mov_b32 s25, s27
    buffer_load_dwordx4 v[128:131], v2, s[52:55], s25 offen
    s_add_u32 s25, s25, 4096
    buffer_load_dwordx4 v[132:135], v2, s[52:55], s25 offen
    s_add_u32 s25, s25, 4096
    buffer_load_dwordx4 v[136:139], v2, s[52:55], s25 offen
    s_add_u32 s25, s25, 4096
    buffer_load_dwordx4 v[140:143], v2, s[52:55], s25 offen
    s_add_u32 s25, s25, 4096
    buffer_load_dwordx4 v[144:147], v2, s[52:55], s25 offen
    s_add_u32 s25, s25, 4096
    buffer_load_dwordx4 v[148:151], v2, s[52:55], s25 offen
    s_add_u32 s25, s25, 4096
    buffer_load_dwordx4 v[152:155], v2, s[52:55], s25 offen
    s_add_u32 s25, s25, 4096
    buffer_load_dwordx4 v[156:159], v2, s[52:55], s25 offen
    s_add_u32 s25, s25, 4096
    buffer_load_dwordx4 v[128:131], v2, s[52:55], s25 offen
    s_add_u32 s25, s25, 4096
    buffer_load_dwordx4 v[132:135], v2, s[52:55], s25 offen
    s_add_u32 s25, s25, 4096
    buffer_load_dwordx4 v[136:139], v2, s[52:55], s25 offen
    s_add_u32 s25, s25, 4096
    buffer_load_dwordx4 v[140:143], v2, s[52:55], s25 offen
    s_add_u32 s25, s25, 4096
    buffer_load_dwordx4 v[144:147], v2, s[52:55], s25 offen
    s_add_u32 s25, s25, 4096
    buffer_load_dwordx4 v[148:151], v2, s[52:55], s25 offen
    s_add_u32 s25, s25, 4096
    buffer_load_dwordx4 v[152:155], v2, s[52:55], s25 offen
    s_add_u32 s25, s25, 4096
    buffer_load_dwordx4 v[156:159], v2, s[52:55], s25 offen
    s_add_u32 s25, s25, 4096
    s_mov_b32 s52, s82
    s_and_b32 s53, s83, 0xffff
    s_mov_b32 s54, 0x400000
    s_mov_b32 s55, 0x00020000
    s_mov_b32 s25, s27
    buffer_load_dwordx4 v[128:131], v2, s[52:55], s25 offen
    s_add_u32 s25, s25, 4096
    buffer_load_dwordx4 v[132:135], v2, s[52:55], s25 offen
    s_add_u32 s25, s25, 4096
    buffer_load_dwordx4 v[136:139], v2, s[52:55], s25 offen
    s_add_u32 s25, s25, 4096
    buffer_load_dwordx4 v[140:143], v2, s[52:55], s25 offen
    s_add_u32 s25, s25, 4096
    buffer_load_dwordx4 v[144:147], v2, s[52:55], s25 offen
    s_add_u32 s25, s25, 4096
    buffer_load_dwordx4 v[148:151], v2, s[52:55], s25 offen
    s_add_u32 s25, s25, 4096
    buffer_load_dwordx4 v[152:155], v2, s[52:55], s25 offen
    s_add_u32 s25, s25, 4096
    buffer_load_dwordx4 v[156:159], v2, s[52:55], s25 offen
    s_add_u32 s25, s25, 4096
    buffer_load_dwordx4 v[128:131], v2, s[52:55], s25 offen
    s_add_u32 s25, s25, 4096
    buffer_load_dwordx4 v[132:135], v2, s[52:55], s25 offen
    s_add_u32 s25, s25, 4096
    buffer_load_dwordx4 v[136:139], v2, s[52:55], s25 offen
    s_add_u32 s25, s25, 4096
    buffer_load_dwordx4 v[140:143], v2, s[52:55], s25 offen
    s_add_u32 s25, s25, 4096
    buffer_load_dwordx4 v[144:147], v2, s[52:55], s25 offen
    s_add_u32 s25, s25, 4096
    buffer_load_dwordx4 v[148:151], v2, s[52:55], s25 offen
    s_add_u32 s25, s25, 4096
    buffer_load_dwordx4 v[152:155], v2, s[52:55], s25 offen
    s_add_u32 s25, s25, 4096
    buffer_load_dwordx4 v[156:159], v2, s[52:55], s25 offen
    s_add_u32 s25, s25, 4096
    s_waitcnt vmcnt(37)
L_ln_pass:
    v_lshlrev_b32 v40, 16, v16
    v_and_b32 v41, 0xffff0000, v16
    v_lshlrev_b32 v42, 16, v17
    v_and_b32 v43, 0xffff0000, v17
    v_lshlrev_b32 v44, 16, v18
    v_and_b32 v45, 0xffff0000, v18
    v_lshlrev_b32 v46, 16, v19
    v_and_b32 v47, 0xffff0000, v19
    v_add_f32 v72, v40, v41
    v_add_f32 v72, v72, v42
    v_add_f32 v72, v72, v43
    v_add_f32 v72, v72, v44
    v_add_f32 v72, v72, v45
    v_add_f32 v72, v72, v46
    v_add_f32 v72, v72, v47
    v_lshlrev_b32 v48, 16, v20
    v_and_b32 v49, 0xffff0000, v20
    v_lshlrev_b32 v50, 16, v21
    v_and_b32 v51, 0xffff0000, v21
    v_lshlrev_b32 v52, 16, v22
    v_and_b32 v53, 0xffff0000, v22
    v_lshlrev_b32 v54, 16, v23
    v_and_b32 v55, 0xffff0000, v23
    v_add_f32 v73, v48, v49
    v_add_f32 v73, v73, v50
    v_add_f32 v73, v73, v51
    v_add_f32 v73, v73, v52
    v_add_f32 v73, v73, v53
    v_add_f32 v73, v73, v54
    v_add_f32 v73, v73, v55
    v_lshlrev_b32 v56, 16, v24
    v_and_b32 v57, 0xffff0000, v24
    v_lshlrev_b32 v58, 16, v25
    v_and_b32 v59, 0xffff0000, v25
    v_lshlrev_b32 v60, 16, v26
    v_and_b32 v61, 0xffff0000, v26
    v_lshlrev_b32 v62, 16, v27
    v_and_b32 v63, 0xffff0000, v27
    v_add_f32 v74, v56, v57
    v_add_f32 v74, v74, v58
    v_add_f32 v74, v74, v59
    v_add_f32 v74, v74, v60
    v_add_f32 v74, v74, v61
    v_add_f32 v74, v74, v62
    v_add_f32 v74, v74, v63
    v_lshlrev_b32 v64, 16, v28
    v_and_b32 v65, 0xffff0000, v28
    v_lshlrev_b32 v66, 16, v29
    v_and_b32 v67, 0xffff0000, v29
    v_lshlrev_b32 v68, 16, v30
    v_and_b32 v69, 0xffff0000, v30
    v_lshlrev_b32 v70, 16, v31
    v_and_b32 v71, 0xffff0000, v31
    v_add_f32 v75, v64, v65
    v_add_f32 v75, v75, v66
    v_add_f32 v75, v75, v67
    v_add_f32 v75, v75, v68
    v_add_f32 v75, v75, v69
    v_add_f32 v75, v75, v70
    v_add_f32 v75, v75, v71
    v_add_f32_dpp v72, v72, v72 quad_perm:[1,0,3,2] row_mask:0xf bank_mask:0xf
    v_add_f32_dpp v73, v73, v73 quad_perm:[1,0,3,2] row_mask:0xf bank_mask:0xf
    v_add_f32_dpp v74, v74, v74 quad_perm:[1,0,3,2] row_mask:0xf bank_mask:0xf
    v_add_f32_dpp v75, v75, v75 quad_perm:[1,0,3,2] row_mask:0xf bank_mask:0xf
    v_add_f32_dpp v72, v72, v72 quad_perm:[2,3,0,1] row_mask:0xf bank_mask:0xf
    v_add_f32_dpp v73, v73, v73 quad_perm:[2,3,0,1] row_mask:0xf bank_mask:0xf
    v_add_f32_dpp v74, v74, v74 quad_perm:[2,3,0,1] row_mask:0xf bank_mask:0xf
    v_add_f32_dpp v75, v75, v75 quad_perm:[2,3,0,1] row_mask:0xf bank_mask:0xf
    v_add_f32_dpp v72, v72, v72 row_half_mirror row_mask:0xf bank_mask:0xf
    v_add_f32_dpp v73, v73, v73 row_half_mirror row_mask:0xf bank_mask:0xf
    v_add_f32_dpp v74, v74, v74 row_half_mirror row_mask:0xf bank_mask:0xf
    v_add_f32_dpp v75, v75, v75 row_half_mirror row_mask:0xf bank_mask:0xf
    v_add_f32_dpp v72, v72, v72 row_mirror row_mask:0xf bank_mask:0xf
    v_add_f32_dpp v73, v73, v73 row_mirror row_mask:0xf bank_mask:0xf
    v_add_f32_dpp v74, v74, v74 row_mirror row_mask:0xf bank_mask:0xf
    v_add_f32_dpp v75, v75, v75 row_mirror row_mask:0xf bank_mask:0xf
    v_mov_b32 v76, v72
    v_mov_b32 v77, v73
    v_mov_b32 v78, v74
    v_mov_b32 v79, v75
    v_permlane16_swap_b32 v72, v76
    v_permlane16_swap_b32 v73, v77
    v_permlane16_swap_b32 v74, v78
    v_permlane16_swap_b32 v75, v79
    v_add_f32 v72, v72, v76
    v_add_f32 v73, v73, v77
    v_add_f32 v74, v74, v78
    v_add_f32 v75, v75, v79
    v_mov_b32 v76, v72
    v_mov_b32 v77, v73
    v_mov_b32 v78, v74
    v_mov_b32 v79, v75
    v_permlane32_swap_b32 v72, v76
    v_permlane32_swap_b32 v73, v77
    v_permlane32_swap_b32 v74, v78
    v_permlane32_swap_b32 v75, v79
    v_add_f32 v72, v72, v76
    v_add_f32 v73, v73, v77
    v_add_f32 v74, v74, v78
    v_add_f32 v75, v75, v79
    v_mul_f32 v80, 0x3b000000, v72
    v_mul_f32 v81, 0x3b000000, v73
    v_mul_f32 v82, 0x3b000000, v74
    v_mul_f32 v83, 0x3b000000, v75
    v_sub_f32 v76, v40, v80
    v_mul_f32 v72, v76, v76
    v_sub_f32 v76, v41, v80
    v_fmac_f32 v72, v76, v76
    v_sub_f32 v76, v42, v80
    v_fmac_f32 v72, v76, v76
    v_sub_f32 v76, v43, v80
    v_fmac_f32 v72, v76, v76
    v_sub_f32 v76, v44, v80
    v_fmac_f32 v72, v76, v76
    v_sub_f32 v76, v45, v80
    v_fmac_f32 v72, v76, v76
    v_sub_f32 v76, v46, v80
    v_fmac_f32 v72, v76, v76
    v_sub_f32 v76, v47, v80
    v_fmac_f32 v72, v76, v76
    v_sub_f32 v76, v48, v81
    v_mul_f32 v73, v76, v76
    v_sub_f32 v76, v49, v81
    v_fmac_f32 v73, v76, v76
    v_sub_f32 v76, v50, v81
    v_fmac_f32 v73, v76, v76
    v_sub_f32 v76, v51, v81
    v_fmac_f32 v73, v76, v76
    v_sub_f32 v76, v52, v81
    v_fmac_f32 v73, v76, v76
    v_sub_f32 v76, v53, v81
    v_fmac_f32 v73, v76, v76
    v_sub_f32 v76, v54, v81
    v_fmac_f32 v73, v76, v76
    v_sub_f32 v76, v55, v81
    v_fmac_f32 v73, v76, v76
    v_sub_f32 v76, v56, v82
    v_mul_f32 v74, v76, v76
    v_sub_f32 v76, v57, v82
    v_fmac_f32 v74, v76, v76
    v_sub_f32 v76, v58, v82
    v_fmac_f32 v74, v76, v76
    v_sub_f32 v76, v59, v82
    v_fmac_f32 v74, v76, v76
    v_sub_f32 v76, v60, v82
    v_fmac_f32 v74, v76, v76
    v_sub_f32 v76, v61, v82
    v_fmac_f32 v74, v76, v76
    v_sub_f32 v76, v62, v82
    v_fmac_f32 v74, v76, v76
    v_sub_f32 v76, v63, v82
    v_fmac_f32 v74, v76, v76
    v_sub_f32 v76, v64, v83
    v_mul_f32 v75, v76, v76
    v_sub_f32 v76, v65, v83
    v_fmac_f32 v75, v76, v76
    v_sub_f32 v76, v66, v83
    v_fmac_f32 v75, v76, v76
    v_sub_f32 v76, v67, v83
    v_fmac_f32 v75, v76, v76
    v_sub_f32 v76, v68, v83
    v_fmac_f32 v75, v76, v76
    v_sub_f32 v76, v69, v83
    v_fmac_f32 v75, v76, v76
    v_sub_f32 v76, v70, v83
    v_fmac_f32 v75, v76, v76
    v_sub_f32 v76, v71, v83
    v_fmac_f32 v75, v76, v76
    v_add_f32_dpp v72, v72, v72 quad_perm:[1,0,3,2] row_mask:0xf bank_mask:0xf
    v_add_f32_dpp v73, v73, v73 quad_perm:[1,0,3,2] row_mask:0xf bank_mask:0xf
    v_add_f32_dpp v74, v74, v74 quad_perm:[1,0,3,2] row_mask:0xf bank_mask:0xf
    v_add_f32_dpp v75, v75, v75 quad_perm:[1,0,3,2] row_mask:0xf bank_mask:0xf
    v_add_f32_dpp v72, v72, v72 quad_perm:[2,3,0,1] row_mask:0xf bank_mask:0xf
    v_add_f32_dpp v73, v73, v73 quad_perm:[2,3,0,1] row_mask:0xf bank_mask:0xf
    v_add_f32_dpp v74, v74, v74 quad_perm:[2,3,0,1] row_mask:0xf bank_mask:0xf
    v_add_f32_dpp v75, v75, v75 quad_perm:[2,3,0,1] row_mask:0xf bank_mask:0xf
    v_add_f32_dpp v72, v72, v72 row_half_mirror row_mask:0xf bank_mask:0xf
    v_add_f32_dpp v73, v73, v73 row_half_mirror row_mask:0xf bank_mask:0xf
    v_add_f32_dpp v74, v74, v74 row_half_mirror row_mask:0xf bank_mask:0xf
    v_add_f32_dpp v75, v75, v75 row_half_mirror row_mask:0xf bank_mask:0xf
    v_add_f32_dpp v72, v72, v72 row_mirror row_mask:0xf bank_mask:0xf
    v_add_f32_dpp v73, v73, v73 row_mirror row_mask:0xf bank_mask:0xf
    v_add_f32_dpp v74, v74, v74 row_mirror row_mask:0xf bank_mask:0xf
    v_add_f32_dpp v75, v75, v75 row_mirror row_mask:0xf bank_mask:0xf
    v_mov_b32 v76, v72
    v_mov_b32 v77, v73
    v_mov_b32 v78, v74
    v_mov_b32 v79, v75
    v_permlane16_swap_b32 v72, v76
    v_permlane16_swap_b32 v73, v77
    v_permlane16_swap_b32 v74, v78
    v_permlane16_swap_b32 v75, v79
    v_add_f32 v72, v72, v76
    v_add_f32 v73, v73, v77
    v_add_f32 v74, v74, v78
    v_add_f32 v75, v75, v79
    v_mov_b32 v76, v72
    v_mov_b32 v77, v73
    v_mov_b32 v78, v74
    v_mov_b32 v79, v75
    v_permlane32_swap_b32 v72, v76
    v_permlane32_swap_b32 v73, v77
    v_permlane32_swap_b32 v74, v78
    v_permlane32_swap_b32 v75, v79
    v_add_f32 v72, v72, v76
    v_add_f32 v73, v73, v77
    v_add_f32 v74, v74, v78
    v_add_f32 v75, v75, v79
    v_cvt_pk_bf16_f32 v80, v80, v80
    v_and_b32 v80, 0xffff0000, v80
    v_mul_f32 v72, 0x3b000000, v72
    v_cvt_pk_bf16_f32 v72, v72, v72
    v_and_b32 v72, 0xffff0000, v72
    v_add_f32 v72, 0x3727c5ac, v72
    v_cvt_pk_bf16_f32 v72, v72, v72
    v_and_b32 v72, 0xffff0000, v72
    v_sqrt_f32 v72, v72
    s_nop 0
    v_cvt_pk_bf16_f32 v72, v72, v72
    v_and_b32 v72, 0xffff0000, v72
    v_rcp_f32 v76, v72
    v_cvt_pk_bf16_f32 v81, v81, v81
    v_and_b32 v81, 0xffff0000, v81
    v_mul_f32 v73, 0x3b000000, v73
    v_cvt_pk_bf16_f32 v73, v73, v73
    v_and_b32 v73, 0xffff0000, v73
    v_add_f32 v73, 0x3727c5ac, v73
    v_cvt_pk_bf16_f32 v73, v73, v73
    v_and_b32 v73, 0xffff0000, v73
    v_sqrt_f32 v73, v73
    s_nop 0
    v_cvt_pk_bf16_f32 v73, v73, v73
    v_and_b32 v73, 0xffff0000, v73
    v_rcp_f32 v77, v73
    v_cvt_pk_bf16_f32 v82, v82, v82
    v_and_b32 v82, 0xffff0000, v82
    v_mul_f32 v74, 0x3b000000, v74
    v_cvt_pk_bf16_f32 v74, v74, v74
    v_and_b32 v74, 0xffff0000, v74
    v_add_f32 v74, 0x3727c5ac, v74
    v_cvt_pk_bf16_f32 v74, v74, v74
    v_and_b32 v74, 0xffff0000, v74
    v_sqrt_f32 v74, v74
    s_nop 0
    v_cvt_pk_bf16_f32 v74, v74, v74
    v_and_b32 v74, 0xffff0000, v74
    v_rcp_f32 v78, v74
    v_cvt_pk_bf16_f32 v83, v83, v83
    v_and_b32 v83, 0xffff0000, v83
    v_mul_f32 v75, 0x3b000000, v75
    v_cvt_pk_bf16_f32 v75, v75, v75
    v_and_b32 v75, 0xffff0000, v75
    v_add_f32 v75, 0x3727c5ac, v75
    v_cvt_pk_bf16_f32 v75, v75, v75
    v_and_b32 v75, 0xffff0000, v75
    v_sqrt_f32 v75, v75
    s_nop 0
    v_cvt_pk_bf16_f32 v75, v75, v75
    v_and_b32 v75, 0xffff0000, v75
    v_rcp_f32 v79, v75
    v_lshlrev_b32 v84, 16, v32
    v_and_b32 v85, 0xffff0000, v32
    v_lshlrev_b32 v86, 16, v33
    v_and_b32 v87, 0xffff0000, v33
    v_lshlrev_b32 v88, 16, v34
    v_and_b32 v89, 0xffff0000, v34
    v_lshlrev_b32 v90, 16, v35
    v_and_b32 v91, 0xffff0000, v35
    v_sub_f32 v40, v40, v80
    v_sub_f32 v41, v41, v80
    v_cvt_pk_bf16_f32 v92, v40, v41
    v_lshlrev_b32 v40, 16, v92
    v_and_b32 v41, 0xffff0000, v92
    v_mul_f32 v92, v40, v76
    v_fma_f32 v94, -v92, v72, v40
    v_fmac_f32 v92, v94, v76
    v_mul_f32 v93, v41, v76
    v_fma_f32 v95, -v93, v72, v41
    v_fmac_f32 v93, v95, v76
    v_cvt_pk_bf16_f32 v16, v92, v93
    v_lshlrev_b32 v40, 16, v16
    v_and_b32 v41, 0xffff0000, v16
    v_mul_f32 v96, v40, v84
    v_fmac_f32 v96, v41, v85
    v_sub_f32 v42, v42, v80
    v_sub_f32 v43, v43, v80
    v_cvt_pk_bf16_f32 v92, v42, v43
    v_lshlrev_b32 v42, 16, v92
    v_and_b32 v43, 0xffff0000, v92
    v_mul_f32 v92, v42, v76
    v_fma_f32 v94, -v92, v72, v42
    v_fmac_f32 v92, v94, v76
    v_mul_f32 v93, v43, v76
    v_fma_f32 v95, -v93, v72, v43
    v_fmac_f32 v93, v95, v76
    v_cvt_pk_bf16_f32 v17, v92, v93
    v_lshlrev_b32 v42, 16, v17
    v_and_b32 v43, 0xffff0000, v17
    v_fmac_f32 v96, v42, v86
    v_fmac_f32 v96, v43, v87
    v_sub_f32 v44, v44, v80
    v_sub_f32 v45, v45, v80
    v_cvt_pk_bf16_f32 v92, v44, v45
    v_lshlrev_b32 v44, 16, v92
    v_and_b32 v45, 0xffff0000, v92
    v_mul_f32 v92, v44, v76
    v_fma_f32 v94, -v92, v72, v44
    v_fmac_f32 v92, v94, v76
    v_mul_f32 v93, v45, v76
    v_fma_f32 v95, -v93, v72, v45
    v_fmac_f32 v93, v95, v76
    v_cvt_pk_bf16_f32 v18, v92, v93
    v_lshlrev_b32 v44, 16, v18
    v_and_b32 v45, 0xffff0000, v18
    v_fmac_f32 v96, v44, v88
    v_fmac_f32 v96, v45, v89
    v_sub_f32 v46, v46, v80
    v_sub_f32 v47, v47, v80
    v_cvt_pk_bf16_f32 v92, v46, v47
    v_lshlrev_b32 v46, 16, v92
    v_and_b32 v47, 0xffff0000, v92
    v_mul_f32 v92, v46, v76
    v_fma_f32 v94, -v92, v72, v46
    v_fmac_f32 v92, v94, v76
    v_mul_f32 v93, v47, v76
    v_fma_f32 v95, -v93, v72, v47
    v_fmac_f32 v93, v95, v76
    v_cvt_pk_bf16_f32 v19, v92, v93
    v_lshlrev_b32 v46, 16, v19
    v_and_b32 v47, 0xffff0000, v19
    v_fmac_f32 v96, v46, v90
    v_fmac_f32 v96, v47, v91
    s_add_u32 s25, s32, 2097152
    buffer_store_dwordx4 v[16:19], v1, s[8:11], s25 offen offset:0 sc1
    s_add_u32 s25, s32, 4194304
    buffer_store_dwordx4 v[16:19], v1, s[8:11], s25 offen offset:0 sc1
    v_sub_f32 v48, v48, v81
    v_sub_f32 v49, v49, v81
    v_cvt_pk_bf16_f32 v92, v48, v49
    v_lshlrev_b32 v48, 16, v92
    v_and_b32 v49, 0xffff0000, v92
    v_mul_f32 v92, v48, v77
    v_fma_f32 v94, -v92, v73, v48
    v_fmac_f32 v92, v94, v77
    v_mul_f32 v93, v49, v77
    v_fma_f32 v95, -v93, v73, v49
    v_fmac_f32 v93, v95, v77
    v_cvt_pk_bf16_f32 v20, v92, v93
    v_lshlrev_b32 v48, 16, v20
    v_and_b32 v49, 0xffff0000, v20
    v_mul_f32 v97, v48, v84
    v_fmac_f32 v97, v49, v85
    v_sub_f32 v50, v50, v81
    v_sub_f32 v51, v51, v81
    v_cvt_pk_bf16_f32 v92, v50, v51
    v_lshlrev_b32 v50, 16, v92
    v_and_b32 v51, 0xffff0000, v92
    v_mul_f32 v92, v50, v77
    v_fma_f32 v94, -v92, v73, v50
    v_fmac_f32 v92, v94, v77
    v_mul_f32 v93, v51, v77
    v_fma_f32 v95, -v93, v73, v51
    v_fmac_f32 v93, v95, v77
    v_cvt_pk_bf16_f32 v21, v92, v93
    v_lshlrev_b32 v50, 16, v21
    v_and_b32 v51, 0xffff0000, v21
    v_fmac_f32 v97, v50, v86
    v_fmac_f32 v97, v51, v87
    v_sub_f32 v52, v52, v81
    v_sub_f32 v53, v53, v81
    v_cvt_pk_bf16_f32 v92, v52, v53
    v_lshlrev_b32 v52, 16, v92
    v_and_b32 v53, 0xffff0000, v92
    v_mul_f32 v92, v52, v77
    v_fma_f32 v94, -v92, v73, v52
    v_fmac_f32 v92, v94, v77
    v_mul_f32 v93, v53, v77
    v_fma_f32 v95, -v93, v73, v53
    v_fmac_f32 v93, v95, v77
    v_cvt_pk_bf16_f32 v22, v92, v93
    v_lshlrev_b32 v52, 16, v22
    v_and_b32 v53, 0xffff0000, v22
    v_fmac_f32 v97, v52, v88
    v_fmac_f32 v97, v53, v89
    v_sub_f32 v54, v54, v81
    v_sub_f32 v55, v55, v81
    v_cvt_pk_bf16_f32 v92, v54, v55
    v_lshlrev_b32 v54, 16, v92
    v_and_b32 v55, 0xffff0000, v92
    v_mul_f32 v92, v54, v77
    v_fma_f32 v94, -v92, v73, v54
    v_fmac_f32 v92, v94, v77
    v_mul_f32 v93, v55, v77
    v_fma_f32 v95, -v93, v73, v55
    v_fmac_f32 v93, v95, v77
    v_cvt_pk_bf16_f32 v23, v92, v93
    v_lshlrev_b32 v54, 16, v23
    v_and_b32 v55, 0xffff0000, v23
    v_fmac_f32 v97, v54, v90
    v_fmac_f32 v97, v55, v91
    s_add_u32 s25, s32, 2097152
    buffer_store_dwordx4 v[20:23], v1, s[8:11], s25 offen offset:1024 sc1
    s_add_u32 s25, s32, 4194304
    buffer_store_dwordx4 v[20:23], v1, s[8:11], s25 offen offset:1024 sc1
    v_sub_f32 v56, v56, v82
    v_sub_f32 v57, v57, v82
    v_cvt_pk_bf16_f32 v92, v56, v57
    v_lshlrev_b32 v56, 16, v92
    v_and_b32 v57, 0xffff0000, v92
    v_mul_f32 v92, v56, v78
    v_fma_f32 v94, -v92, v74, v56
    v_fmac_f32 v92, v94, v78
    v_mul_f32 v93, v57, v78
    v_fma_f32 v95, -v93, v74, v57
    v_fmac_f32 v93, v95, v78
    v_cvt_pk_bf16_f32 v24, v92, v93
    v_lshlrev_b32 v56, 16, v24
    v_and_b32 v57, 0xffff0000, v24
    v_mul_f32 v98, v56, v84
    v_fmac_f32 v98, v57, v85
    v_sub_f32 v58, v58, v82
    v_sub_f32 v59, v59, v82
    v_cvt_pk_bf16_f32 v92, v58, v59
    v_lshlrev_b32 v58, 16, v92
    v_and_b32 v59, 0xffff0000, v92
    v_mul_f32 v92, v58, v78
    v_fma_f32 v94, -v92, v74, v58
    v_fmac_f32 v92, v94, v78
    v_mul_f32 v93, v59, v78
    v_fma_f32 v95, -v93, v74, v59
    v_fmac_f32 v93, v95, v78
    v_cvt_pk_bf16_f32 v25, v92, v93
    v_lshlrev_b32 v58, 16, v25
    v_and_b32 v59, 0xffff0000, v25
    v_fmac_f32 v98, v58, v86
    v_fmac_f32 v98, v59, v87
    v_sub_f32 v60, v60, v82
    v_sub_f32 v61, v61, v82
    v_cvt_pk_bf16_f32 v92, v60, v61
    v_lshlrev_b32 v60, 16, v92
    v_and_b32 v61, 0xffff0000, v92
    v_mul_f32 v92, v60, v78
    v_fma_f32 v94, -v92, v74, v60
    v_fmac_f32 v92, v94, v78
    v_mul_f32 v93, v61, v78
    v_fma_f32 v95, -v93, v74, v61
    v_fmac_f32 v93, v95, v78
    v_cvt_pk_bf16_f32 v26, v92, v93
    v_lshlrev_b32 v60, 16, v26
    v_and_b32 v61, 0xffff0000, v26
    v_fmac_f32 v98, v60, v88
    v_fmac_f32 v98, v61, v89
    v_sub_f32 v62, v62, v82
    v_sub_f32 v63, v63, v82
    v_cvt_pk_bf16_f32 v92, v62, v63
    v_lshlrev_b32 v62, 16, v92
    v_and_b32 v63, 0xffff0000, v92
    v_mul_f32 v92, v62, v78
    v_fma_f32 v94, -v92, v74, v62
    v_fmac_f32 v92, v94, v78
    v_mul_f32 v93, v63, v78
    v_fma_f32 v95, -v93, v74, v63
    v_fmac_f32 v93, v95, v78
    v_cvt_pk_bf16_f32 v27, v92, v93
    v_lshlrev_b32 v62, 16, v27
    v_and_b32 v63, 0xffff0000, v27
    v_fmac_f32 v98, v62, v90
    v_fmac_f32 v98, v63, v91
    s_add_u32 s25, s32, 2097152
    buffer_store_dwordx4 v[24:27], v1, s[8:11], s25 offen offset:2048 sc1
    s_add_u32 s25, s32, 4194304
    buffer_store_dwordx4 v[24:27], v1, s[8:11], s25 offen offset:2048 sc1
    v_sub_f32 v64, v64, v83
    v_sub_f32 v65, v65, v83
    v_cvt_pk_bf16_f32 v92, v64, v65
    v_lshlrev_b32 v64, 16, v92
    v_and_b32 v65, 0xffff0000, v92
    v_mul_f32 v92, v64, v79
    v_fma_f32 v94, -v92, v75, v64
    v_fmac_f32 v92, v94, v79
    v_mul_f32 v93, v65, v79
    v_fma_f32 v95, -v93, v75, v65
    v_fmac_f32 v93, v95, v79
    v_cvt_pk_bf16_f32 v28, v92, v93
    v_lshlrev_b32 v64, 16, v28
    v_and_b32 v65, 0xffff0000, v28
    v_mul_f32 v99, v64, v84
    v_fmac_f32 v99, v65, v85
    v_sub_f32 v66, v66, v83
    v_sub_f32 v67, v67, v83
    v_cvt_pk_bf16_f32 v92, v66, v67
    v_lshlrev_b32 v66, 16, v92
    v_and_b32 v67, 0xffff0000, v92
    v_mul_f32 v92, v66, v79
    v_fma_f32 v94, -v92, v75, v66
    v_fmac_f32 v92, v94, v79
    v_mul_f32 v93, v67, v79
    v_fma_f32 v95, -v93, v75, v67
    v_fmac_f32 v93, v95, v79
    v_cvt_pk_bf16_f32 v29, v92, v93
    v_lshlrev_b32 v66, 16, v29
    v_and_b32 v67, 0xffff0000, v29
    v_fmac_f32 v99, v66, v86
    v_fmac_f32 v99, v67, v87
    v_sub_f32 v68, v68, v83
    v_sub_f32 v69, v69, v83
    v_cvt_pk_bf16_f32 v92, v68, v69
    v_lshlrev_b32 v68, 16, v92
    v_and_b32 v69, 0xffff0000, v92
    v_mul_f32 v92, v68, v79
    v_fma_f32 v94, -v92, v75, v68
    v_fmac_f32 v92, v94, v79
    v_mul_f32 v93, v69, v79
    v_fma_f32 v95, -v93, v75, v69
    v_fmac_f32 v93, v95, v79
    v_cvt_pk_bf16_f32 v30, v92, v93
    v_lshlrev_b32 v68, 16, v30
    v_and_b32 v69, 0xffff0000, v30
    v_fmac_f32 v99, v68, v88
    v_fmac_f32 v99, v69, v89
    v_sub_f32 v70, v70, v83
    v_sub_f32 v71, v71, v83
    v_cvt_pk_bf16_f32 v92, v70, v71
    v_lshlrev_b32 v70, 16, v92
    v_and_b32 v71, 0xffff0000, v92
    v_mul_f32 v92, v70, v79
    v_fma_f32 v94, -v92, v75, v70
    v_fmac_f32 v92, v94, v79
    v_mul_f32 v93, v71, v79
    v_fma_f32 v95, -v93, v75, v71
    v_fmac_f32 v93, v95, v79
    v_cvt_pk_bf16_f32 v31, v92, v93
    v_lshlrev_b32 v70, 16, v31
    v_and_b32 v71, 0xffff0000, v31
    v_fmac_f32 v99, v70, v90
    v_fmac_f32 v99, v71, v91
    s_add_u32 s25, s32, 2097152
    buffer_store_dwordx4 v[28:31], v1, s[8:11], s25 offen offset:3072 sc1
    s_add_u32 s25, s32, 4194304
    buffer_store_dwordx4 v[28:31], v1, s[8:11], s25 offen offset:3072 sc1
    v_add_f32_dpp v96, v96, v96 quad_perm:[1,0,3,2] row_mask:0xf bank_mask:0xf
    v_add_f32_dpp v97, v97, v97 quad_perm:[1,0,3,2] row_mask:0xf bank_mask:0xf
    v_add_f32_dpp v98, v98, v98 quad_perm:[1,0,3,2] row_mask:0xf bank_mask:0xf
    v_add_f32_dpp v99, v99, v99 quad_perm:[1,0,3,2] row_mask:0xf bank_mask:0xf
    v_add_f32_dpp v96, v96, v96 quad_perm:[2,3,0,1] row_mask:0xf bank_mask:0xf
    v_add_f32_dpp v97, v97, v97 quad_perm:[2,3,0,1] row_mask:0xf bank_mask:0xf
    v_add_f32_dpp v98, v98, v98 quad_perm:[2,3,0,1] row_mask:0xf bank_mask:0xf
    v_add_f32_dpp v99, v99, v99 quad_perm:[2,3,0,1] row_mask:0xf bank_mask:0xf
    v_add_f32_dpp v96, v96, v96 row_half_mirror row_mask:0xf bank_mask:0xf
    v_add_f32_dpp v97, v97, v97 row_half_mirror row_mask:0xf bank_mask:0xf
    v_add_f32_dpp v98, v98, v98 row_half_mirror row_mask:0xf bank_mask:0xf
    v_add_f32_dpp v99, v99, v99 row_half_mirror row_mask:0xf bank_mask:0xf
    v_add_f32_dpp v96, v96, v96 row_mirror row_mask:0xf bank_mask:0xf
    v_add_f32_dpp v97, v97, v97 row_mirror row_mask:0xf bank_mask:0xf
    v_add_f32_dpp v98, v98, v98 row_mirror row_mask:0xf bank_mask:0xf
    v_add_f32_dpp v99, v99, v99 row_mirror row_mask:0xf bank_mask:0xf
    v_mov_b32 v76, v96
    v_mov_b32 v77, v97
    v_mov_b32 v78, v98
    v_mov_b32 v79, v99
    v_permlane16_swap_b32 v96, v76
    v_permlane16_swap_b32 v97, v77
    v_permlane16_swap_b32 v98, v78
    v_permlane16_swap_b32 v99, v79
    v_add_f32 v96, v96, v76
    v_add_f32 v97, v97, v77
    v_add_f32 v98, v98, v78
    v_add_f32 v99, v99, v79
    v_mov_b32 v76, v96
    v_mov_b32 v77, v97
    v_mov_b32 v78, v98
    v_mov_b32 v79, v99
    v_permlane32_swap_b32 v96, v76
    v_permlane32_swap_b32 v97, v77
    v_permlane32_swap_b32 v98, v78
    v_permlane32_swap_b32 v99, v79
    v_add_f32 v96, v96, v76
    v_add_f32 v97, v97, v77
    v_add_f32 v98, v98, v78
    v_add_f32 v99, v99, v79
    v_cvt_pk_bf16_f32 v96, v96, v96
    v_and_b32 v96, 0xffff0000, v96
    v_cvt_pk_bf16_f32 v97, v97, v97
    v_and_b32 v97, 0xffff0000, v97
    v_cvt_pk_bf16_f32 v98, v98, v98
    v_and_b32 v98, 0xffff0000, v98
    v_cvt_pk_bf16_f32 v99, v99, v99
    v_and_b32 v99, 0xffff0000, v99
    s_add_u32 s25, s33, 6291456
    s_mov_b64 exec, 1
    buffer_store_dwordx4 v[96:99], v1, s[8:11], s25 offen sc1
    s_mov_b64 exec, -1
    s_cmp_lg_u32 s30, 0
    s_cbranch_scc1 L_ln_fin
    s_mov_b32 s30, 1
    s_add_u32 s32, s32, 16384
    s_add_u32 s33, s33, 64
    s_waitcnt vmcnt(42)
    v_mov_b64 v[16:17], v[100:101]
    v_mov_b64 v[18:19], v[102:103]
    v_mov_b64 v[20:21], v[104:105]
    v_mov_b64 v[22:23], v[106:107]
    v_mov_b64 v[24:25], v[108:109]
    v_mov_b64 v[26:27], v[110:111]
    v_mov_b64 v[28:29], v[112:113]
    v_mov_b64 v[30:31], v[114:115]
    s_branch L_ln_pass
L_ln_fin:
    s_waitcnt vmcnt(0)
    s_barrier
    s_cmp_lg_u32 s21, 0
    s_cbranch_scc1 L_sigln
    s_mov_b64 exec, 1
    v_mov_b32 v5, 68
    v_mov_b32 v6, 1
    buffer_atomic_add v6, v5, s[12:15], 0 offen
    s_mov_b64 exec, -1
L_sigln:
L_ln_done:
L_orole2:
    s_sub_u32 s25, s24, 128
    s_and_b32 s28, s25, 15
    s_lshr_b32 s30, s25, 4
    v_lshlrev_b32 v5, 13, v4
    v_lshl_add_u32 v5, v3, 2, v5
    s_lshl_b32 s25, s21, 20
    s_lshl_b32 s27, s28, 6
    s_add_u32 s25, s25, s27
    v_add_u32 v5, s25, v5
    v_add_u32 v6, 4096, v5
    v_lshlrev_b32 v7, 12, v4
    v_lshl_add_u32 v7, v3, 2, v7
    s_lshl_b32 s25, s21, 10
    s_add_u32 s25, s25, s27
    v_add_u32 v7, s25, v7
    s_lshl_b32 s25, s21, 2
    v_add_u32 v8, s25, v1
    s_cmp_lg_u32 s21, 0
    s_cbranch_scc1 L_wdmoe_ok
    v_mov_b32 v10, 0
L_wdmoe:
    buffer_load_dword v11, v10, s[12:15], 0 offen offset:132 sc1
    s_waitcnt vmcnt(0)
    v_readfirstlane_b32 s25, v11
    s_cmp_ge_u32 s25, 1
    s_cbranch_scc1 L_wdmoe_ok
    s_sleep 40
    s_add_u32 s26, s26, 1
    s_cmp_lt_u32 s26, 400000
    s_cbranch_scc1 L_wdmoe
L_wdmoe_ok:
    s_barrier
    s_nop 1
    s_mov_b32 s16, s86
    s_and_b32 s17, s87, 0xffff
    s_mov_b32 s18, 0x400000
    s_mov_b32 s19, 0x00020000
    s_mov_b32 s25, 0
    buffer_load_dword v16, v5, s[16:19], s25 offen offset:0
    buffer_load_dword v17, v5, s[16:19], s25 offen offset:1024
    buffer_load_dword v18, v5, s[16:19], s25 offen offset:2048
    buffer_load_dword v19, v5, s[16:19], s25 offen offset:3072
    buffer_load_dword v20, v6, s[16:19], s25 offen offset:0
    buffer_load_dword v21, v6, s[16:19], s25 offen offset:1024
    buffer_load_dword v22, v6, s[16:19], s25 offen offset:2048
    buffer_load_dword v23, v6, s[16:19], s25 offen offset:3072
    s_mov_b32 s25, 32768
    buffer_load_dword v24, v5, s[16:19], s25 offen offset:0
    buffer_load_dword v25, v5, s[16:19], s25 offen offset:1024
    buffer_load_dword v26, v5, s[16:19], s25 offen offset:2048
    buffer_load_dword v27, v5, s[16:19], s25 offen offset:3072
    buffer_load_dword v28, v6, s[16:19], s25 offen offset:0
    buffer_load_dword v29, v6, s[16:19], s25 offen offset:1024
    buffer_load_dword v30, v6, s[16:19], s25 offen offset:2048
    buffer_load_dword v31, v6, s[16:19], s25 offen offset:3072
    s_mov_b32 s25, 65536
    buffer_load_dword v32, v5, s[16:19], s25 offen offset:0
    buffer_load_dword v33, v5, s[16:19], s25 offen offset:1024
    buffer_load_dword v34, v5, s[16:19], s25 offen offset:2048
    buffer_load_dword v35, v5, s[16:19], s25 offen offset:3072
    buffer_load_dword v36, v6, s[16:19], s25 offen offset:0
    buffer_load_dword v37, v6, s[16:19], s25 offen offset:1024
    buffer_load_dword v38, v6, s[16:19], s25 offen offset:2048
    buffer_load_dword v39, v6, s[16:19], s25 offen offset:3072
    s_mov_b32 s25, 98304
    buffer_load_dword v40, v5, s[16:19], s25 offen offset:0
    buffer_load_dword v41, v5, s[16:19], s25 offen offset:1024
    buffer_load_dword v42, v5, s[16:19], s25 offen offset:2048
    buffer_load_dword v43, v5, s[16:19], s25 offen offset:3072
    buffer_load_dword v44, v6, s[16:19], s25 offen offset:0
    buffer_load_dword v45, v6, s[16:19], s25 offen offset:1024
    buffer_load_dword v46, v6, s[16:19], s25 offen offset:2048
    buffer_load_dword v47, v6, s[16:19], s25 offen offset:3072
    s_mov_b32 s25, 131072
    buffer_load_dword v48, v5, s[16:19], s25 offen offset:0
    buffer_load_dword v49, v5, s[16:19], s25 offen offset:1024
    buffer_load_dword v50, v5, s[16:19], s25 offen offset:2048
    buffer_load_dword v51, v5, s[16:19], s25 offen offset:3072
    buffer_load_dword v52, v6, s[16:19], s25 offen offset:0
    buffer_load_dword v53, v6, s[16:19], s25 offen offset:1024
    buffer_load_dword v54, v6, s[16:19], s25 offen offset:2048
    buffer_load_dword v55, v6, s[16:19], s25 offen offset:3072
    s_mov_b32 s25, 163840
    buffer_load_dword v56, v5, s[16:19], s25 offen offset:0
    buffer_load_dword v57, v5, s[16:19], s25 offen offset:1024
    buffer_load_dword v58, v5, s[16:19], s25 offen offset:2048
    buffer_load_dword v59, v5, s[16:19], s25 offen offset:3072
    buffer_load_dword v60, v6, s[16:19], s25 offen offset:0
    buffer_load_dword v61, v6, s[16:19], s25 offen offset:1024
    buffer_load_dword v62, v6, s[16:19], s25 offen offset:2048
    buffer_load_dword v63, v6, s[16:19], s25 offen offset:3072
    s_waitcnt vmcnt(32)
    v_perm_b32 v64, v17, v16, s39
    v_accvgpr_write_b32 a0, v64
    v_perm_b32 v65, v19, v18, s39
    v_accvgpr_write_b32 a1, v65
    v_perm_b32 v64, v21, v20, s39
    v_accvgpr_write_b32 a2, v64
    v_perm_b32 v65, v23, v22, s39
    v_accvgpr_write_b32 a3, v65
    v_perm_b32 v64, v17, v16, s40
    v_accvgpr_write_b32 a4, v64
    v_perm_b32 v65, v19, v18, s40
    v_accvgpr_write_b32 a5, v65
    v_perm_b32 v64, v21, v20, s40
    v_accvgpr_write_b32 a6, v64
    v_perm_b32 v65, v23, v22, s40
    v_accvgpr_write_b32 a7, v65
    v_perm_b32 v64, v25, v24, s39
    v_accvgpr_write_b32 a8, v64
    v_perm_b32 v65, v27, v26, s39
    v_accvgpr_write_b32 a9, v65
    v_perm_b32 v64, v29, v28, s39
    v_accvgpr_write_b32 a10, v64
    v_perm_b32 v65, v31, v30, s39
    v_accvgpr_write_b32 a11, v65
    v_perm_b32 v64, v25, v24, s40
    v_accvgpr_write_b32 a12, v64
    v_perm_b32 v65, v27, v26, s40
    v_accvgpr_write_b32 a13, v65
    v_perm_b32 v64, v29, v28, s40
    v_accvgpr_write_b32 a14, v64
    v_perm_b32 v65, v31, v30, s40
    v_accvgpr_write_b32 a15, v65
    s_mov_b32 s25, 196608
    buffer_load_dword v16, v5, s[16:19], s25 offen offset:0
    buffer_load_dword v17, v5, s[16:19], s25 offen offset:1024
    buffer_load_dword v18, v5, s[16:19], s25 offen offset:2048
    buffer_load_dword v19, v5, s[16:19], s25 offen offset:3072
    buffer_load_dword v20, v6, s[16:19], s25 offen offset:0
    buffer_load_dword v21, v6, s[16:19], s25 offen offset:1024
    buffer_load_dword v22, v6, s[16:19], s25 offen offset:2048
    buffer_load_dword v23, v6, s[16:19], s25 offen offset:3072
    s_mov_b32 s25, 229376
    buffer_load_dword v24, v5, s[16:19], s25 offen offset:0
    buffer_load_dword v25, v5, s[16:19], s25 offen offset:1024
    buffer_load_dword v26, v5, s[16:19], s25 offen offset:2048
    buffer_load_dword v27, v5, s[16:19], s25 offen offset:3072
    buffer_load_dword v28, v6, s[16:19], s25 offen offset:0
    buffer_load_dword v29, v6, s[16:19], s25 offen offset:1024
    buffer_load_dword v30, v6, s[16:19], s25 offen offset:2048
    buffer_load_dword v31, v6, s[16:19], s25 offen offset:3072
    s_waitcnt vmcnt(32)
    v_perm_b32 v64, v33, v32, s39
    v_accvgpr_write_b32 a16, v64
    v_perm_b32 v65, v35, v34, s39
    v_accvgpr_write_b32 a17, v65
    v_perm_b32 v64, v37, v36, s39
    v_accvgpr_write_b32 a18, v64
    v_perm_b32 v65, v39, v38, s39
    v_accvgpr_write_b32 a19, v65
    v_perm_b32 v64, v33, v32, s40
    v_accvgpr_write_b32 a20, v64
    v_perm_b32 v65, v35, v34, s40
    v_accvgpr_write_b32 a21, v65
    v_perm_b32 v64, v37, v36, s40
    v_accvgpr_write_b32 a22, v64
    v_perm_b32 v65, v39, v38, s40
    v_accvgpr_write_b32 a23, v65
    v_perm_b32 v64, v41, v40, s39
    v_accvgpr_write_b32 a24, v64
    v_perm_b32 v65, v43, v42, s39
    v_accvgpr_write_b32 a25, v65
    v_perm_b32 v64, v45, v44, s39
    v_accvgpr_write_b32 a26, v64
    v_perm_b32 v65, v47, v46, s39
    v_accvgpr_write_b32 a27, v65
    v_perm_b32 v64, v41, v40, s40
    v_accvgpr_write_b32 a28, v64
    v_perm_b32 v65, v43, v42, s40
    v_accvgpr_write_b32 a29, v65
    v_perm_b32 v64, v45, v44, s40
    v_accvgpr_write_b32 a30, v64
    v_perm_b32 v65, v47, v46, s40
    v_accvgpr_write_b32 a31, v65
    s_mov_b32 s25, 262144
    buffer_load_dword v32, v5, s[16:19], s25 offen offset:0
    buffer_load_dword v33, v5, s[16:19], s25 offen offset:1024
    buffer_load_dword v34, v5, s[16:19], s25 offen offset:2048
    buffer_load_dword v35, v5, s[16:19], s25 offen offset:3072
    buffer_load_dword v36, v6, s[16:19], s25 offen offset:0
    buffer_load_dword v37, v6, s[16:19], s25 offen offset:1024
    buffer_load_dword v38, v6, s[16:19], s25 offen offset:2048
    buffer_load_dword v39, v6, s[16:19], s25 offen offset:3072
    s_mov_b32 s25, 294912
    buffer_load_dword v40, v5, s[16:19], s25 offen offset:0
    buffer_load_dword v41, v5, s[16:19], s25 offen offset:1024
    buffer_load_dword v42, v5, s[16:19], s25 offen offset:2048
    buffer_load_dword v43, v5, s[16:19], s25 offen offset:3072
    buffer_load_dword v44, v6, s[16:19], s25 offen offset:0
    buffer_load_dword v45, v6, s[16:19], s25 offen offset:1024
    buffer_load_dword v46, v6, s[16:19], s25 offen offset:2048
    buffer_load_dword v47, v6, s[16:19], s25 offen offset:3072
    s_waitcnt vmcnt(32)
    v_perm_b32 v64, v49, v48, s39
    v_accvgpr_write_b32 a32, v64
    v_perm_b32 v65, v51, v50, s39
    v_accvgpr_write_b32 a33, v65
    v_perm_b32 v64, v53, v52, s39
    v_accvgpr_write_b32 a34, v64
    v_perm_b32 v65, v55, v54, s39
    v_accvgpr_write_b32 a35, v65
    v_perm_b32 v64, v49, v48, s40
    v_accvgpr_write_b32 a36, v64
    v_perm_b32 v65, v51, v50, s40
    v_accvgpr_write_b32 a37, v65
    v_perm_b32 v64, v53, v52, s40
    v_accvgpr_write_b32 a38, v64
    v_perm_b32 v65, v55, v54, s40
    v_accvgpr_write_b32 a39, v65
    v_perm_b32 v64, v57, v56, s39
    v_accvgpr_write_b32 a40, v64
    v_perm_b32 v65, v59, v58, s39
    v_accvgpr_write_b32 a41, v65
    v_perm_b32 v64, v61, v60, s39
    v_accvgpr_write_b32 a42, v64
    v_perm_b32 v65, v63, v62, s39
    v_accvgpr_write_b32 a43, v65
    v_perm_b32 v64, v57, v56, s40
    v_accvgpr_write_b32 a44, v64
    v_perm_b32 v65, v59, v58, s40
    v_accvgpr_write_b32 a45, v65
    v_perm_b32 v64, v61, v60, s40
    v_accvgpr_write_b32 a46, v64
    v_perm_b32 v65, v63, v62, s40
    v_accvgpr_write_b32 a47, v65
    s_mov_b32 s25, 327680
    buffer_load_dword v48, v5, s[16:19], s25 offen offset:0
    buffer_load_dword v49, v5, s[16:19], s25 offen offset:1024
    buffer_load_dword v50, v5, s[16:19], s25 offen offset:2048
    buffer_load_dword v51, v5, s[16:19], s25 offen offset:3072
    buffer_load_dword v52, v6, s[16:19], s25 offen offset:0
    buffer_load_dword v53, v6, s[16:19], s25 offen offset:1024
    buffer_load_dword v54, v6, s[16:19], s25 offen offset:2048
    buffer_load_dword v55, v6, s[16:19], s25 offen offset:3072
    s_mov_b32 s25, 360448
    buffer_load_dword v56, v5, s[16:19], s25 offen offset:0
    buffer_load_dword v57, v5, s[16:19], s25 offen offset:1024
    buffer_load_dword v58, v5, s[16:19], s25 offen offset:2048
    buffer_load_dword v59, v5, s[16:19], s25 offen offset:3072
    buffer_load_dword v60, v6, s[16:19], s25 offen offset:0
    buffer_load_dword v61, v6, s[16:19], s25 offen offset:1024
    buffer_load_dword v62, v6, s[16:19], s25 offen offset:2048
    buffer_load_dword v63, v6, s[16:19], s25 offen offset:3072
    s_waitcnt vmcnt(32)
    v_perm_b32 v64, v17, v16, s39
    v_accvgpr_write_b32 a48, v64
    v_perm_b32 v65, v19, v18, s39
    v_accvgpr_write_b32 a49, v65
    v_perm_b32 v64, v21, v20, s39
    v_accvgpr_write_b32 a50, v64
    v_perm_b32 v65, v23, v22, s39
    v_accvgpr_write_b32 a51, v65
    v_perm_b32 v64, v17, v16, s40
    v_accvgpr_write_b32 a52, v64
    v_perm_b32 v65, v19, v18, s40
    v_accvgpr_write_b32 a53, v65
    v_perm_b32 v64, v21, v20, s40
    v_accvgpr_write_b32 a54, v64
    v_perm_b32 v65, v23, v22, s40
    v_accvgpr_write_b32 a55, v65
    v_perm_b32 v64, v25, v24, s39
    v_accvgpr_write_b32 a56, v64
    v_perm_b32 v65, v27, v26, s39
    v_accvgpr_write_b32 a57, v65
    v_perm_b32 v64, v29, v28, s39
    v_accvgpr_write_b32 a58, v64
    v_perm_b32 v65, v31, v30, s39
    v_accvgpr_write_b32 a59, v65
    v_perm_b32 v64, v25, v24, s40
    v_accvgpr_write_b32 a60, v64
    v_perm_b32 v65, v27, v26, s40
    v_accvgpr_write_b32 a61, v65
    v_perm_b32 v64, v29, v28, s40
    v_accvgpr_write_b32 a62, v64
    v_perm_b32 v65, v31, v30, s40
    v_accvgpr_write_b32 a63, v65
    s_mov_b32 s25, 393216
    buffer_load_dword v16, v5, s[16:19], s25 offen offset:0
    buffer_load_dword v17, v5, s[16:19], s25 offen offset:1024
    buffer_load_dword v18, v5, s[16:19], s25 offen offset:2048
    buffer_load_dword v19, v5, s[16:19], s25 offen offset:3072
    buffer_load_dword v20, v6, s[16:19], s25 offen offset:0
    buffer_load_dword v21, v6, s[16:19], s25 offen offset:1024
    buffer_load_dword v22, v6, s[16:19], s25 offen offset:2048
    buffer_load_dword v23, v6, s[16:19], s25 offen offset:3072
    s_mov_b32 s25, 425984
    buffer_load_dword v24, v5, s[16:19], s25 offen offset:0
    buffer_load_dword v25, v5, s[16:19], s25 offen offset:1024
    buffer_load_dword v26, v5, s[16:19], s25 offen offset:2048
    buffer_load_dword v27, v5, s[16:19], s25 offen offset:3072
    buffer_load_dword v28, v6, s[16:19], s25 offen offset:0
    buffer_load_dword v29, v6, s[16:19], s25 offen offset:1024
    buffer_load_dword v30, v6, s[16:19], s25 offen offset:2048
    buffer_load_dword v31, v6, s[16:19], s25 offen offset:3072
    s_waitcnt vmcnt(32)
    v_perm_b32 v64, v33, v32, s39
    v_accvgpr_write_b32 a64, v64
    v_perm_b32 v65, v35, v34, s39
    v_accvgpr_write_b32 a65, v65
    v_perm_b32 v64, v37, v36, s39
    v_accvgpr_write_b32 a66, v64
    v_perm_b32 v65, v39, v38, s39
    v_accvgpr_write_b32 a67, v65
    v_perm_b32 v64, v33, v32, s40
    v_accvgpr_write_b32 a68, v64
    v_perm_b32 v65, v35, v34, s40
    v_accvgpr_write_b32 a69, v65
    v_perm_b32 v64, v37, v36, s40
    v_accvgpr_write_b32 a70, v64
    v_perm_b32 v65, v39, v38, s40
    v_accvgpr_write_b32 a71, v65
    v_perm_b32 v64, v41, v40, s39
    v_accvgpr_write_b32 a72, v64
    v_perm_b32 v65, v43, v42, s39
    v_accvgpr_write_b32 a73, v65
    v_perm_b32 v64, v45, v44, s39
    v_accvgpr_write_b32 a74, v64
    v_perm_b32 v65, v47, v46, s39
    v_accvgpr_write_b32 a75, v65
    v_perm_b32 v64, v41, v40, s40
    v_accvgpr_write_b32 a76, v64
    v_perm_b32 v65, v43, v42, s40
    v_accvgpr_write_b32 a77, v65
    v_perm_b32 v64, v45, v44, s40
    v_accvgpr_write_b32 a78, v64
    v_perm_b32 v65, v47, v46, s40
    v_accvgpr_write_b32 a79, v65
    s_mov_b32 s25, 458752
    buffer_load_dword v32, v5, s[16:19], s25 offen offset:0
    buffer_load_dword v33, v5, s[16:19], s25 offen offset:1024
    buffer_load_dword v34, v5, s[16:19], s25 offen offset:2048
    buffer_load_dword v35, v5, s[16:19], s25 offen offset:3072
    buffer_load_dword v36, v6, s[16:19], s25 offen offset:0
    buffer_load_dword v37, v6, s[16:19], s25 offen offset:1024
    buffer_load_dword v38, v6, s[16:19], s25 offen offset:2048
    buffer_load_dword v39, v6, s[16:19], s25 offen offset:3072
    s_mov_b32 s25, 491520
    buffer_load_dword v40, v5, s[16:19], s25 offen offset:0
    buffer_load_dword v41, v5, s[16:19], s25 offen offset:1024
    buffer_load_dword v42, v5, s[16:19], s25 offen offset:2048
    buffer_load_dword v43, v5, s[16:19], s25 offen offset:3072
    buffer_load_dword v44, v6, s[16:19], s25 offen offset:0
    buffer_load_dword v45, v6, s[16:19], s25 offen offset:1024
    buffer_load_dword v46, v6, s[16:19], s25 offen offset:2048
    buffer_load_dword v47, v6, s[16:19], s25 offen offset:3072
    s_waitcnt vmcnt(32)
    v_perm_b32 v64, v49, v48, s39
    v_accvgpr_write_b32 a80, v64
    v_perm_b32 v65, v51, v50, s39
    v_accvgpr_write_b32 a81, v65
    v_perm_b32 v64, v53, v52, s39
    v_accvgpr_write_b32 a82, v64
    v_perm_b32 v65, v55, v54, s39
    v_accvgpr_write_b32 a83, v65
    v_perm_b32 v64, v49, v48, s40
    v_accvgpr_write_b32 a84, v64
    v_perm_b32 v65, v51, v50, s40
    v_accvgpr_write_b32 a85, v65
    v_perm_b32 v64, v53, v52, s40
    v_accvgpr_write_b32 a86, v64
    v_perm_b32 v65, v55, v54, s40
    v_accvgpr_write_b32 a87, v65
    v_perm_b32 v64, v57, v56, s39
    v_accvgpr_write_b32 a88, v64
    v_perm_b32 v65, v59, v58, s39
    v_accvgpr_write_b32 a89, v65
    v_perm_b32 v64, v61, v60, s39
    v_accvgpr_write_b32 a90, v64
    v_perm_b32 v65, v63, v62, s39
    v_accvgpr_write_b32 a91, v65
    v_perm_b32 v64, v57, v56, s40
    v_accvgpr_write_b32 a92, v64
    v_perm_b32 v65, v59, v58, s40
    v_accvgpr_write_b32 a93, v65
    v_perm_b32 v64, v61, v60, s40
    v_accvgpr_write_b32 a94, v64
    v_perm_b32 v65, v63, v62, s40
    v_accvgpr_write_b32 a95, v65
    s_mov_b32 s25, 524288
    buffer_load_dword v48, v5, s[16:19], s25 offen offset:0
    buffer_load_dword v49, v5, s[16:19], s25 offen offset:1024
    buffer_load_dword v50, v5, s[16:19], s25 offen offset:2048
    buffer_load_dword v51, v5, s[16:19], s25 offen offset:3072
    buffer_load_dword v52, v6, s[16:19], s25 offen offset:0
    buffer_load_dword v53, v6, s[16:19], s25 offen offset:1024
    buffer_load_dword v54, v6, s[16:19], s25 offen offset:2048
    buffer_load_dword v55, v6, s[16:19], s25 offen offset:3072
    s_mov_b32 s25, 557056
    buffer_load_dword v56, v5, s[16:19], s25 offen offset:0
    buffer_load_dword v57, v5, s[16:19], s25 offen offset:1024
    buffer_load_dword v58, v5, s[16:19], s25 offen offset:2048
    buffer_load_dword v59, v5, s[16:19], s25 offen offset:3072
    buffer_load_dword v60, v6, s[16:19], s25 offen offset:0
    buffer_load_dword v61, v6, s[16:19], s25 offen offset:1024
    buffer_load_dword v62, v6, s[16:19], s25 offen offset:2048
    buffer_load_dword v63, v6, s[16:19], s25 offen offset:3072
    s_waitcnt vmcnt(32)
    v_perm_b32 v64, v17, v16, s39
    v_accvgpr_write_b32 a96, v64
    v_perm_b32 v65, v19, v18, s39
    v_accvgpr_write_b32 a97, v65
    v_perm_b32 v64, v21, v20, s39
    v_accvgpr_write_b32 a98, v64
    v_perm_b32 v65, v23, v22, s39
    v_accvgpr_write_b32 a99, v65
    v_perm_b32 v64, v17, v16, s40
    v_accvgpr_write_b32 a100, v64
    v_perm_b32 v65, v19, v18, s40
    v_accvgpr_write_b32 a101, v65
    v_perm_b32 v64, v21, v20, s40
    v_accvgpr_write_b32 a102, v64
    v_perm_b32 v65, v23, v22, s40
    v_accvgpr_write_b32 a103, v65
    v_perm_b32 v64, v25, v24, s39
    v_accvgpr_write_b32 a104, v64
    v_perm_b32 v65, v27, v26, s39
    v_accvgpr_write_b32 a105, v65
    v_perm_b32 v64, v29, v28, s39
    v_accvgpr_write_b32 a106, v64
    v_perm_b32 v65, v31, v30, s39
    v_accvgpr_write_b32 a107, v65
    v_perm_b32 v64, v25, v24, s40
    v_accvgpr_write_b32 a108, v64
    v_perm_b32 v65, v27, v26, s40
    v_accvgpr_write_b32 a109, v65
    v_perm_b32 v64, v29, v28, s40
    v_accvgpr_write_b32 a110, v64
    v_perm_b32 v65, v31, v30, s40
    v_accvgpr_write_b32 a111, v65
    s_mov_b32 s25, 589824
    buffer_load_dword v16, v5, s[16:19], s25 offen offset:0
    buffer_load_dword v17, v5, s[16:19], s25 offen offset:1024
    buffer_load_dword v18, v5, s[16:19], s25 offen offset:2048
    buffer_load_dword v19, v5, s[16:19], s25 offen offset:3072
    buffer_load_dword v20, v6, s[16:19], s25 offen offset:0
    buffer_load_dword v21, v6, s[16:19], s25 offen offset:1024
    buffer_load_dword v22, v6, s[16:19], s25 offen offset:2048
    buffer_load_dword v23, v6, s[16:19], s25 offen offset:3072
    s_mov_b32 s25, 622592
    buffer_load_dword v24, v5, s[16:19], s25 offen offset:0
    buffer_load_dword v25, v5, s[16:19], s25 offen offset:1024
    buffer_load_dword v26, v5, s[16:19], s25 offen offset:2048
    buffer_load_dword v27, v5, s[16:19], s25 offen offset:3072
    buffer_load_dword v28, v6, s[16:19], s25 offen offset:0
    buffer_load_dword v29, v6, s[16:19], s25 offen offset:1024
    buffer_load_dword v30, v6, s[16:19], s25 offen offset:2048
    buffer_load_dword v31, v6, s[16:19], s25 offen offset:3072
    s_waitcnt vmcnt(32)
    v_perm_b32 v64, v33, v32, s39
    v_accvgpr_write_b32 a112, v64
    v_perm_b32 v65, v35, v34, s39
    v_accvgpr_write_b32 a113, v65
    v_perm_b32 v64, v37, v36, s39
    v_accvgpr_write_b32 a114, v64
    v_perm_b32 v65, v39, v38, s39
    v_accvgpr_write_b32 a115, v65
    v_perm_b32 v64, v33, v32, s40
    v_accvgpr_write_b32 a116, v64
    v_perm_b32 v65, v35, v34, s40
    v_accvgpr_write_b32 a117, v65
    v_perm_b32 v64, v37, v36, s40
    v_accvgpr_write_b32 a118, v64
    v_perm_b32 v65, v39, v38, s40
    v_accvgpr_write_b32 a119, v65
    v_perm_b32 v64, v41, v40, s39
    v_accvgpr_write_b32 a120, v64
    v_perm_b32 v65, v43, v42, s39
    v_accvgpr_write_b32 a121, v65
    v_perm_b32 v64, v45, v44, s39
    v_accvgpr_write_b32 a122, v64
    v_perm_b32 v65, v47, v46, s39
    v_accvgpr_write_b32 a123, v65
    v_perm_b32 v64, v41, v40, s40
    v_accvgpr_write_b32 a124, v64
    v_perm_b32 v65, v43, v42, s40
    v_accvgpr_write_b32 a125, v65
    v_perm_b32 v64, v45, v44, s40
    v_accvgpr_write_b32 a126, v64
    v_perm_b32 v65, v47, v46, s40
    v_accvgpr_write_b32 a127, v65
    s_mov_b32 s25, 655360
    buffer_load_dword v32, v5, s[16:19], s25 offen offset:0
    buffer_load_dword v33, v5, s[16:19], s25 offen offset:1024
    buffer_load_dword v34, v5, s[16:19], s25 offen offset:2048
    buffer_load_dword v35, v5, s[16:19], s25 offen offset:3072
    buffer_load_dword v36, v6, s[16:19], s25 offen offset:0
    buffer_load_dword v37, v6, s[16:19], s25 offen offset:1024
    buffer_load_dword v38, v6, s[16:19], s25 offen offset:2048
    buffer_load_dword v39, v6, s[16:19], s25 offen offset:3072
    s_mov_b32 s25, 688128
    buffer_load_dword v40, v5, s[16:19], s25 offen offset:0
    buffer_load_dword v41, v5, s[16:19], s25 offen offset:1024
    buffer_load_dword v42, v5, s[16:19], s25 offen offset:2048
    buffer_load_dword v43, v5, s[16:19], s25 offen offset:3072
    buffer_load_dword v44, v6, s[16:19], s25 offen offset:0
    buffer_load_dword v45, v6, s[16:19], s25 offen offset:1024
    buffer_load_dword v46, v6, s[16:19], s25 offen offset:2048
    buffer_load_dword v47, v6, s[16:19], s25 offen offset:3072
    s_waitcnt vmcnt(32)
    v_perm_b32 v64, v49, v48, s39
    v_accvgpr_write_b32 a128, v64
    v_perm_b32 v65, v51, v50, s39
    v_accvgpr_write_b32 a129, v65
    v_perm_b32 v64, v53, v52, s39
    v_accvgpr_write_b32 a130, v64
    v_perm_b32 v65, v55, v54, s39
    v_accvgpr_write_b32 a131, v65
    v_perm_b32 v64, v49, v48, s40
    v_accvgpr_write_b32 a132, v64
    v_perm_b32 v65, v51, v50, s40
    v_accvgpr_write_b32 a133, v65
    v_perm_b32 v64, v53, v52, s40
    v_accvgpr_write_b32 a134, v64
    v_perm_b32 v65, v55, v54, s40
    v_accvgpr_write_b32 a135, v65
    v_perm_b32 v64, v57, v56, s39
    v_accvgpr_write_b32 a136, v64
    v_perm_b32 v65, v59, v58, s39
    v_accvgpr_write_b32 a137, v65
    v_perm_b32 v64, v61, v60, s39
    v_accvgpr_write_b32 a138, v64
    v_perm_b32 v65, v63, v62, s39
    v_accvgpr_write_b32 a139, v65
    v_perm_b32 v64, v57, v56, s40
    v_accvgpr_write_b32 a140, v64
    v_perm_b32 v65, v59, v58, s40
    v_accvgpr_write_b32 a141, v65
    v_perm_b32 v64, v61, v60, s40
    v_accvgpr_write_b32 a142, v64
    v_perm_b32 v65, v63, v62, s40
    v_accvgpr_write_b32 a143, v65
    s_mov_b32 s25, 720896
    buffer_load_dword v48, v5, s[16:19], s25 offen offset:0
    buffer_load_dword v49, v5, s[16:19], s25 offen offset:1024
    buffer_load_dword v50, v5, s[16:19], s25 offen offset:2048
    buffer_load_dword v51, v5, s[16:19], s25 offen offset:3072
    buffer_load_dword v52, v6, s[16:19], s25 offen offset:0
    buffer_load_dword v53, v6, s[16:19], s25 offen offset:1024
    buffer_load_dword v54, v6, s[16:19], s25 offen offset:2048
    buffer_load_dword v55, v6, s[16:19], s25 offen offset:3072
    s_mov_b32 s25, 753664
    buffer_load_dword v56, v5, s[16:19], s25 offen offset:0
    buffer_load_dword v57, v5, s[16:19], s25 offen offset:1024
    buffer_load_dword v58, v5, s[16:19], s25 offen offset:2048
    buffer_load_dword v59, v5, s[16:19], s25 offen offset:3072
    buffer_load_dword v60, v6, s[16:19], s25 offen offset:0
    buffer_load_dword v61, v6, s[16:19], s25 offen offset:1024
    buffer_load_dword v62, v6, s[16:19], s25 offen offset:2048
    buffer_load_dword v63, v6, s[16:19], s25 offen offset:3072
    s_waitcnt vmcnt(32)
    v_perm_b32 v64, v17, v16, s39
    v_accvgpr_write_b32 a144, v64
    v_perm_b32 v65, v19, v18, s39
    v_accvgpr_write_b32 a145, v65
    v_perm_b32 v64, v21, v20, s39
    v_accvgpr_write_b32 a146, v64
    v_perm_b32 v65, v23, v22, s39
    v_accvgpr_write_b32 a147, v65
    v_perm_b32 v64, v17, v16, s40
    v_accvgpr_write_b32 a148, v64
    v_perm_b32 v65, v19, v18, s40
    v_accvgpr_write_b32 a149, v65
    v_perm_b32 v64, v21, v20, s40
    v_accvgpr_write_b32 a150, v64
    v_perm_b32 v65, v23, v22, s40
    v_accvgpr_write_b32 a151, v65
    v_perm_b32 v64, v25, v24, s39
    v_accvgpr_write_b32 a152, v64
    v_perm_b32 v65, v27, v26, s39
    v_accvgpr_write_b32 a153, v65
    v_perm_b32 v64, v29, v28, s39
    v_accvgpr_write_b32 a154, v64
    v_perm_b32 v65, v31, v30, s39
    v_accvgpr_write_b32 a155, v65
    v_perm_b32 v64, v25, v24, s40
    v_accvgpr_write_b32 a156, v64
    v_perm_b32 v65, v27, v26, s40
    v_accvgpr_write_b32 a157, v65
    v_perm_b32 v64, v29, v28, s40
    v_accvgpr_write_b32 a158, v64
    v_perm_b32 v65, v31, v30, s40
    v_accvgpr_write_b32 a159, v65
    s_mov_b32 s25, 786432
    buffer_load_dword v16, v5, s[16:19], s25 offen offset:0
    buffer_load_dword v17, v5, s[16:19], s25 offen offset:1024
    buffer_load_dword v18, v5, s[16:19], s25 offen offset:2048
    buffer_load_dword v19, v5, s[16:19], s25 offen offset:3072
    buffer_load_dword v20, v6, s[16:19], s25 offen offset:0
    buffer_load_dword v21, v6, s[16:19], s25 offen offset:1024
    buffer_load_dword v22, v6, s[16:19], s25 offen offset:2048
    buffer_load_dword v23, v6, s[16:19], s25 offen offset:3072
    s_mov_b32 s25, 819200
    buffer_load_dword v24, v5, s[16:19], s25 offen offset:0
    buffer_load_dword v25, v5, s[16:19], s25 offen offset:1024
    buffer_load_dword v26, v5, s[16:19], s25 offen offset:2048
    buffer_load_dword v27, v5, s[16:19], s25 offen offset:3072
    buffer_load_dword v28, v6, s[16:19], s25 offen offset:0
    buffer_load_dword v29, v6, s[16:19], s25 offen offset:1024
    buffer_load_dword v30, v6, s[16:19], s25 offen offset:2048
    buffer_load_dword v31, v6, s[16:19], s25 offen offset:3072
    s_waitcnt vmcnt(32)
    v_perm_b32 v64, v33, v32, s39
    v_accvgpr_write_b32 a160, v64
    v_perm_b32 v65, v35, v34, s39
    v_accvgpr_write_b32 a161, v65
    v_perm_b32 v64, v37, v36, s39
    v_accvgpr_write_b32 a162, v64
    v_perm_b32 v65, v39, v38, s39
    v_accvgpr_write_b32 a163, v65
    v_perm_b32 v64, v33, v32, s40
    v_accvgpr_write_b32 a164, v64
    v_perm_b32 v65, v35, v34, s40
    v_accvgpr_write_b32 a165, v65
    v_perm_b32 v64, v37, v36, s40
    v_accvgpr_write_b32 a166, v64
    v_perm_b32 v65, v39, v38, s40
    v_accvgpr_write_b32 a167, v65
    v_perm_b32 v64, v41, v40, s39
    v_accvgpr_write_b32 a168, v64
    v_perm_b32 v65, v43, v42, s39
    v_accvgpr_write_b32 a169, v65
    v_perm_b32 v64, v45, v44, s39
    v_accvgpr_write_b32 a170, v64
    v_perm_b32 v65, v47, v46, s39
    v_accvgpr_write_b32 a171, v65
    v_perm_b32 v64, v41, v40, s40
    v_accvgpr_write_b32 a172, v64
    v_perm_b32 v65, v43, v42, s40
    v_accvgpr_write_b32 a173, v65
    v_perm_b32 v64, v45, v44, s40
    v_accvgpr_write_b32 a174, v64
    v_perm_b32 v65, v47, v46, s40
    v_accvgpr_write_b32 a175, v65
    s_mov_b32 s25, 851968
    buffer_load_dword v32, v5, s[16:19], s25 offen offset:0
    buffer_load_dword v33, v5, s[16:19], s25 offen offset:1024
    buffer_load_dword v34, v5, s[16:19], s25 offen offset:2048
    buffer_load_dword v35, v5, s[16:19], s25 offen offset:3072
    buffer_load_dword v36, v6, s[16:19], s25 offen offset:0
    buffer_load_dword v37, v6, s[16:19], s25 offen offset:1024
    buffer_load_dword v38, v6, s[16:19], s25 offen offset:2048
    buffer_load_dword v39, v6, s[16:19], s25 offen offset:3072
    s_mov_b32 s25, 884736
    buffer_load_dword v40, v5, s[16:19], s25 offen offset:0
    buffer_load_dword v41, v5, s[16:19], s25 offen offset:1024
    buffer_load_dword v42, v5, s[16:19], s25 offen offset:2048
    buffer_load_dword v43, v5, s[16:19], s25 offen offset:3072
    buffer_load_dword v44, v6, s[16:19], s25 offen offset:0
    buffer_load_dword v45, v6, s[16:19], s25 offen offset:1024
    buffer_load_dword v46, v6, s[16:19], s25 offen offset:2048
    buffer_load_dword v47, v6, s[16:19], s25 offen offset:3072
    s_waitcnt vmcnt(32)
    v_perm_b32 v64, v49, v48, s39
    v_accvgpr_write_b32 a176, v64
    v_perm_b32 v65, v51, v50, s39
    v_accvgpr_write_b32 a177, v65
    v_perm_b32 v64, v53, v52, s39
    v_accvgpr_write_b32 a178, v64
    v_perm_b32 v65, v55, v54, s39
    v_accvgpr_write_b32 a179, v65
    v_perm_b32 v64, v49, v48, s40
    v_accvgpr_write_b32 a180, v64
    v_perm_b32 v65, v51, v50, s40
    v_accvgpr_write_b32 a181, v65
    v_perm_b32 v64, v53, v52, s40
    v_accvgpr_write_b32 a182, v64
    v_perm_b32 v65, v55, v54, s40
    v_accvgpr_write_b32 a183, v65
    v_perm_b32 v64, v57, v56, s39
    v_accvgpr_write_b32 a184, v64
    v_perm_b32 v65, v59, v58, s39
    v_accvgpr_write_b32 a185, v65
    v_perm_b32 v64, v61, v60, s39
    v_accvgpr_write_b32 a186, v64
    v_perm_b32 v65, v63, v62, s39
    v_accvgpr_write_b32 a187, v65
    v_perm_b32 v64, v57, v56, s40
    v_accvgpr_write_b32 a188, v64
    v_perm_b32 v65, v59, v58, s40
    v_accvgpr_write_b32 a189, v65
    v_perm_b32 v64, v61, v60, s40
    v_accvgpr_write_b32 a190, v64
    v_perm_b32 v65, v63, v62, s40
    v_accvgpr_write_b32 a191, v65
    s_mov_b32 s25, 917504
    buffer_load_dword v48, v5, s[16:19], s25 offen offset:0
    buffer_load_dword v49, v5, s[16:19], s25 offen offset:1024
    buffer_load_dword v50, v5, s[16:19], s25 offen offset:2048
    buffer_load_dword v51, v5, s[16:19], s25 offen offset:3072
    buffer_load_dword v52, v6, s[16:19], s25 offen offset:0
    buffer_load_dword v53, v6, s[16:19], s25 offen offset:1024
    buffer_load_dword v54, v6, s[16:19], s25 offen offset:2048
    buffer_load_dword v55, v6, s[16:19], s25 offen offset:3072
    s_mov_b32 s25, 950272
    buffer_load_dword v56, v5, s[16:19], s25 offen offset:0
    buffer_load_dword v57, v5, s[16:19], s25 offen offset:1024
    buffer_load_dword v58, v5, s[16:19], s25 offen offset:2048
    buffer_load_dword v59, v5, s[16:19], s25 offen offset:3072
    buffer_load_dword v60, v6, s[16:19], s25 offen offset:0
    buffer_load_dword v61, v6, s[16:19], s25 offen offset:1024
    buffer_load_dword v62, v6, s[16:19], s25 offen offset:2048
    buffer_load_dword v63, v6, s[16:19], s25 offen offset:3072
    s_waitcnt vmcnt(32)
    v_perm_b32 v64, v17, v16, s39
    v_accvgpr_write_b32 a192, v64
    v_perm_b32 v65, v19, v18, s39
    v_accvgpr_write_b32 a193, v65
    v_perm_b32 v64, v21, v20, s39
    v_accvgpr_write_b32 a194, v64
    v_perm_b32 v65, v23, v22, s39
    v_accvgpr_write_b32 a195, v65
    v_perm_b32 v64, v17, v16, s40
    v_accvgpr_write_b32 a196, v64
    v_perm_b32 v65, v19, v18, s40
    v_accvgpr_write_b32 a197, v65
    v_perm_b32 v64, v21, v20, s40
    v_accvgpr_write_b32 a198, v64
    v_perm_b32 v65, v23, v22, s40
    v_accvgpr_write_b32 a199, v65
    v_perm_b32 v64, v25, v24, s39
    v_accvgpr_write_b32 a200, v64
    v_perm_b32 v65, v27, v26, s39
    v_accvgpr_write_b32 a201, v65
    v_perm_b32 v64, v29, v28, s39
    v_accvgpr_write_b32 a202, v64
    v_perm_b32 v65, v31, v30, s39
    v_accvgpr_write_b32 a203, v65
    v_perm_b32 v64, v25, v24, s40
    v_accvgpr_write_b32 a204, v64
    v_perm_b32 v65, v27, v26, s40
    v_accvgpr_write_b32 a205, v65
    v_perm_b32 v64, v29, v28, s40
    v_accvgpr_write_b32 a206, v64
    v_perm_b32 v65, v31, v30, s40
    v_accvgpr_write_b32 a207, v65
    s_mov_b32 s25, 983040
    buffer_load_dword v16, v5, s[16:19], s25 offen offset:0
    buffer_load_dword v17, v5, s[16:19], s25 offen offset:1024
    buffer_load_dword v18, v5, s[16:19], s25 offen offset:2048
    buffer_load_dword v19, v5, s[16:19], s25 offen offset:3072
    buffer_load_dword v20, v6, s[16:19], s25 offen offset:0
    buffer_load_dword v21, v6, s[16:19], s25 offen offset:1024
    buffer_load_dword v22, v6, s[16:19], s25 offen offset:2048
    buffer_load_dword v23, v6, s[16:19], s25 offen offset:3072
    s_mov_b32 s25, 1015808
    buffer_load_dword v24, v5, s[16:19], s25 offen offset:0
    buffer_load_dword v25, v5, s[16:19], s25 offen offset:1024
    buffer_load_dword v26, v5, s[16:19], s25 offen offset:2048
    buffer_load_dword v27, v5, s[16:19], s25 offen offset:3072
    buffer_load_dword v28, v6, s[16:19], s25 offen offset:0
    buffer_load_dword v29, v6, s[16:19], s25 offen offset:1024
    buffer_load_dword v30, v6, s[16:19], s25 offen offset:2048
    buffer_load_dword v31, v6, s[16:19], s25 offen offset:3072
    s_waitcnt vmcnt(32)
    v_perm_b32 v64, v33, v32, s39
    v_accvgpr_write_b32 a208, v64
    v_perm_b32 v65, v35, v34, s39
    v_accvgpr_write_b32 a209, v65
    v_perm_b32 v64, v37, v36, s39
    v_accvgpr_write_b32 a210, v64
    v_perm_b32 v65, v39, v38, s39
    v_accvgpr_write_b32 a211, v65
    v_perm_b32 v64, v33, v32, s40
    v_accvgpr_write_b32 a212, v64
    v_perm_b32 v65, v35, v34, s40
    v_accvgpr_write_b32 a213, v65
    v_perm_b32 v64, v37, v36, s40
    v_accvgpr_write_b32 a214, v64
    v_perm_b32 v65, v39, v38, s40
    v_accvgpr_write_b32 a215, v65
    v_perm_b32 v64, v41, v40, s39
    v_accvgpr_write_b32 a216, v64
    v_perm_b32 v65, v43, v42, s39
    v_accvgpr_write_b32 a217, v65
    v_perm_b32 v64, v45, v44, s39
    v_accvgpr_write_b32 a218, v64
    v_perm_b32 v65, v47, v46, s39
    v_accvgpr_write_b32 a219, v65
    v_perm_b32 v64, v41, v40, s40
    v_accvgpr_write_b32 a220, v64
    v_perm_b32 v65, v43, v42, s40
    v_accvgpr_write_b32 a221, v65
    v_perm_b32 v64, v45, v44, s40
    v_accvgpr_write_b32 a222, v64
    v_perm_b32 v65, v47, v46, s40
    v_accvgpr_write_b32 a223, v65
    s_waitcnt vmcnt(16)
    v_perm_b32 v64, v49, v48, s39
    v_accvgpr_write_b32 a224, v64
    v_perm_b32 v65, v51, v50, s39
    v_accvgpr_write_b32 a225, v65
    v_perm_b32 v64, v53, v52, s39
    v_accvgpr_write_b32 a226, v64
    v_perm_b32 v65, v55, v54, s39
    v_accvgpr_write_b32 a227, v65
    v_perm_b32 v64, v49, v48, s40
    v_accvgpr_write_b32 a228, v64
    v_perm_b32 v65, v51, v50, s40
    v_accvgpr_write_b32 a229, v65
    v_perm_b32 v64, v53, v52, s40
    v_accvgpr_write_b32 a230, v64
    v_perm_b32 v65, v55, v54, s40
    v_accvgpr_write_b32 a231, v65
    v_perm_b32 v64, v57, v56, s39
    v_accvgpr_write_b32 a232, v64
    v_perm_b32 v65, v59, v58, s39
    v_accvgpr_write_b32 a233, v65
    v_perm_b32 v64, v61, v60, s39
    v_accvgpr_write_b32 a234, v64
    v_perm_b32 v65, v63, v62, s39
    v_accvgpr_write_b32 a235, v65
    v_perm_b32 v64, v57, v56, s40
    v_accvgpr_write_b32 a236, v64
    v_perm_b32 v65, v59, v58, s40
    v_accvgpr_write_b32 a237, v65
    v_perm_b32 v64, v61, v60, s40
    v_accvgpr_write_b32 a238, v64
    v_perm_b32 v65, v63, v62, s40
    v_accvgpr_write_b32 a239, v65
    s_waitcnt vmcnt(0)
    v_perm_b32 v64, v17, v16, s39
    v_accvgpr_write_b32 a240, v64
    v_perm_b32 v65, v19, v18, s39
    v_accvgpr_write_b32 a241, v65
    v_perm_b32 v64, v21, v20, s39
    v_accvgpr_write_b32 a242, v64
    v_perm_b32 v65, v23, v22, s39
    v_accvgpr_write_b32 a243, v65
    v_perm_b32 v64, v17, v16, s40
    v_accvgpr_write_b32 a244, v64
    v_perm_b32 v65, v19, v18, s40
    v_accvgpr_write_b32 a245, v65
    v_perm_b32 v64, v21, v20, s40
    v_accvgpr_write_b32 a246, v64
    v_perm_b32 v65, v23, v22, s40
    v_accvgpr_write_b32 a247, v65
    v_perm_b32 v64, v25, v24, s39
    v_accvgpr_write_b32 a248, v64
    v_perm_b32 v65, v27, v26, s39
    v_accvgpr_write_b32 a249, v65
    v_perm_b32 v64, v29, v28, s39
    v_accvgpr_write_b32 a250, v64
    v_perm_b32 v65, v31, v30, s39
    v_accvgpr_write_b32 a251, v65
    v_perm_b32 v64, v25, v24, s40
    v_accvgpr_write_b32 a252, v64
    v_perm_b32 v65, v27, v26, s40
    v_accvgpr_write_b32 a253, v65
    v_perm_b32 v64, v29, v28, s40
    v_accvgpr_write_b32 a254, v64
    v_perm_b32 v65, v31, v30, s40
    v_accvgpr_write_b32 a255, v65
L_o:
    s_lshl_b32 s32, s30, 14
    buffer_load_dword v24, v7, s[44:47], s32 offen
    s_add_u32 s25, s32, 4194304
    buffer_load_dword v25, v7, s[8:11], s25 offen sc1
    s_lshr_b32 s31, s30, 1
    s_lshl_b32 s31, s31, 8
    s_add_u32 s31, s31, 1179648
    s_lshl_b32 s33, s30, 17
    s_lshl_b32 s25, s21, 15
    s_add_u32 s33, s33, s25
    s_add_u32 s33, s33, 71303168
    s_cmp_lg_u32 s21, 0
    s_cbranch_scc1 L_wdoc_ok
    v_mov_b32 v10, 0
L_wdoc:
    buffer_load_dword v11, v10, s[8:11], s31 offen offset:128 sc1
    s_waitcnt vmcnt(0)
    v_readfirstlane_b32 s25, v11
    s_cmp_ge_u32 s25, 32
    s_cbranch_scc1 L_wdoc_ok
    s_sleep 2
    s_add_u32 s26, s26, 1
    s_cmp_lt_u32 s26, 400000
    s_cbranch_scc1 L_wdoc
L_wdoc_ok:
    s_barrier
    s_nop 1
    buffer_load_dwordx4 v[128:131], v1, s[8:11], s33 offen offset:0 sc1
    buffer_load_dwordx4 v[132:135], v1, s[8:11], s33 offen offset:1024 sc1
    buffer_load_dwordx4 v[136:139], v1, s[8:11], s33 offen offset:2048 sc1
    buffer_load_dwordx4 v[140:143], v1, s[8:11], s33 offen offset:3072 sc1
    s_add_u32 s33, s33, 4096
    buffer_load_dwordx4 v[144:147], v1, s[8:11], s33 offen offset:0 sc1
    buffer_load_dwordx4 v[148:151], v1, s[8:11], s33 offen offset:1024 sc1
    buffer_load_dwordx4 v[152:155], v1, s[8:11], s33 offen offset:2048 sc1
    buffer_load_dwordx4 v[156:159], v1, s[8:11], s33 offen offset:3072 sc1
    s_add_u32 s33, s33, 4096
    buffer_load_dwordx4 v[160:163], v1, s[8:11], s33 offen offset:0 sc1
    buffer_load_dwordx4 v[164:167], v1, s[8:11], s33 offen offset:1024 sc1
    buffer_load_dwordx4 v[168:171], v1, s[8:11], s33 offen offset:2048 sc1
    buffer_load_dwordx4 v[172:175], v1, s[8:11], s33 offen offset:3072 sc1
    s_add_u32 s33, s33, 4096
    buffer_load_dwordx4 v[176:179], v1, s[8:11], s33 offen offset:0 sc1
    buffer_load_dwordx4 v[180:183], v1, s[8:11], s33 offen offset:1024 sc1
    buffer_load_dwordx4 v[184:187], v1, s[8:11], s33 offen offset:2048 sc1
    buffer_load_dwordx4 v[188:191], v1, s[8:11], s33 offen offset:3072 sc1
    s_add_u32 s33, s33, 4096
    buffer_load_dwordx4 v[192:195], v1, s[8:11], s33 offen offset:0 sc1
    buffer_load_dwordx4 v[196:199], v1, s[8:11], s33 offen offset:1024 sc1
    buffer_load_dwordx4 v[200:203], v1, s[8:11], s33 offen offset:2048 sc1
    buffer_load_dwordx4 v[204:207], v1, s[8:11], s33 offen offset:3072 sc1
    s_add_u32 s33, s33, 4096
    buffer_load_dwordx4 v[208:211], v1, s[8:11], s33 offen offset:0 sc1
    buffer_load_dwordx4 v[212:215], v1, s[8:11], s33 offen offset:1024 sc1
    buffer_load_dwordx4 v[216:219], v1, s[8:11], s33 offen offset:2048 sc1
    buffer_load_dwordx4 v[220:223], v1, s[8:11], s33 offen offset:3072 sc1
    s_add_u32 s33, s33, 4096
    buffer_load_dwordx4 v[224:227], v1, s[8:11], s33 offen offset:0 sc1
    buffer_load_dwordx4 v[228:231], v1, s[8:11], s33 offen offset:1024 sc1
    buffer_load_dwordx4 v[232:235], v1, s[8:11], s33 offen offset:2048 sc1
    buffer_load_dwordx4 v[236:239], v1, s[8:11], s33 offen offset:3072 sc1
    s_add_u32 s33, s33, 4096
    buffer_load_dwordx4 v[240:243], v1, s[8:11], s33 offen offset:0 sc1
    buffer_load_dwordx4 v[244:247], v1, s[8:11], s33 offen offset:1024 sc1
    buffer_load_dwordx4 v[248:251], v1, s[8:11], s33 offen offset:2048 sc1
    buffer_load_dwordx4 v[252:255], v1, s[8:11], s33 offen offset:3072 sc1
    s_waitcnt vmcnt(31)
    v_mfma_f32_16x16x32_bf16 v[16:19], v[128:131], a[0:3], 0
    v_mfma_f32_16x16x32_bf16 v[20:23], v[128:131], a[4:7], 0
    s_waitcnt vmcnt(30)
    v_mfma_f32_16x16x32_bf16 v[16:19], v[132:135], a[8:11], v[16:19]
    v_mfma_f32_16x16x32_bf16 v[20:23], v[132:135], a[12:15], v[20:23]
    s_waitcnt vmcnt(29)
    v_mfma_f32_16x16x32_bf16 v[16:19], v[136:139], a[16:19], v[16:19]
    v_mfma_f32_16x16x32_bf16 v[20:23], v[136:139], a[20:23], v[20:23]
    s_waitcnt vmcnt(28)
    v_mfma_f32_16x16x32_bf16 v[16:19], v[140:143], a[24:27], v[16:19]
    v_mfma_f32_16x16x32_bf16 v[20:23], v[140:143], a[28:31], v[20:23]
    s_waitcnt vmcnt(27)
    v_mfma_f32_16x16x32_bf16 v[16:19], v[144:147], a[32:35], v[16:19]
    v_mfma_f32_16x16x32_bf16 v[20:23], v[144:147], a[36:39], v[20:23]
    s_waitcnt vmcnt(26)
    v_mfma_f32_16x16x32_bf16 v[16:19], v[148:151], a[40:43], v[16:19]
    v_mfma_f32_16x16x32_bf16 v[20:23], v[148:151], a[44:47], v[20:23]
    s_waitcnt vmcnt(25)
    v_mfma_f32_16x16x32_bf16 v[16:19], v[152:155], a[48:51], v[16:19]
    v_mfma_f32_16x16x32_bf16 v[20:23], v[152:155], a[52:55], v[20:23]
    s_waitcnt vmcnt(24)
    v_mfma_f32_16x16x32_bf16 v[16:19], v[156:159], a[56:59], v[16:19]
    v_mfma_f32_16x16x32_bf16 v[20:23], v[156:159], a[60:63], v[20:23]
    s_waitcnt vmcnt(23)
    v_mfma_f32_16x16x32_bf16 v[16:19], v[160:163], a[64:67], v[16:19]
    v_mfma_f32_16x16x32_bf16 v[20:23], v[160:163], a[68:71], v[20:23]
    s_waitcnt vmcnt(22)
    v_mfma_f32_16x16x32_bf16 v[16:19], v[164:167], a[72:75], v[16:19]
    v_mfma_f32_16x16x32_bf16 v[20:23], v[164:167], a[76:79], v[20:23]
    s_waitcnt vmcnt(21)
    v_mfma_f32_16x16x32_bf16 v[16:19], v[168:171], a[80:83], v[16:19]
    v_mfma_f32_16x16x32_bf16 v[20:23], v[168:171], a[84:87], v[20:23]
    s_waitcnt vmcnt(20)
    v_mfma_f32_16x16x32_bf16 v[16:19], v[172:175], a[88:91], v[16:19]
    v_mfma_f32_16x16x32_bf16 v[20:23], v[172:175], a[92:95], v[20:23]
    s_waitcnt vmcnt(19)
    v_mfma_f32_16x16x32_bf16 v[16:19], v[176:179], a[96:99], v[16:19]
    v_mfma_f32_16x16x32_bf16 v[20:23], v[176:179], a[100:103], v[20:23]
    s_waitcnt vmcnt(18)
    v_mfma_f32_16x16x32_bf16 v[16:19], v[180:183], a[104:107], v[16:19]
    v_mfma_f32_16x16x32_bf16 v[20:23], v[180:183], a[108:111], v[20:23]
    s_waitcnt vmcnt(17)
    v_mfma_f32_16x16x32_bf16 v[16:19], v[184:187], a[112:115], v[16:19]
    v_mfma_f32_16x16x32_bf16 v[20:23], v[184:187], a[116:119], v[20:23]
    s_waitcnt vmcnt(16)
    v_mfma_f32_16x16x32_bf16 v[16:19], v[188:191], a[120:123], v[16:19]
    v_mfma_f32_16x16x32_bf16 v[20:23], v[188:191], a[124:127], v[20:23]
    s_waitcnt vmcnt(15)
    v_mfma_f32_16x16x32_bf16 v[16:19], v[192:195], a[128:131], v[16:19]
    v_mfma_f32_16x16x32_bf16 v[20:23], v[192:195], a[132:135], v[20:23]
    s_waitcnt vmcnt(14)
    v_mfma_f32_16x16x32_bf16 v[16:19], v[196:199], a[136:139], v[16:19]
    v_mfma_f32_16x16x32_bf16 v[20:23], v[196:199], a[140:143], v[20:23]
    s_waitcnt vmcnt(13)
    v_mfma_f32_16x16x32_bf16 v[16:19], v[200:203], a[144:147], v[16:19]
    v_mfma_f32_16x16x32_bf16 v[20:23], v[200:203], a[148:151], v[20:23]
    s_waitcnt vmcnt(12)
    v_mfma_f32_16x16x32_bf16 v[16:19], v[204:207], a[152:155], v[16:19]
    v_mfma_f32_16x16x32_bf16 v[20:23], v[204:207], a[156:159], v[20:23]
    s_waitcnt vmcnt(11)
    v_mfma_f32_16x16x32_bf16 v[16:19], v[208:211], a[160:163], v[16:19]
    v_mfma_f32_16x16x32_bf16 v[20:23], v[208:211], a[164:167], v[20:23]
    s_waitcnt vmcnt(10)
    v_mfma_f32_16x16x32_bf16 v[16:19], v[212:215], a[168:171], v[16:19]
    v_mfma_f32_16x16x32_bf16 v[20:23], v[212:215], a[172:175], v[20:23]
    s_waitcnt vmcnt(9)
    v_mfma_f32_16x16x32_bf16 v[16:19], v[216:219], a[176:179], v[16:19]
    v_mfma_f32_16x16x32_bf16 v[20:23], v[216:219], a[180:183], v[20:23]
    s_waitcnt vmcnt(8)
    v_mfma_f32_16x16x32_bf16 v[16:19], v[220:223], a[184:187], v[16:19]
    v_mfma_f32_16x16x32_bf16 v[20:23], v[220:223], a[188:191], v[20:23]
    s_waitcnt vmcnt(7)
    v_mfma_f32_16x16x32_bf16 v[16:19], v[224:227], a[192:195], v[16:19]
    v_mfma_f32_16x16x32_bf16 v[20:23], v[224:227], a[196:199], v[20:23]
    s_waitcnt vmcnt(6)
    v_mfma_f32_16x16x32_bf16 v[16:19], v[228:231], a[200:203], v[16:19]
    v_mfma_f32_16x16x32_bf16 v[20:23], v[228:231], a[204:207], v[20:23]
    s_waitcnt vmcnt(5)
    v_mfma_f32_16x16x32_bf16 v[16:19], v[232:235], a[208:211], v[16:19]
    v_mfma_f32_16x16x32_bf16 v[20:23], v[232:235], a[212:215], v[20:23]
    s_waitcnt vmcnt(4)
    v_mfma_f32_16x16x32_bf16 v[16:19], v[236:239], a[216:219], v[16:19]
    v_mfma_f32_16x16x32_bf16 v[20:23], v[236:239], a[220:223], v[20:23]
    s_waitcnt vmcnt(3)
    v_mfma_f32_16x16x32_bf16 v[16:19], v[240:243], a[224:227], v[16:19]
    v_mfma_f32_16x16x32_bf16 v[20:23], v[240:243], a[228:231], v[20:23]
    s_waitcnt vmcnt(2)
    v_mfma_f32_16x16x32_bf16 v[16:19], v[244:247], a[232:235], v[16:19]
    v_mfma_f32_16x16x32_bf16 v[20:23], v[244:247], a[236:239], v[20:23]
    s_waitcnt vmcnt(1)
    v_mfma_f32_16x16x32_bf16 v[16:19], v[248:251], a[240:243], v[16:19]
    v_mfma_f32_16x16x32_bf16 v[20:23], v[248:251], a[244:247], v[20:23]
    s_waitcnt vmcnt(0)
    v_mfma_f32_16x16x32_bf16 v[16:19], v[252:255], a[248:251], v[16:19]
    v_mfma_f32_16x16x32_bf16 v[20:23], v[252:255], a[252:255], v[20:23]
    s_nop 3
    ds_write_b128 v2, v[16:19]
    s_nop 2
    ds_write_b128 v2, v[20:23] offset:4096
    s_waitcnt lgkmcnt(0)
    s_barrier
    ds_read_b32 v32, v8 offset:0
    ds_read_b32 v33, v8 offset:1024
    ds_read_b32 v34, v8 offset:2048
    ds_read_b32 v35, v8 offset:3072
    ds_read_b32 v36, v8 offset:4096
    ds_read_b32 v37, v8 offset:5120
    ds_read_b32 v38, v8 offset:6144
    ds_read_b32 v39, v8 offset:7168
    v_lshlrev_b32 v26, 16, v24
    v_and_b32 v27, 0xffff0000, v24
    v_lshlrev_b32 v28, 16, v25
    v_and_b32 v29, 0xffff0000, v25
    s_waitcnt lgkmcnt(0)
    s_barrier
    v_add_f32 v32, v32, v33
    v_add_f32 v34, v34, v35
    v_add_f32 v32, v32, v34
    v_add_f32 v36, v36, v37
    v_add_f32 v38, v38, v39
    v_add_f32 v36, v36, v38
    v_cvt_pk_bf16_f32 v33, v32, v36
    v_lshlrev_b32 v32, 16, v33
    v_and_b32 v36, 0xffff0000, v33
    v_add_f32 v32, v32, v26
    v_add_f32 v36, v36, v27
    v_cvt_pk_bf16_f32 v33, v32, v36
    v_lshlrev_b32 v32, 16, v33
    v_and_b32 v36, 0xffff0000, v33
    v_add_f32 v32, v32, v28
    v_add_f32 v36, v36, v29
    v_cvt_pk_bf16_f32 v33, v32, v36
    buffer_store_dword v33, v7, s[48:51], s32 offen
    s_add_u32 s30, s30, 6
    s_cmp_lt_u32 s30, 128
    s_cbranch_scc1 L_o
    s_branch L_end
L_end:
    s_waitcnt vmcnt(0)
    s_endpgm
L_mrole:
    s_sub_u32 s28, s24, 128
    v_lshrrev_b32 v5, 2, v1
    s_mul_i32 s25, s28, 224
    s_mul_i32 s27, s21, 458752
    s_add_u32 s25, s25, s27
    v_add_u32 v5, s25, v5
    v_lshlrev_b32 v7, 2, v0
    s_mul_i32 s25, s28, 114688
    v_add_u32 v6, s25, v7
    s_sub_u32 s25, s24, 128
    s_lshl_b32 s25, s25, 17
    s_mov_b32 s52, s86
    s_and_b32 s53, s87, 0xffff
    s_mov_b32 s54, 0x400000
    s_mov_b32 s55, 0x00020000
    buffer_load_dwordx4 v[128:131], v2, s[52:55], s25 offen
    s_add_u32 s25, s25, 4096
    buffer_load_dwordx4 v[132:135], v2, s[52:55], s25 offen
    s_add_u32 s25, s25, 4096
    buffer_load_dwordx4 v[136:139], v2, s[52:55], s25 offen
    s_add_u32 s25, s25, 4096
    buffer_load_dwordx4 v[140:143], v2, s[52:55], s25 offen
    s_add_u32 s25, s25, 4096
    buffer_load_dwordx4 v[144:147], v2, s[52:55], s25 offen
    s_add_u32 s25, s25, 4096
    buffer_load_dwordx4 v[148:151], v2, s[52:55], s25 offen
    s_add_u32 s25, s25, 4096
    buffer_load_dwordx4 v[152:155], v2, s[52:55], s25 offen
    s_add_u32 s25, s25, 4096
    buffer_load_dwordx4 v[156:159], v2, s[52:55], s25 offen
    s_add_u32 s25, s25, 4096
    buffer_load_dwordx4 v[128:131], v2, s[52:55], s25 offen
    s_add_u32 s25, s25, 4096
    buffer_load_dwordx4 v[132:135], v2, s[52:55], s25 offen
    s_add_u32 s25, s25, 4096
    buffer_load_dwordx4 v[136:139], v2, s[52:55], s25 offen
    s_add_u32 s25, s25, 4096
    buffer_load_dwordx4 v[140:143], v2, s[52:55], s25 offen
    s_add_u32 s25, s25, 4096
    buffer_load_dwordx4 v[144:147], v2, s[52:55], s25 offen
    s_add_u32 s25, s25, 4096
    buffer_load_dwordx4 v[148:151], v2, s[52:55], s25 offen
    s_add_u32 s25, s25, 4096
    buffer_load_dwordx4 v[152:155], v2, s[52:55], s25 offen
    s_add_u32 s25, s25, 4096
    buffer_load_dwordx4 v[156:159], v2, s[52:55], s25 offen
    s_add_u32 s25, s25, 4096
    buffer_load_dwordx4 v[128:131], v2, s[52:55], s25 offen
    s_add_u32 s25, s25, 4096
    buffer_load_dwordx4 v[132:135], v2, s[52:55], s25 offen
    s_add_u32 s25, s25, 4096
    buffer_load_dwordx4 v[136:139], v2, s[52:55], s25 offen
    s_add_u32 s25, s25, 4096
    buffer_load_dwordx4 v[140:143], v2, s[52:55], s25 offen
    s_add_u32 s25, s25, 4096
    buffer_load_dwordx4 v[144:147], v2, s[52:55], s25 offen
    s_add_u32 s25, s25, 4096
    buffer_load_dwordx4 v[148:151], v2, s[52:55], s25 offen
    s_add_u32 s25, s25, 4096
    buffer_load_dwordx4 v[152:155], v2, s[52:55], s25 offen
    s_add_u32 s25, s25, 4096
    buffer_load_dwordx4 v[156:159], v2, s[52:55], s25 offen
    s_add_u32 s25, s25, 4096
    buffer_load_dwordx4 v[128:131], v2, s[52:55], s25 offen
    s_add_u32 s25, s25, 4096
    buffer_load_dwordx4 v[132:135], v2, s[52:55], s25 offen
    s_add_u32 s25, s25, 4096
    buffer_load_dwordx4 v[136:139], v2, s[52:55], s25 offen
    s_add_u32 s25, s25, 4096
    buffer_load_dwordx4 v[140:143], v2, s[52:55], s25 offen
    s_add_u32 s25, s25, 4096
    buffer_load_dwordx4 v[144:147], v2, s[52:55], s25 offen
    s_add_u32 s25, s25, 4096
    buffer_load_dwordx4 v[148:151], v2, s[52:55], s25 offen
    s_add_u32 s25, s25, 4096
    buffer_load_dwordx4 v[152:155], v2, s[52:55], s25 offen
    s_add_u32 s25, s25, 4096
    buffer_load_dwordx4 v[156:159], v2, s[52:55], s25 offen
    s_add_u32 s25, s25, 4096
    s_mov_b32 s16, s90
    s_and_b32 s17, s91, 0xffff
    s_mov_b32 s18, 0x1c0000
    s_mov_b32 s19, 0x00020000
    s_mov_b32 s52, s92
    s_and_b32 s53, s93, 0xffff
    s_mov_b32 s54, 0x1c0000
    s_mov_b32 s55, 0x00020000
    s_mov_b32 s56, s94
    s_and_b32 s57, s95, 0xffff
    s_mov_b32 s58, 0x1c0000
    s_mov_b32 s59, 0x00020000
    s_cmp_lg_u32 s21, 0
    s_cbranch_scc1 L_wdlnm_ok
    v_mov_b32 v10, 0
L_wdlnm:
    buffer_load_dword v11, v10, s[12:15], 0 offen offset:68 sc1
    s_waitcnt vmcnt(0)
    v_readfirstlane_b32 s25, v11
    s_cmp_ge_u32 s25, 64
    s_cbranch_scc1 L_wdlnm_ok
    s_sleep 16
    s_add_u32 s26, s26, 1
    s_cmp_lt_u32 s26, 400000
    s_cbranch_scc1 L_wdlnm
L_wdlnm_ok:
    s_barrier
    s_nop 1
    s_mov_b32 s25, 0
    buffer_load_dword v128, v5, s[16:19], s25 offen
    buffer_load_dword a0, v5, s[52:55], s25 offen
    s_mov_b32 s25, 3584
    buffer_load_dword v129, v5, s[16:19], s25 offen
    buffer_load_dword a1, v5, s[52:55], s25 offen
    s_mov_b32 s25, 7168
    buffer_load_dword v130, v5, s[16:19], s25 offen
    buffer_load_dword a2, v5, s[52:55], s25 offen
    s_mov_b32 s25, 10752
    buffer_load_dword v131, v5, s[16:19], s25 offen
    buffer_load_dword a3, v5, s[52:55], s25 offen
    s_mov_b32 s25, 14336
    buffer_load_dword v132, v5, s[16:19], s25 offen
    buffer_load_dword a4, v5, s[52:55], s25 offen
    s_mov_b32 s25, 17920
    buffer_load_dword v133, v5, s[16:19], s25 offen
    buffer_load_dword a5, v5, s[52:55], s25 offen
    s_mov_b32 s25, 21504
    buffer_load_dword v134, v5, s[16:19], s25 offen
    buffer_load_dword a6, v5, s[52:55], s25 offen
    s_mov_b32 s25, 25088
    buffer_load_dword v135, v5, s[16:19], s25 offen
    buffer_load_dword a7, v5, s[52:55], s25 offen
    s_waitcnt vmcnt(40)
    s_mov_b32 s25, 28672
    buffer_load_dword v136, v5, s[16:19], s25 offen
    buffer_load_dword a8, v5, s[52:55], s25 offen
    s_mov_b32 s25, 32256
    buffer_load_dword v137, v5, s[16:19], s25 offen
    buffer_load_dword a9, v5, s[52:55], s25 offen
    s_mov_b32 s25, 35840
    buffer_load_dword v138, v5, s[16:19], s25 offen
    buffer_load_dword a10, v5, s[52:55], s25 offen
    s_mov_b32 s25, 39424
    buffer_load_dword v139, v5, s[16:19], s25 offen
    buffer_load_dword a11, v5, s[52:55], s25 offen
    s_mov_b32 s25, 43008
    buffer_load_dword v140, v5, s[16:19], s25 offen
    buffer_load_dword a12, v5, s[52:55], s25 offen
    s_mov_b32 s25, 46592
    buffer_load_dword v141, v5, s[16:19], s25 offen
    buffer_load_dword a13, v5, s[52:55], s25 offen
    s_mov_b32 s25, 50176
    buffer_load_dword v142, v5, s[16:19], s25 offen
    buffer_load_dword a14, v5, s[52:55], s25 offen
    s_mov_b32 s25, 53760
    buffer_load_dword v143, v5, s[16:19], s25 offen
    buffer_load_dword a15, v5, s[52:55], s25 offen
    s_waitcnt vmcnt(40)
    s_mov_b32 s25, 57344
    buffer_load_dword v144, v5, s[16:19], s25 offen
    buffer_load_dword a16, v5, s[52:55], s25 offen
    s_mov_b32 s25, 60928
    buffer_load_dword v145, v5, s[16:19], s25 offen
    buffer_load_dword a17, v5, s[52:55], s25 offen
    s_mov_b32 s25, 64512
    buffer_load_dword v146, v5, s[16:19], s25 offen
    buffer_load_dword a18, v5, s[52:55], s25 offen
    s_mov_b32 s25, 68096
    buffer_load_dword v147, v5, s[16:19], s25 offen
    buffer_load_dword a19, v5, s[52:55], s25 offen
    s_mov_b32 s25, 71680
    buffer_load_dword v148, v5, s[16:19], s25 offen
    buffer_load_dword a20, v5, s[52:55], s25 offen
    s_mov_b32 s25, 75264
    buffer_load_dword v149, v5, s[16:19], s25 offen
    buffer_load_dword a21, v5, s[52:55], s25 offen
    s_mov_b32 s25, 78848
    buffer_load_dword v150, v5, s[16:19], s25 offen
    buffer_load_dword a22, v5, s[52:55], s25 offen
    s_mov_b32 s25, 82432
    buffer_load_dword v151, v5, s[16:19], s25 offen
    buffer_load_dword a23, v5, s[52:55], s25 offen
    s_waitcnt vmcnt(40)
    s_mov_b32 s25, 86016
    buffer_load_dword v152, v5, s[16:19], s25 offen
    buffer_load_dword a24, v5, s[52:55], s25 offen
    s_mov_b32 s25, 89600
    buffer_load_dword v153, v5, s[16:19], s25 offen
    buffer_load_dword a25, v5, s[52:55], s25 offen
    s_mov_b32 s25, 93184
    buffer_load_dword v154, v5, s[16:19], s25 offen
    buffer_load_dword a26, v5, s[52:55], s25 offen
    s_mov_b32 s25, 96768
    buffer_load_dword v155, v5, s[16:19], s25 offen
    buffer_load_dword a27, v5, s[52:55], s25 offen
    s_mov_b32 s25, 100352
    buffer_load_dword v156, v5, s[16:19], s25 offen
    buffer_load_dword a28, v5, s[52:55], s25 offen
    s_mov_b32 s25, 103936
    buffer_load_dword v157, v5, s[16:19], s25 offen
    buffer_load_dword a29, v5, s[52:55], s25 offen
    s_mov_b32 s25, 107520
    buffer_load_dword v158, v5, s[16:19], s25 offen
    buffer_load_dword a30, v5, s[52:55], s25 offen
    s_mov_b32 s25, 111104
    buffer_load_dword v159, v5, s[16:19], s25 offen
    buffer_load_dword a31, v5, s[52:55], s25 offen
    s_waitcnt vmcnt(40)
    s_mov_b32 s25, 114688
    buffer_load_dword v160, v5, s[16:19], s25 offen
    buffer_load_dword a32, v5, s[52:55], s25 offen
    s_mov_b32 s25, 118272
    buffer_load_dword v161, v5, s[16:19], s25 offen
    buffer_load_dword a33, v5, s[52:55], s25 offen
    s_mov_b32 s25, 121856
    buffer_load_dword v162, v5, s[16:19], s25 offen
    buffer_load_dword a34, v5, s[52:55], s25 offen
    s_mov_b32 s25, 125440
    buffer_load_dword v163, v5, s[16:19], s25 offen
    buffer_load_dword a35, v5, s[52:55], s25 offen
    s_mov_b32 s25, 129024
    buffer_load_dword v164, v5, s[16:19], s25 offen
    buffer_load_dword a36, v5, s[52:55], s25 offen
    s_mov_b32 s25, 132608
    buffer_load_dword v165, v5, s[16:19], s25 offen
    buffer_load_dword a37, v5, s[52:55], s25 offen
    s_mov_b32 s25, 136192
    buffer_load_dword v166, v5, s[16:19], s25 offen
    buffer_load_dword a38, v5, s[52:55], s25 offen
    s_mov_b32 s25, 139776
    buffer_load_dword v167, v5, s[16:19], s25 offen
    buffer_load_dword a39, v5, s[52:55], s25 offen
    s_waitcnt vmcnt(40)
    s_mov_b32 s25, 143360
    buffer_load_dword v168, v5, s[16:19], s25 offen
    buffer_load_dword a40, v5, s[52:55], s25 offen
    s_mov_b32 s25, 146944
    buffer_load_dword v169, v5, s[16:19], s25 offen
    buffer_load_dword a41, v5, s[52:55], s25 offen
    s_mov_b32 s25, 150528
    buffer_load_dword v170, v5, s[16:19], s25 offen
    buffer_load_dword a42, v5, s[52:55], s25 offen
    s_mov_b32 s25, 154112
    buffer_load_dword v171, v5, s[16:19], s25 offen
    buffer_load_dword a43, v5, s[52:55], s25 offen
    s_mov_b32 s25, 157696
    buffer_load_dword v172, v5, s[16:19], s25 offen
    buffer_load_dword a44, v5, s[52:55], s25 offen
    s_mov_b32 s25, 161280
    buffer_load_dword v173, v5, s[16:19], s25 offen
    buffer_load_dword a45, v5, s[52:55], s25 offen
    s_mov_b32 s25, 164864
    buffer_load_dword v174, v5, s[16:19], s25 offen
    buffer_load_dword a46, v5, s[52:55], s25 offen
    s_mov_b32 s25, 168448
    buffer_load_dword v175, v5, s[16:19], s25 offen
    buffer_load_dword a47, v5, s[52:55], s25 offen
    s_waitcnt vmcnt(40)
    s_mov_b32 s25, 172032
    buffer_load_dword v176, v5, s[16:19], s25 offen
    buffer_load_dword a48, v5, s[52:55], s25 offen
    s_mov_b32 s25, 175616
    buffer_load_dword v177, v5, s[16:19], s25 offen
    buffer_load_dword a49, v5, s[52:55], s25 offen
    s_mov_b32 s25, 179200
    buffer_load_dword v178, v5, s[16:19], s25 offen
    buffer_load_dword a50, v5, s[52:55], s25 offen
    s_mov_b32 s25, 182784
    buffer_load_dword v179, v5, s[16:19], s25 offen
    buffer_load_dword a51, v5, s[52:55], s25 offen
    s_mov_b32 s25, 186368
    buffer_load_dword v180, v5, s[16:19], s25 offen
    buffer_load_dword a52, v5, s[52:55], s25 offen
    s_mov_b32 s25, 189952
    buffer_load_dword v181, v5, s[16:19], s25 offen
    buffer_load_dword a53, v5, s[52:55], s25 offen
    s_mov_b32 s25, 193536
    buffer_load_dword v182, v5, s[16:19], s25 offen
    buffer_load_dword a54, v5, s[52:55], s25 offen
    s_mov_b32 s25, 197120
    buffer_load_dword v183, v5, s[16:19], s25 offen
    buffer_load_dword a55, v5, s[52:55], s25 offen
    s_waitcnt vmcnt(40)
    s_mov_b32 s25, 200704
    buffer_load_dword v184, v5, s[16:19], s25 offen
    buffer_load_dword a56, v5, s[52:55], s25 offen
    s_mov_b32 s25, 204288
    buffer_load_dword v185, v5, s[16:19], s25 offen
    buffer_load_dword a57, v5, s[52:55], s25 offen
    s_mov_b32 s25, 207872
    buffer_load_dword v186, v5, s[16:19], s25 offen
    buffer_load_dword a58, v5, s[52:55], s25 offen
    s_mov_b32 s25, 211456
    buffer_load_dword v187, v5, s[16:19], s25 offen
    buffer_load_dword a59, v5, s[52:55], s25 offen
    s_mov_b32 s25, 215040
    buffer_load_dword v188, v5, s[16:19], s25 offen
    buffer_load_dword a60, v5, s[52:55], s25 offen
    s_mov_b32 s25, 218624
    buffer_load_dword v189, v5, s[16:19], s25 offen
    buffer_load_dword a61, v5, s[52:55], s25 offen
    s_mov_b32 s25, 222208
    buffer_load_dword v190, v5, s[16:19], s25 offen
    buffer_load_dword a62, v5, s[52:55], s25 offen
    s_mov_b32 s25, 225792
    buffer_load_dword v191, v5, s[16:19], s25 offen
    buffer_load_dword a63, v5, s[52:55], s25 offen
    s_waitcnt vmcnt(40)
    s_mov_b32 s25, 229376
    buffer_load_dword v192, v5, s[16:19], s25 offen
    buffer_load_dword a64, v5, s[52:55], s25 offen
    s_mov_b32 s25, 232960
    buffer_load_dword v193, v5, s[16:19], s25 offen
    buffer_load_dword a65, v5, s[52:55], s25 offen
    s_mov_b32 s25, 236544
    buffer_load_dword v194, v5, s[16:19], s25 offen
    buffer_load_dword a66, v5, s[52:55], s25 offen
    s_mov_b32 s25, 240128
    buffer_load_dword v195, v5, s[16:19], s25 offen
    buffer_load_dword a67, v5, s[52:55], s25 offen
    s_mov_b32 s25, 243712
    buffer_load_dword v196, v5, s[16:19], s25 offen
    buffer_load_dword a68, v5, s[52:55], s25 offen
    s_mov_b32 s25, 247296
    buffer_load_dword v197, v5, s[16:19], s25 offen
    buffer_load_dword a69, v5, s[52:55], s25 offen
    s_mov_b32 s25, 250880
    buffer_load_dword v198, v5, s[16:19], s25 offen
    buffer_load_dword a70, v5, s[52:55], s25 offen
    s_mov_b32 s25, 254464
    buffer_load_dword v199, v5, s[16:19], s25 offen
    buffer_load_dword a71, v5, s[52:55], s25 offen
    s_waitcnt vmcnt(40)
    s_mov_b32 s25, 258048
    buffer_load_dword v200, v5, s[16:19], s25 offen
    buffer_load_dword a72, v5, s[52:55], s25 offen
    s_mov_b32 s25, 261632
    buffer_load_dword v201, v5, s[16:19], s25 offen
    buffer_load_dword a73, v5, s[52:55], s25 offen
    s_mov_b32 s25, 265216
    buffer_load_dword v202, v5, s[16:19], s25 offen
    buffer_load_dword a74, v5, s[52:55], s25 offen
    s_mov_b32 s25, 268800
    buffer_load_dword v203, v5, s[16:19], s25 offen
    buffer_load_dword a75, v5, s[52:55], s25 offen
    s_mov_b32 s25, 272384
    buffer_load_dword v204, v5, s[16:19], s25 offen
    buffer_load_dword a76, v5, s[52:55], s25 offen
    s_mov_b32 s25, 275968
    buffer_load_dword v205, v5, s[16:19], s25 offen
    buffer_load_dword a77, v5, s[52:55], s25 offen
    s_mov_b32 s25, 279552
    buffer_load_dword v206, v5, s[16:19], s25 offen
    buffer_load_dword a78, v5, s[52:55], s25 offen
    s_mov_b32 s25, 283136
    buffer_load_dword v207, v5, s[16:19], s25 offen
    buffer_load_dword a79, v5, s[52:55], s25 offen
    s_waitcnt vmcnt(40)
    s_mov_b32 s25, 286720
    buffer_load_dword v208, v5, s[16:19], s25 offen
    buffer_load_dword a80, v5, s[52:55], s25 offen
    s_mov_b32 s25, 290304
    buffer_load_dword v209, v5, s[16:19], s25 offen
    buffer_load_dword a81, v5, s[52:55], s25 offen
    s_mov_b32 s25, 293888
    buffer_load_dword v210, v5, s[16:19], s25 offen
    buffer_load_dword a82, v5, s[52:55], s25 offen
    s_mov_b32 s25, 297472
    buffer_load_dword v211, v5, s[16:19], s25 offen
    buffer_load_dword a83, v5, s[52:55], s25 offen
    s_mov_b32 s25, 301056
    buffer_load_dword v212, v5, s[16:19], s25 offen
    buffer_load_dword a84, v5, s[52:55], s25 offen
    s_mov_b32 s25, 304640
    buffer_load_dword v213, v5, s[16:19], s25 offen
    buffer_load_dword a85, v5, s[52:55], s25 offen
    s_mov_b32 s25, 308224
    buffer_load_dword v214, v5, s[16:19], s25 offen
    buffer_load_dword a86, v5, s[52:55], s25 offen
    s_mov_b32 s25, 311808
    buffer_load_dword v215, v5, s[16:19], s25 offen
    buffer_load_dword a87, v5, s[52:55], s25 offen
    s_waitcnt vmcnt(40)
    s_mov_b32 s25, 315392
    buffer_load_dword v216, v5, s[16:19], s25 offen
    buffer_load_dword a88, v5, s[52:55], s25 offen
    s_mov_b32 s25, 318976
    buffer_load_dword v217, v5, s[16:19], s25 offen
    buffer_load_dword a89, v5, s[52:55], s25 offen
    s_mov_b32 s25, 322560
    buffer_load_dword v218, v5, s[16:19], s25 offen
    buffer_load_dword a90, v5, s[52:55], s25 offen
    s_mov_b32 s25, 326144
    buffer_load_dword v219, v5, s[16:19], s25 offen
    buffer_load_dword a91, v5, s[52:55], s25 offen
    s_mov_b32 s25, 329728
    buffer_load_dword v220, v5, s[16:19], s25 offen
    buffer_load_dword a92, v5, s[52:55], s25 offen
    s_mov_b32 s25, 333312
    buffer_load_dword v221, v5, s[16:19], s25 offen
    buffer_load_dword a93, v5, s[52:55], s25 offen
    s_mov_b32 s25, 336896
    buffer_load_dword v222, v5, s[16:19], s25 offen
    buffer_load_dword a94, v5, s[52:55], s25 offen
    s_mov_b32 s25, 340480
    buffer_load_dword v223, v5, s[16:19], s25 offen
    buffer_load_dword a95, v5, s[52:55], s25 offen
    s_waitcnt vmcnt(40)
    s_mov_b32 s25, 344064
    buffer_load_dword v224, v5, s[16:19], s25 offen
    buffer_load_dword a96, v5, s[52:55], s25 offen
    s_mov_b32 s25, 347648
    buffer_load_dword v225, v5, s[16:19], s25 offen
    buffer_load_dword a97, v5, s[52:55], s25 offen
    s_mov_b32 s25, 351232
    buffer_load_dword v226, v5, s[16:19], s25 offen
    buffer_load_dword a98, v5, s[52:55], s25 offen
    s_mov_b32 s25, 354816
    buffer_load_dword v227, v5, s[16:19], s25 offen
    buffer_load_dword a99, v5, s[52:55], s25 offen
    s_mov_b32 s25, 358400
    buffer_load_dword v228, v5, s[16:19], s25 offen
    buffer_load_dword a100, v5, s[52:55], s25 offen
    s_mov_b32 s25, 361984
    buffer_load_dword v229, v5, s[16:19], s25 offen
    buffer_load_dword a101, v5, s[52:55], s25 offen
    s_mov_b32 s25, 365568
    buffer_load_dword v230, v5, s[16:19], s25 offen
    buffer_load_dword a102, v5, s[52:55], s25 offen
    s_mov_b32 s25, 369152
    buffer_load_dword v231, v5, s[16:19], s25 offen
    buffer_load_dword a103, v5, s[52:55], s25 offen
    s_waitcnt vmcnt(40)
    s_mov_b32 s25, 372736
    buffer_load_dword v232, v5, s[16:19], s25 offen
    buffer_load_dword a104, v5, s[52:55], s25 offen
    s_mov_b32 s25, 376320
    buffer_load_dword v233, v5, s[16:19], s25 offen
    buffer_load_dword a105, v5, s[52:55], s25 offen
    s_mov_b32 s25, 379904
    buffer_load_dword v234, v5, s[16:19], s25 offen
    buffer_load_dword a106, v5, s[52:55], s25 offen
    s_mov_b32 s25, 383488
    buffer_load_dword v235, v5, s[16:19], s25 offen
    buffer_load_dword a107, v5, s[52:55], s25 offen
    s_mov_b32 s25, 387072
    buffer_load_dword v236, v5, s[16:19], s25 offen
    buffer_load_dword a108, v5, s[52:55], s25 offen
    s_mov_b32 s25, 390656
    buffer_load_dword v237, v5, s[16:19], s25 offen
    buffer_load_dword a109, v5, s[52:55], s25 offen
    s_mov_b32 s25, 394240
    buffer_load_dword v238, v5, s[16:19], s25 offen
    buffer_load_dword a110, v5, s[52:55], s25 offen
    s_mov_b32 s25, 397824
    buffer_load_dword v239, v5, s[16:19], s25 offen
    buffer_load_dword a111, v5, s[52:55], s25 offen
    s_waitcnt vmcnt(40)
    s_mov_b32 s25, 401408
    buffer_load_dword v240, v5, s[16:19], s25 offen
    buffer_load_dword a112, v5, s[52:55], s25 offen
    s_mov_b32 s25, 404992
    buffer_load_dword v241, v5, s[16:19], s25 offen
    buffer_load_dword a113, v5, s[52:55], s25 offen
    s_mov_b32 s25, 408576
    buffer_load_dword v242, v5, s[16:19], s25 offen
    buffer_load_dword a114, v5, s[52:55], s25 offen
    s_mov_b32 s25, 412160
    buffer_load_dword v243, v5, s[16:19], s25 offen
    buffer_load_dword a115, v5, s[52:55], s25 offen
    s_mov_b32 s25, 415744
    buffer_load_dword v244, v5, s[16:19], s25 offen
    buffer_load_dword a116, v5, s[52:55], s25 offen
    s_mov_b32 s25, 419328
    buffer_load_dword v245, v5, s[16:19], s25 offen
    buffer_load_dword a117, v5, s[52:55], s25 offen
    s_mov_b32 s25, 422912
    buffer_load_dword v246, v5, s[16:19], s25 offen
    buffer_load_dword a118, v5, s[52:55], s25 offen
    s_mov_b32 s25, 426496
    buffer_load_dword v247, v5, s[16:19], s25 offen
    buffer_load_dword a119, v5, s[52:55], s25 offen
    s_waitcnt vmcnt(40)
    s_mov_b32 s25, 430080
    buffer_load_dword v248, v5, s[16:19], s25 offen
    buffer_load_dword a120, v5, s[52:55], s25 offen
    s_mov_b32 s25, 433664
    buffer_load_dword v249, v5, s[16:19], s25 offen
    buffer_load_dword a121, v5, s[52:55], s25 offen
    s_mov_b32 s25, 437248
    buffer_load_dword v250, v5, s[16:19], s25 offen
    buffer_load_dword a122, v5, s[52:55], s25 offen
    s_mov_b32 s25, 440832
    buffer_load_dword v251, v5, s[16:19], s25 offen
    buffer_load_dword a123, v5, s[52:55], s25 offen
    s_mov_b32 s25, 444416
    buffer_load_dword v252, v5, s[16:19], s25 offen
    buffer_load_dword a124, v5, s[52:55], s25 offen
    s_mov_b32 s25, 448000
    buffer_load_dword v253, v5, s[16:19], s25 offen
    buffer_load_dword a125, v5, s[52:55], s25 offen
    s_mov_b32 s25, 451584
    buffer_load_dword v254, v5, s[16:19], s25 offen
    buffer_load_dword a126, v5, s[52:55], s25 offen
    s_mov_b32 s25, 455168
    buffer_load_dword v255, v5, s[16:19], s25 offen
    buffer_load_dword a127, v5, s[52:55], s25 offen
    s_waitcnt vmcnt(40)
    s_mov_b32 s25, 0
    buffer_load_dword a128, v6, s[56:59], s25 offen offset:0
    buffer_load_dword a129, v6, s[56:59], s25 offen offset:1024
    buffer_load_dword a130, v6, s[56:59], s25 offen offset:2048
    buffer_load_dword a131, v6, s[56:59], s25 offen offset:3072
    s_mov_b32 s25, 4096
    buffer_load_dword a132, v6, s[56:59], s25 offen offset:0
    buffer_load_dword a133, v6, s[56:59], s25 offen offset:1024
    buffer_load_dword a134, v6, s[56:59], s25 offen offset:2048
    buffer_load_dword a135, v6, s[56:59], s25 offen offset:3072
    s_mov_b32 s25, 8192
    buffer_load_dword a136, v6, s[56:59], s25 offen offset:0
    buffer_load_dword a137, v6, s[56:59], s25 offen offset:1024
    buffer_load_dword a138, v6, s[56:59], s25 offen offset:2048
    buffer_load_dword a139, v6, s[56:59], s25 offen offset:3072
    s_mov_b32 s25, 12288
    buffer_load_dword a140, v6, s[56:59], s25 offen offset:0
    buffer_load_dword a141, v6, s[56:59], s25 offen offset:1024
    buffer_load_dword a142, v6, s[56:59], s25 offen offset:2048
    buffer_load_dword a143, v6, s[56:59], s25 offen offset:3072
    s_waitcnt vmcnt(40)
    s_mov_b32 s25, 16384
    buffer_load_dword a144, v6, s[56:59], s25 offen offset:0
    buffer_load_dword a145, v6, s[56:59], s25 offen offset:1024
    buffer_load_dword a146, v6, s[56:59], s25 offen offset:2048
    buffer_load_dword a147, v6, s[56:59], s25 offen offset:3072
    s_mov_b32 s25, 20480
    buffer_load_dword a148, v6, s[56:59], s25 offen offset:0
    buffer_load_dword a149, v6, s[56:59], s25 offen offset:1024
    buffer_load_dword a150, v6, s[56:59], s25 offen offset:2048
    buffer_load_dword a151, v6, s[56:59], s25 offen offset:3072
    s_mov_b32 s25, 24576
    buffer_load_dword a152, v6, s[56:59], s25 offen offset:0
    buffer_load_dword a153, v6, s[56:59], s25 offen offset:1024
    buffer_load_dword a154, v6, s[56:59], s25 offen offset:2048
    buffer_load_dword a155, v6, s[56:59], s25 offen offset:3072
    s_mov_b32 s25, 28672
    buffer_load_dword a156, v6, s[56:59], s25 offen offset:0
    buffer_load_dword a157, v6, s[56:59], s25 offen offset:1024
    buffer_load_dword a158, v6, s[56:59], s25 offen offset:2048
    buffer_load_dword a159, v6, s[56:59], s25 offen offset:3072
    s_waitcnt vmcnt(40)
    s_mov_b32 s25, 32768
    buffer_load_dword a160, v6, s[56:59], s25 offen offset:0
    buffer_load_dword a161, v6, s[56:59], s25 offen offset:1024
    buffer_load_dword a162, v6, s[56:59], s25 offen offset:2048
    buffer_load_dword a163, v6, s[56:59], s25 offen offset:3072
    s_mov_b32 s25, 36864
    buffer_load_dword a164, v6, s[56:59], s25 offen offset:0
    buffer_load_dword a165, v6, s[56:59], s25 offen offset:1024
    buffer_load_dword a166, v6, s[56:59], s25 offen offset:2048
    buffer_load_dword a167, v6, s[56:59], s25 offen offset:3072
    s_mov_b32 s25, 40960
    buffer_load_dword a168, v6, s[56:59], s25 offen offset:0
    buffer_load_dword a169, v6, s[56:59], s25 offen offset:1024
    buffer_load_dword a170, v6, s[56:59], s25 offen offset:2048
    buffer_load_dword a171, v6, s[56:59], s25 offen offset:3072
    s_mov_b32 s25, 45056
    buffer_load_dword a172, v6, s[56:59], s25 offen offset:0
    buffer_load_dword a173, v6, s[56:59], s25 offen offset:1024
    buffer_load_dword a174, v6, s[56:59], s25 offen offset:2048
    buffer_load_dword a175, v6, s[56:59], s25 offen offset:3072
    s_waitcnt vmcnt(40)
    s_mov_b32 s25, 49152
    buffer_load_dword a176, v6, s[56:59], s25 offen offset:0
    buffer_load_dword a177, v6, s[56:59], s25 offen offset:1024
    buffer_load_dword a178, v6, s[56:59], s25 offen offset:2048
    buffer_load_dword a179, v6, s[56:59], s25 offen offset:3072
    s_mov_b32 s25, 53248
    buffer_load_dword a180, v6, s[56:59], s25 offen offset:0
    buffer_load_dword a181, v6, s[56:59], s25 offen offset:1024
    buffer_load_dword a182, v6, s[56:59], s25 offen offset:2048
    buffer_load_dword a183, v6, s[56:59], s25 offen offset:3072
    s_mov_b32 s25, 57344
    buffer_load_dword a184, v6, s[56:59], s25 offen offset:0
    buffer_load_dword a185, v6, s[56:59], s25 offen offset:1024
    buffer_load_dword a186, v6, s[56:59], s25 offen offset:2048
    buffer_load_dword a187, v6, s[56:59], s25 offen offset:3072
    s_mov_b32 s25, 61440
    buffer_load_dword a188, v6, s[56:59], s25 offen offset:0
    buffer_load_dword a189, v6, s[56:59], s25 offen offset:1024
    buffer_load_dword a190, v6, s[56:59], s25 offen offset:2048
    buffer_load_dword a191, v6, s[56:59], s25 offen offset:3072
    s_waitcnt vmcnt(40)
    s_mov_b32 s25, 65536
    buffer_load_dword a192, v6, s[56:59], s25 offen offset:0
    buffer_load_dword a193, v6, s[56:59], s25 offen offset:1024
    buffer_load_dword a194, v6, s[56:59], s25 offen offset:2048
    buffer_load_dword a195, v6, s[56:59], s25 offen offset:3072
    s_mov_b32 s25, 69632
    buffer_load_dword a196, v6, s[56:59], s25 offen offset:0
    buffer_load_dword a197, v6, s[56:59], s25 offen offset:1024
    buffer_load_dword a198, v6, s[56:59], s25 offen offset:2048
    buffer_load_dword a199, v6, s[56:59], s25 offen offset:3072
    s_mov_b32 s25, 73728
    buffer_load_dword a200, v6, s[56:59], s25 offen offset:0
    buffer_load_dword a201, v6, s[56:59], s25 offen offset:1024
    buffer_load_dword a202, v6, s[56:59], s25 offen offset:2048
    buffer_load_dword a203, v6, s[56:59], s25 offen offset:3072
    s_mov_b32 s25, 77824
    buffer_load_dword a204, v6, s[56:59], s25 offen offset:0
    buffer_load_dword a205, v6, s[56:59], s25 offen offset:1024
    buffer_load_dword a206, v6, s[56:59], s25 offen offset:2048
    buffer_load_dword a207, v6, s[56:59], s25 offen offset:3072
    s_waitcnt vmcnt(40)
    s_mov_b32 s25, 81920
    buffer_load_dword a208, v6, s[56:59], s25 offen offset:0
    buffer_load_dword a209, v6, s[56:59], s25 offen offset:1024
    buffer_load_dword a210, v6, s[56:59], s25 offen offset:2048
    buffer_load_dword a211, v6, s[56:59], s25 offen offset:3072
    s_mov_b32 s25, 86016
    buffer_load_dword a212, v6, s[56:59], s25 offen offset:0
    buffer_load_dword a213, v6, s[56:59], s25 offen offset:1024
    buffer_load_dword a214, v6, s[56:59], s25 offen offset:2048
    buffer_load_dword a215, v6, s[56:59], s25 offen offset:3072
    s_mov_b32 s25, 90112
    buffer_load_dword a216, v6, s[56:59], s25 offen offset:0
    buffer_load_dword a217, v6, s[56:59], s25 offen offset:1024
    buffer_load_dword a218, v6, s[56:59], s25 offen offset:2048
    buffer_load_dword a219, v6, s[56:59], s25 offen offset:3072
    s_mov_b32 s25, 94208
    buffer_load_dword a220, v6, s[56:59], s25 offen offset:0
    buffer_load_dword a221, v6, s[56:59], s25 offen offset:1024
    buffer_load_dword a222, v6, s[56:59], s25 offen offset:2048
    buffer_load_dword a223, v6, s[56:59], s25 offen offset:3072
    s_waitcnt vmcnt(40)
    s_mov_b32 s25, 98304
    buffer_load_dword a224, v6, s[56:59], s25 offen offset:0
    buffer_load_dword a225, v6, s[56:59], s25 offen offset:1024
    buffer_load_dword a226, v6, s[56:59], s25 offen offset:2048
    buffer_load_dword a227, v6, s[56:59], s25 offen offset:3072
    s_mov_b32 s25, 102400
    buffer_load_dword a228, v6, s[56:59], s25 offen offset:0
    buffer_load_dword a229, v6, s[56:59], s25 offen offset:1024
    buffer_load_dword a230, v6, s[56:59], s25 offen offset:2048
    buffer_load_dword a231, v6, s[56:59], s25 offen offset:3072
    s_mov_b32 s25, 106496
    buffer_load_dword a232, v6, s[56:59], s25 offen offset:0
    buffer_load_dword a233, v6, s[56:59], s25 offen offset:1024
    buffer_load_dword a234, v6, s[56:59], s25 offen offset:2048
    buffer_load_dword a235, v6, s[56:59], s25 offen offset:3072
    s_mov_b32 s25, 110592
    buffer_load_dword a236, v6, s[56:59], s25 offen offset:0
    buffer_load_dword a237, v6, s[56:59], s25 offen offset:1024
    buffer_load_dword a238, v6, s[56:59], s25 offen offset:2048
    buffer_load_dword a239, v6, s[56:59], s25 offen offset:3072
    s_waitcnt vmcnt(40)
    v_lshlrev_b32 v10, 5, v0
    s_mov_b32 s25, 6291456
    buffer_load_dwordx4 v[16:19], v10, s[8:11], s25 offen sc1
    buffer_load_dwordx4 v[20:23], v10, s[8:11], s25 offen offset:16 sc1
    v_lshlrev_b32 v10, 3, v0
    v_sub_u32 v10, 2047, v10
    s_waitcnt vmcnt(0)
    v_ashrrev_i32 v11, 31, v16
    v_or_b32 v11, 0x80000000, v11
    v_xor_b32 v16, v16, v11
    v_and_b32 v16, 0xffff0000, v16
    v_subrev_u32 v11, 0, v10
    v_or_b32 v16, v16, v11
    v_ashrrev_i32 v11, 31, v17
    v_or_b32 v11, 0x80000000, v11
    v_xor_b32 v17, v17, v11
    v_and_b32 v17, 0xffff0000, v17
    v_subrev_u32 v11, 1, v10
    v_or_b32 v17, v17, v11
    v_ashrrev_i32 v11, 31, v18
    v_or_b32 v11, 0x80000000, v11
    v_xor_b32 v18, v18, v11
    v_and_b32 v18, 0xffff0000, v18
    v_subrev_u32 v11, 2, v10
    v_or_b32 v18, v18, v11
    v_ashrrev_i32 v11, 31, v19
    v_or_b32 v11, 0x80000000, v11
    v_xor_b32 v19, v19, v11
    v_and_b32 v19, 0xffff0000, v19
    v_subrev_u32 v11, 3, v10
    v_or_b32 v19, v19, v11
    v_ashrrev_i32 v11, 31, v20
    v_or_b32 v11, 0x80000000, v11
    v_xor_b32 v20, v20, v11
    v_and_b32 v20, 0xffff0000, v20
    v_subrev_u32 v11, 4, v10
    v_or_b32 v20, v20, v11
    v_ashrrev_i32 v11, 31, v21
    v_or_b32 v11, 0x80000000, v11
    v_xor_b32 v21, v21, v11
    v_and_b32 v21, 0xffff0000, v21
    v_subrev_u32 v11, 5, v10
    v_or_b32 v21, v21, v11
    v_ashrrev_i32 v11, 31, v22
    v_or_b32 v11, 0x80000000, v11
    v_xor_b32 v22, v22, v11
    v_and_b32 v22, 0xffff0000, v22
    v_subrev_u32 v11, 6, v10
    v_or_b32 v22, v22, v11
    v_ashrrev_i32 v11, 31, v23
    v_or_b32 v11, 0x80000000, v11
    v_xor_b32 v23, v23, v11
    v_and_b32 v23, 0xffff0000, v23
    v_subrev_u32 v11, 7, v10
    v_or_b32 v23, v23, v11
    s_lshl_b32 s25, s21, 2
    v_mov_b32 v13, s25
    v_mov_b32 v14, 0
    v_max3_u32 v12, v16, v17, v18
    v_max3_u32 v12, v12, v19, v20
    v_max3_u32 v12, v12, v21, v22
    v_max_u32 v12, v12, v23
    s_nop 1
    v_max_u32_dpp v12, v12, v12 quad_perm:[1,0,3,2] row_mask:0xf bank_mask:0xf
    s_nop 1
    v_max_u32_dpp v12, v12, v12 quad_perm:[2,3,0,1] row_mask:0xf bank_mask:0xf
    s_nop 1
    v_max_u32_dpp v12, v12, v12 row_half_mirror row_mask:0xf bank_mask:0xf
    s_nop 1
    v_max_u32_dpp v12, v12, v12 row_mirror row_mask:0xf bank_mask:0xf
    v_mov_b32 v11, v12
    s_nop 1
    v_permlane16_swap_b32 v12, v11
    v_max_u32 v12, v12, v11
    v_mov_b32 v11, v12
    s_nop 1
    v_permlane32_swap_b32 v12, v11
    v_max_u32 v12, v12, v11
    ds_write_b32 v13, v12 offset:0
    s_waitcnt lgkmcnt(0)
    s_barrier
    ds_read_b128 v[24:27], v14 offset:0
    s_waitcnt lgkmcnt(0)
    v_max3_u32 v12, v24, v25, v26
    v_max_u32 v12, v12, v27
    s_nop 0
    v_readfirstlane_b32 s29, v12
    v_cmp_ne_u32 vcc, v12, v16
    s_nop 1
    v_cndmask_b32 v16, 0, v16, vcc
    v_cmp_ne_u32 vcc, v12, v17
    s_nop 1
    v_cndmask_b32 v17, 0, v17, vcc
    v_cmp_ne_u32 vcc, v12, v18
    s_nop 1
    v_cndmask_b32 v18, 0, v18, vcc
    v_cmp_ne_u32 vcc, v12, v19
    s_nop 1
    v_cndmask_b32 v19, 0, v19, vcc
    v_cmp_ne_u32 vcc, v12, v20
    s_nop 1
    v_cndmask_b32 v20, 0, v20, vcc
    v_cmp_ne_u32 vcc, v12, v21
    s_nop 1
    v_cndmask_b32 v21, 0, v21, vcc
    v_cmp_ne_u32 vcc, v12, v22
    s_nop 1
    v_cndmask_b32 v22, 0, v22, vcc
    v_cmp_ne_u32 vcc, v12, v23
    s_nop 1
    v_cndmask_b32 v23, 0, v23, vcc
    v_max3_u32 v12, v16, v17, v18
    v_max3_u32 v12, v12, v19, v20
    v_max3_u32 v12, v12, v21, v22
    v_max_u32 v12, v12, v23
    s_nop 1
    v_max_u32_dpp v12, v12, v12 quad_perm:[1,0,3,2] row_mask:0xf bank_mask:0xf
    s_nop 1
    v_max_u32_dpp v12, v12, v12 quad_perm:[2,3,0,1] row_mask:0xf bank_mask:0xf
    s_nop 1
    v_max_u32_dpp v12, v12, v12 row_half_mirror row_mask:0xf bank_mask:0xf
    s_nop 1
    v_max_u32_dpp v12, v12, v12 row_mirror row_mask:0xf bank_mask:0xf
    v_mov_b32 v11, v12
    s_nop 1
    v_permlane16_swap_b32 v12, v11
    v_max_u32 v12, v12, v11
    v_mov_b32 v11, v12
    s_nop 1
    v_permlane32_swap_b32 v12, v11
    v_max_u32 v12, v12, v11
    ds_write_b32 v13, v12 offset:16
    s_waitcnt lgkmcnt(0)
    s_barrier
    ds_read_b128 v[24:27], v14 offset:16
    s_waitcnt lgkmcnt(0)
    v_max3_u32 v12, v24, v25, v26
    v_max_u32 v12, v12, v27
    s_nop 0
    v_readfirstlane_b32 s30, v12
    s_and_b32 s29, s29, 0x7ff
    s_sub_u32 s29, 2047, s29
    s_and_b32 s30, s30, 0x7ff
    s_sub_u32 s30, 2047, s30
    s_lshl_b32 s25, s29, 10
    s_add_u32 s25, s25, 2097152
    buffer_load_dword v16, v7, s[8:11], s25 offen sc1
    s_lshl_b32 s25, s29, 2
    s_add_u32 s25, s25, 6291456
    buffer_load_dword v18, v14, s[8:11], s25 offen sc1
    s_lshl_b32 s25, s30, 10
    s_add_u32 s25, s25, 2097152
    buffer_load_dword v17, v7, s[8:11], s25 offen sc1
    s_lshl_b32 s25, s30, 2
    s_add_u32 s25, s25, 6291456
    buffer_load_dword v19, v14, s[8:11], s25 offen sc1
    v_mov_b32 v24, 0
    v_mov_b32 v25, 0
    v_mov_b32 v26, 0
    v_mov_b32 v27, 0
    v_mov_b32 v28, 0
    v_mov_b32 v29, 0
    v_mov_b32 v30, 0
    v_mov_b32 v31, 0
    s_waitcnt vmcnt(0)
    v_readlane_b32 s60, v16, 0
    v_readlane_b32 s61, v17, 0
    v_accvgpr_read_b32 v36, a0
    v_accvgpr_read_b32 v37, a1
    s_lshl_b32 s62, s60, 16
    s_lshl_b32 s63, s61, 16
    s_and_b32 s64, s60, 0xffff0000
    s_and_b32 s65, s61, 0xffff0000
    v_lshlrev_b32 v32, 16, v128
    v_and_b32 v33, 0xffff0000, v128
    v_lshlrev_b32 v34, 16, v36
    v_and_b32 v35, 0xffff0000, v36
    v_fmac_f32 v24, s62, v32
    v_fmac_f32 v25, s62, v33
    v_fmac_f32 v26, s63, v32
    v_fmac_f32 v27, s63, v33
    v_fmac_f32 v28, s62, v34
    v_fmac_f32 v29, s62, v35
    v_fmac_f32 v30, s63, v34
    v_fmac_f32 v31, s63, v35
    v_lshlrev_b32 v32, 16, v129
    v_and_b32 v33, 0xffff0000, v129
    v_lshlrev_b32 v34, 16, v37
    v_and_b32 v35, 0xffff0000, v37
    v_fmac_f32 v24, s64, v32
    v_fmac_f32 v25, s64, v33
    v_fmac_f32 v26, s65, v32
    v_fmac_f32 v27, s65, v33
    v_fmac_f32 v28, s64, v34
    v_fmac_f32 v29, s64, v35
    v_fmac_f32 v30, s65, v34
    v_fmac_f32 v31, s65, v35
    v_readlane_b32 s66, v16, 1
    v_readlane_b32 s67, v17, 1
    v_accvgpr_read_b32 v36, a2
    v_accvgpr_read_b32 v37, a3
    s_lshl_b32 s68, s66, 16
    s_lshl_b32 s69, s67, 16
    s_and_b32 s70, s66, 0xffff0000
    s_and_b32 s71, s67, 0xffff0000
    v_lshlrev_b32 v32, 16, v130
    v_and_b32 v33, 0xffff0000, v130
    v_lshlrev_b32 v34, 16, v36
    v_and_b32 v35, 0xffff0000, v36
    v_fmac_f32 v24, s68, v32
    v_fmac_f32 v25, s68, v33
    v_fmac_f32 v26, s69, v32
    v_fmac_f32 v27, s69, v33
    v_fmac_f32 v28, s68, v34
    v_fmac_f32 v29, s68, v35
    v_fmac_f32 v30, s69, v34
    v_fmac_f32 v31, s69, v35
    v_lshlrev_b32 v32, 16, v131
    v_and_b32 v33, 0xffff0000, v131
    v_lshlrev_b32 v34, 16, v37
    v_and_b32 v35, 0xffff0000, v37
    v_fmac_f32 v24, s70, v32
    v_fmac_f32 v25, s70, v33
    v_fmac_f32 v26, s71, v32
    v_fmac_f32 v27, s71, v33
    v_fmac_f32 v28, s70, v34
    v_fmac_f32 v29, s70, v35
    v_fmac_f32 v30, s71, v34
    v_fmac_f32 v31, s71, v35
    v_readlane_b32 s60, v16, 2
    v_readlane_b32 s61, v17, 2
    v_accvgpr_read_b32 v36, a4
    v_accvgpr_read_b32 v37, a5
    s_lshl_b32 s62, s60, 16
    s_lshl_b32 s63, s61, 16
    s_and_b32 s64, s60, 0xffff0000
    s_and_b32 s65, s61, 0xffff0000
    v_lshlrev_b32 v32, 16, v132
    v_and_b32 v33, 0xffff0000, v132
    v_lshlrev_b32 v34, 16, v36
    v_and_b32 v35, 0xffff0000, v36
    v_fmac_f32 v24, s62, v32
    v_fmac_f32 v25, s62, v33
    v_fmac_f32 v26, s63, v32
    v_fmac_f32 v27, s63, v33
    v_fmac_f32 v28, s62, v34
    v_fmac_f32 v29, s62, v35
    v_fmac_f32 v30, s63, v34
    v_fmac_f32 v31, s63, v35
    v_lshlrev_b32 v32, 16, v133
    v_and_b32 v33, 0xffff0000, v133
    v_lshlrev_b32 v34, 16, v37
    v_and_b32 v35, 0xffff0000, v37
    v_fmac_f32 v24, s64, v32
    v_fmac_f32 v25, s64, v33
    v_fmac_f32 v26, s65, v32
    v_fmac_f32 v27, s65, v33
    v_fmac_f32 v28, s64, v34
    v_fmac_f32 v29, s64, v35
    v_fmac_f32 v30, s65, v34
    v_fmac_f32 v31, s65, v35
    v_readlane_b32 s66, v16, 3
    v_readlane_b32 s67, v17, 3
    v_accvgpr_read_b32 v36, a6
    v_accvgpr_read_b32 v37, a7
    s_lshl_b32 s68, s66, 16
    s_lshl_b32 s69, s67, 16
    s_and_b32 s70, s66, 0xffff0000
    s_and_b32 s71, s67, 0xffff0000
    v_lshlrev_b32 v32, 16, v134
    v_and_b32 v33, 0xffff0000, v134
    v_lshlrev_b32 v34, 16, v36
    v_and_b32 v35, 0xffff0000, v36
    v_fmac_f32 v24, s68, v32
    v_fmac_f32 v25, s68, v33
    v_fmac_f32 v26, s69, v32
    v_fmac_f32 v27, s69, v33
    v_fmac_f32 v28, s68, v34
    v_fmac_f32 v29, s68, v35
    v_fmac_f32 v30, s69, v34
    v_fmac_f32 v31, s69, v35
    v_lshlrev_b32 v32, 16, v135
    v_and_b32 v33, 0xffff0000, v135
    v_lshlrev_b32 v34, 16, v37
    v_and_b32 v35, 0xffff0000, v37
    v_fmac_f32 v24, s70, v32
    v_fmac_f32 v25, s70, v33
    v_fmac_f32 v26, s71, v32
    v_fmac_f32 v27, s71, v33
    v_fmac_f32 v28, s70, v34
    v_fmac_f32 v29, s70, v35
    v_fmac_f32 v30, s71, v34
    v_fmac_f32 v31, s71, v35
    v_readlane_b32 s60, v16, 4
    v_readlane_b32 s61, v17, 4
    v_accvgpr_read_b32 v36, a8
    v_accvgpr_read_b32 v37, a9
    s_lshl_b32 s62, s60, 16
    s_lshl_b32 s63, s61, 16
    s_and_b32 s64, s60, 0xffff0000
    s_and_b32 s65, s61, 0xffff0000
    v_lshlrev_b32 v32, 16, v136
    v_and_b32 v33, 0xffff0000, v136
    v_lshlrev_b32 v34, 16, v36
    v_and_b32 v35, 0xffff0000, v36
    v_fmac_f32 v24, s62, v32
    v_fmac_f32 v25, s62, v33
    v_fmac_f32 v26, s63, v32
    v_fmac_f32 v27, s63, v33
    v_fmac_f32 v28, s62, v34
    v_fmac_f32 v29, s62, v35
    v_fmac_f32 v30, s63, v34
    v_fmac_f32 v31, s63, v35
    v_lshlrev_b32 v32, 16, v137
    v_and_b32 v33, 0xffff0000, v137
    v_lshlrev_b32 v34, 16, v37
    v_and_b32 v35, 0xffff0000, v37
    v_fmac_f32 v24, s64, v32
    v_fmac_f32 v25, s64, v33
    v_fmac_f32 v26, s65, v32
    v_fmac_f32 v27, s65, v33
    v_fmac_f32 v28, s64, v34
    v_fmac_f32 v29, s64, v35
    v_fmac_f32 v30, s65, v34
    v_fmac_f32 v31, s65, v35
    v_readlane_b32 s66, v16, 5
    v_readlane_b32 s67, v17, 5
    v_accvgpr_read_b32 v36, a10
    v_accvgpr_read_b32 v37, a11
    s_lshl_b32 s68, s66, 16
    s_lshl_b32 s69, s67, 16
    s_and_b32 s70, s66, 0xffff0000
    s_and_b32 s71, s67, 0xffff0000
    v_lshlrev_b32 v32, 16, v138
    v_and_b32 v33, 0xffff0000, v138
    v_lshlrev_b32 v34, 16, v36
    v_and_b32 v35, 0xffff0000, v36
    v_fmac_f32 v24, s68, v32
    v_fmac_f32 v25, s68, v33
    v_fmac_f32 v26, s69, v32
    v_fmac_f32 v27, s69, v33
    v_fmac_f32 v28, s68, v34
    v_fmac_f32 v29, s68, v35
    v_fmac_f32 v30, s69, v34
    v_fmac_f32 v31, s69, v35
    v_lshlrev_b32 v32, 16, v139
    v_and_b32 v33, 0xffff0000, v139
    v_lshlrev_b32 v34, 16, v37
    v_and_b32 v35, 0xffff0000, v37
    v_fmac_f32 v24, s70, v32
    v_fmac_f32 v25, s70, v33
    v_fmac_f32 v26, s71, v32
    v_fmac_f32 v27, s71, v33
    v_fmac_f32 v28, s70, v34
    v_fmac_f32 v29, s70, v35
    v_fmac_f32 v30, s71, v34
    v_fmac_f32 v31, s71, v35
    v_readlane_b32 s60, v16, 6
    v_readlane_b32 s61, v17, 6
    v_accvgpr_read_b32 v36, a12
    v_accvgpr_read_b32 v37, a13
    s_lshl_b32 s62, s60, 16
    s_lshl_b32 s63, s61, 16
    s_and_b32 s64, s60, 0xffff0000
    s_and_b32 s65, s61, 0xffff0000
    v_lshlrev_b32 v32, 16, v140
    v_and_b32 v33, 0xffff0000, v140
    v_lshlrev_b32 v34, 16, v36
    v_and_b32 v35, 0xffff0000, v36
    v_fmac_f32 v24, s62, v32
    v_fmac_f32 v25, s62, v33
    v_fmac_f32 v26, s63, v32
    v_fmac_f32 v27, s63, v33
    v_fmac_f32 v28, s62, v34
    v_fmac_f32 v29, s62, v35
    v_fmac_f32 v30, s63, v34
    v_fmac_f32 v31, s63, v35
    v_lshlrev_b32 v32, 16, v141
    v_and_b32 v33, 0xffff0000, v141
    v_lshlrev_b32 v34, 16, v37
    v_and_b32 v35, 0xffff0000, v37
    v_fmac_f32 v24, s64, v32
    v_fmac_f32 v25, s64, v33
    v_fmac_f32 v26, s65, v32
    v_fmac_f32 v27, s65, v33
    v_fmac_f32 v28, s64, v34
    v_fmac_f32 v29, s64, v35
    v_fmac_f32 v30, s65, v34
    v_fmac_f32 v31, s65, v35
    v_readlane_b32 s66, v16, 7
    v_readlane_b32 s67, v17, 7
    v_accvgpr_read_b32 v36, a14
    v_accvgpr_read_b32 v37, a15
    s_lshl_b32 s68, s66, 16
    s_lshl_b32 s69, s67, 16
    s_and_b32 s70, s66, 0xffff0000
    s_and_b32 s71, s67, 0xffff0000
    v_lshlrev_b32 v32, 16, v142
    v_and_b32 v33, 0xffff0000, v142
    v_lshlrev_b32 v34, 16, v36
    v_and_b32 v35, 0xffff0000, v36
    v_fmac_f32 v24, s68, v32
    v_fmac_f32 v25, s68, v33
    v_fmac_f32 v26, s69, v32
    v_fmac_f32 v27, s69, v33
    v_fmac_f32 v28, s68, v34
    v_fmac_f32 v29, s68, v35
    v_fmac_f32 v30, s69, v34
    v_fmac_f32 v31, s69, v35
    v_lshlrev_b32 v32, 16, v143
    v_and_b32 v33, 0xffff0000, v143
    v_lshlrev_b32 v34, 16, v37
    v_and_b32 v35, 0xffff0000, v37
    v_fmac_f32 v24, s70, v32
    v_fmac_f32 v25, s70, v33
    v_fmac_f32 v26, s71, v32
    v_fmac_f32 v27, s71, v33
    v_fmac_f32 v28, s70, v34
    v_fmac_f32 v29, s70, v35
    v_fmac_f32 v30, s71, v34
    v_fmac_f32 v31, s71, v35
    v_readlane_b32 s60, v16, 8
    v_readlane_b32 s61, v17, 8
    v_accvgpr_read_b32 v36, a16
    v_accvgpr_read_b32 v37, a17
    s_lshl_b32 s62, s60, 16
    s_lshl_b32 s63, s61, 16
    s_and_b32 s64, s60, 0xffff0000
    s_and_b32 s65, s61, 0xffff0000
    v_lshlrev_b32 v32, 16, v144
    v_and_b32 v33, 0xffff0000, v144
    v_lshlrev_b32 v34, 16, v36
    v_and_b32 v35, 0xffff0000, v36
    v_fmac_f32 v24, s62, v32
    v_fmac_f32 v25, s62, v33
    v_fmac_f32 v26, s63, v32
    v_fmac_f32 v27, s63, v33
    v_fmac_f32 v28, s62, v34
    v_fmac_f32 v29, s62, v35
    v_fmac_f32 v30, s63, v34
    v_fmac_f32 v31, s63, v35
    v_lshlrev_b32 v32, 16, v145
    v_and_b32 v33, 0xffff0000, v145
    v_lshlrev_b32 v34, 16, v37
    v_and_b32 v35, 0xffff0000, v37
    v_fmac_f32 v24, s64, v32
    v_fmac_f32 v25, s64, v33
    v_fmac_f32 v26, s65, v32
    v_fmac_f32 v27, s65, v33
    v_fmac_f32 v28, s64, v34
    v_fmac_f32 v29, s64, v35
    v_fmac_f32 v30, s65, v34
    v_fmac_f32 v31, s65, v35
    v_readlane_b32 s66, v16, 9
    v_readlane_b32 s67, v17, 9
    v_accvgpr_read_b32 v36, a18
    v_accvgpr_read_b32 v37, a19
    s_lshl_b32 s68, s66, 16
    s_lshl_b32 s69, s67, 16
    s_and_b32 s70, s66, 0xffff0000
    s_and_b32 s71, s67, 0xffff0000
    v_lshlrev_b32 v32, 16, v146
    v_and_b32 v33, 0xffff0000, v146
    v_lshlrev_b32 v34, 16, v36
    v_and_b32 v35, 0xffff0000, v36
    v_fmac_f32 v24, s68, v32
    v_fmac_f32 v25, s68, v33
    v_fmac_f32 v26, s69, v32
    v_fmac_f32 v27, s69, v33
    v_fmac_f32 v28, s68, v34
    v_fmac_f32 v29, s68, v35
    v_fmac_f32 v30, s69, v34
    v_fmac_f32 v31, s69, v35
    v_lshlrev_b32 v32, 16, v147
    v_and_b32 v33, 0xffff0000, v147
    v_lshlrev_b32 v34, 16, v37
    v_and_b32 v35, 0xffff0000, v37
    v_fmac_f32 v24, s70, v32
    v_fmac_f32 v25, s70, v33
    v_fmac_f32 v26, s71, v32
    v_fmac_f32 v27, s71, v33
    v_fmac_f32 v28, s70, v34
    v_fmac_f32 v29, s70, v35
    v_fmac_f32 v30, s71, v34
    v_fmac_f32 v31, s71, v35
    v_readlane_b32 s60, v16, 10
    v_readlane_b32 s61, v17, 10
    v_accvgpr_read_b32 v36, a20
    v_accvgpr_read_b32 v37, a21
    s_lshl_b32 s62, s60, 16
    s_lshl_b32 s63, s61, 16
    s_and_b32 s64, s60, 0xffff0000
    s_and_b32 s65, s61, 0xffff0000
    v_lshlrev_b32 v32, 16, v148
    v_and_b32 v33, 0xffff0000, v148
    v_lshlrev_b32 v34, 16, v36
    v_and_b32 v35, 0xffff0000, v36
    v_fmac_f32 v24, s62, v32
    v_fmac_f32 v25, s62, v33
    v_fmac_f32 v26, s63, v32
    v_fmac_f32 v27, s63, v33
    v_fmac_f32 v28, s62, v34
    v_fmac_f32 v29, s62, v35
    v_fmac_f32 v30, s63, v34
    v_fmac_f32 v31, s63, v35
    v_lshlrev_b32 v32, 16, v149
    v_and_b32 v33, 0xffff0000, v149
    v_lshlrev_b32 v34, 16, v37
    v_and_b32 v35, 0xffff0000, v37
    v_fmac_f32 v24, s64, v32
    v_fmac_f32 v25, s64, v33
    v_fmac_f32 v26, s65, v32
    v_fmac_f32 v27, s65, v33
    v_fmac_f32 v28, s64, v34
    v_fmac_f32 v29, s64, v35
    v_fmac_f32 v30, s65, v34
    v_fmac_f32 v31, s65, v35
    v_readlane_b32 s66, v16, 11
    v_readlane_b32 s67, v17, 11
    v_accvgpr_read_b32 v36, a22
    v_accvgpr_read_b32 v37, a23
    s_lshl_b32 s68, s66, 16
    s_lshl_b32 s69, s67, 16
    s_and_b32 s70, s66, 0xffff0000
    s_and_b32 s71, s67, 0xffff0000
    v_lshlrev_b32 v32, 16, v150
    v_and_b32 v33, 0xffff0000, v150
    v_lshlrev_b32 v34, 16, v36
    v_and_b32 v35, 0xffff0000, v36
    v_fmac_f32 v24, s68, v32
    v_fmac_f32 v25, s68, v33
    v_fmac_f32 v26, s69, v32
    v_fmac_f32 v27, s69, v33
    v_fmac_f32 v28, s68, v34
    v_fmac_f32 v29, s68, v35
    v_fmac_f32 v30, s69, v34
    v_fmac_f32 v31, s69, v35
    v_lshlrev_b32 v32, 16, v151
    v_and_b32 v33, 0xffff0000, v151
    v_lshlrev_b32 v34, 16, v37
    v_and_b32 v35, 0xffff0000, v37
    v_fmac_f32 v24, s70, v32
    v_fmac_f32 v25, s70, v33
    v_fmac_f32 v26, s71, v32
    v_fmac_f32 v27, s71, v33
    v_fmac_f32 v28, s70, v34
    v_fmac_f32 v29, s70, v35
    v_fmac_f32 v30, s71, v34
    v_fmac_f32 v31, s71, v35
    v_readlane_b32 s60, v16, 12
    v_readlane_b32 s61, v17, 12
    v_accvgpr_read_b32 v36, a24
    v_accvgpr_read_b32 v37, a25
    s_lshl_b32 s62, s60, 16
    s_lshl_b32 s63, s61, 16
    s_and_b32 s64, s60, 0xffff0000
    s_and_b32 s65, s61, 0xffff0000
    v_lshlrev_b32 v32, 16, v152
    v_and_b32 v33, 0xffff0000, v152
    v_lshlrev_b32 v34, 16, v36
    v_and_b32 v35, 0xffff0000, v36
    v_fmac_f32 v24, s62, v32
    v_fmac_f32 v25, s62, v33
    v_fmac_f32 v26, s63, v32
    v_fmac_f32 v27, s63, v33
    v_fmac_f32 v28, s62, v34
    v_fmac_f32 v29, s62, v35
    v_fmac_f32 v30, s63, v34
    v_fmac_f32 v31, s63, v35
    v_lshlrev_b32 v32, 16, v153
    v_and_b32 v33, 0xffff0000, v153
    v_lshlrev_b32 v34, 16, v37
    v_and_b32 v35, 0xffff0000, v37
    v_fmac_f32 v24, s64, v32
    v_fmac_f32 v25, s64, v33
    v_fmac_f32 v26, s65, v32
    v_fmac_f32 v27, s65, v33
    v_fmac_f32 v28, s64, v34
    v_fmac_f32 v29, s64, v35
    v_fmac_f32 v30, s65, v34
    v_fmac_f32 v31, s65, v35
    v_readlane_b32 s66, v16, 13
    v_readlane_b32 s67, v17, 13
    v_accvgpr_read_b32 v36, a26
    v_accvgpr_read_b32 v37, a27
    s_lshl_b32 s68, s66, 16
    s_lshl_b32 s69, s67, 16
    s_and_b32 s70, s66, 0xffff0000
    s_and_b32 s71, s67, 0xffff0000
    v_lshlrev_b32 v32, 16, v154
    v_and_b32 v33, 0xffff0000, v154
    v_lshlrev_b32 v34, 16, v36
    v_and_b32 v35, 0xffff0000, v36
    v_fmac_f32 v24, s68, v32
    v_fmac_f32 v25, s68, v33
    v_fmac_f32 v26, s69, v32
    v_fmac_f32 v27, s69, v33
    v_fmac_f32 v28, s68, v34
    v_fmac_f32 v29, s68, v35
    v_fmac_f32 v30, s69, v34
    v_fmac_f32 v31, s69, v35
    v_lshlrev_b32 v32, 16, v155
    v_and_b32 v33, 0xffff0000, v155
    v_lshlrev_b32 v34, 16, v37
    v_and_b32 v35, 0xffff0000, v37
    v_fmac_f32 v24, s70, v32
    v_fmac_f32 v25, s70, v33
    v_fmac_f32 v26, s71, v32
    v_fmac_f32 v27, s71, v33
    v_fmac_f32 v28, s70, v34
    v_fmac_f32 v29, s70, v35
    v_fmac_f32 v30, s71, v34
    v_fmac_f32 v31, s71, v35
    v_readlane_b32 s60, v16, 14
    v_readlane_b32 s61, v17, 14
    v_accvgpr_read_b32 v36, a28
    v_accvgpr_read_b32 v37, a29
    s_lshl_b32 s62, s60, 16
    s_lshl_b32 s63, s61, 16
    s_and_b32 s64, s60, 0xffff0000
    s_and_b32 s65, s61, 0xffff0000
    v_lshlrev_b32 v32, 16, v156
    v_and_b32 v33, 0xffff0000, v156
    v_lshlrev_b32 v34, 16, v36
    v_and_b32 v35, 0xffff0000, v36
    v_fmac_f32 v24, s62, v32
    v_fmac_f32 v25, s62, v33
    v_fmac_f32 v26, s63, v32
    v_fmac_f32 v27, s63, v33
    v_fmac_f32 v28, s62, v34
    v_fmac_f32 v29, s62, v35
    v_fmac_f32 v30, s63, v34
    v_fmac_f32 v31, s63, v35
    v_lshlrev_b32 v32, 16, v157
    v_and_b32 v33, 0xffff0000, v157
    v_lshlrev_b32 v34, 16, v37
    v_and_b32 v35, 0xffff0000, v37
    v_fmac_f32 v24, s64, v32
    v_fmac_f32 v25, s64, v33
    v_fmac_f32 v26, s65, v32
    v_fmac_f32 v27, s65, v33
    v_fmac_f32 v28, s64, v34
    v_fmac_f32 v29, s64, v35
    v_fmac_f32 v30, s65, v34
    v_fmac_f32 v31, s65, v35
    v_readlane_b32 s66, v16, 15
    v_readlane_b32 s67, v17, 15
    v_accvgpr_read_b32 v36, a30
    v_accvgpr_read_b32 v37, a31
    s_lshl_b32 s68, s66, 16
    s_lshl_b32 s69, s67, 16
    s_and_b32 s70, s66, 0xffff0000
    s_and_b32 s71, s67, 0xffff0000
    v_lshlrev_b32 v32, 16, v158
    v_and_b32 v33, 0xffff0000, v158
    v_lshlrev_b32 v34, 16, v36
    v_and_b32 v35, 0xffff0000, v36
    v_fmac_f32 v24, s68, v32
    v_fmac_f32 v25, s68, v33
    v_fmac_f32 v26, s69, v32
    v_fmac_f32 v27, s69, v33
    v_fmac_f32 v28, s68, v34
    v_fmac_f32 v29, s68, v35
    v_fmac_f32 v30, s69, v34
    v_fmac_f32 v31, s69, v35
    v_lshlrev_b32 v32, 16, v159
    v_and_b32 v33, 0xffff0000, v159
    v_lshlrev_b32 v34, 16, v37
    v_and_b32 v35, 0xffff0000, v37
    v_fmac_f32 v24, s70, v32
    v_fmac_f32 v25, s70, v33
    v_fmac_f32 v26, s71, v32
    v_fmac_f32 v27, s71, v33
    v_fmac_f32 v28, s70, v34
    v_fmac_f32 v29, s70, v35
    v_fmac_f32 v30, s71, v34
    v_fmac_f32 v31, s71, v35
    v_readlane_b32 s60, v16, 16
    v_readlane_b32 s61, v17, 16
    v_accvgpr_read_b32 v36, a32
    v_accvgpr_read_b32 v37, a33
    s_lshl_b32 s62, s60, 16
    s_lshl_b32 s63, s61, 16
    s_and_b32 s64, s60, 0xffff0000
    s_and_b32 s65, s61, 0xffff0000
    v_lshlrev_b32 v32, 16, v160
    v_and_b32 v33, 0xffff0000, v160
    v_lshlrev_b32 v34, 16, v36
    v_and_b32 v35, 0xffff0000, v36
    v_fmac_f32 v24, s62, v32
    v_fmac_f32 v25, s62, v33
    v_fmac_f32 v26, s63, v32
    v_fmac_f32 v27, s63, v33
    v_fmac_f32 v28, s62, v34
    v_fmac_f32 v29, s62, v35
    v_fmac_f32 v30, s63, v34
    v_fmac_f32 v31, s63, v35
    v_lshlrev_b32 v32, 16, v161
    v_and_b32 v33, 0xffff0000, v161
    v_lshlrev_b32 v34, 16, v37
    v_and_b32 v35, 0xffff0000, v37
    v_fmac_f32 v24, s64, v32
    v_fmac_f32 v25, s64, v33
    v_fmac_f32 v26, s65, v32
    v_fmac_f32 v27, s65, v33
    v_fmac_f32 v28, s64, v34
    v_fmac_f32 v29, s64, v35
    v_fmac_f32 v30, s65, v34
    v_fmac_f32 v31, s65, v35
    v_readlane_b32 s66, v16, 17
    v_readlane_b32 s67, v17, 17
    v_accvgpr_read_b32 v36, a34
    v_accvgpr_read_b32 v37, a35
    s_lshl_b32 s68, s66, 16
    s_lshl_b32 s69, s67, 16
    s_and_b32 s70, s66, 0xffff0000
    s_and_b32 s71, s67, 0xffff0000
    v_lshlrev_b32 v32, 16, v162
    v_and_b32 v33, 0xffff0000, v162
    v_lshlrev_b32 v34, 16, v36
    v_and_b32 v35, 0xffff0000, v36
    v_fmac_f32 v24, s68, v32
    v_fmac_f32 v25, s68, v33
    v_fmac_f32 v26, s69, v32
    v_fmac_f32 v27, s69, v33
    v_fmac_f32 v28, s68, v34
    v_fmac_f32 v29, s68, v35
    v_fmac_f32 v30, s69, v34
    v_fmac_f32 v31, s69, v35
    v_lshlrev_b32 v32, 16, v163
    v_and_b32 v33, 0xffff0000, v163
    v_lshlrev_b32 v34, 16, v37
    v_and_b32 v35, 0xffff0000, v37
    v_fmac_f32 v24, s70, v32
    v_fmac_f32 v25, s70, v33
    v_fmac_f32 v26, s71, v32
    v_fmac_f32 v27, s71, v33
    v_fmac_f32 v28, s70, v34
    v_fmac_f32 v29, s70, v35
    v_fmac_f32 v30, s71, v34
    v_fmac_f32 v31, s71, v35
    v_readlane_b32 s60, v16, 18
    v_readlane_b32 s61, v17, 18
    v_accvgpr_read_b32 v36, a36
    v_accvgpr_read_b32 v37, a37
    s_lshl_b32 s62, s60, 16
    s_lshl_b32 s63, s61, 16
    s_and_b32 s64, s60, 0xffff0000
    s_and_b32 s65, s61, 0xffff0000
    v_lshlrev_b32 v32, 16, v164
    v_and_b32 v33, 0xffff0000, v164
    v_lshlrev_b32 v34, 16, v36
    v_and_b32 v35, 0xffff0000, v36
    v_fmac_f32 v24, s62, v32
    v_fmac_f32 v25, s62, v33
    v_fmac_f32 v26, s63, v32
    v_fmac_f32 v27, s63, v33
    v_fmac_f32 v28, s62, v34
    v_fmac_f32 v29, s62, v35
    v_fmac_f32 v30, s63, v34
    v_fmac_f32 v31, s63, v35
    v_lshlrev_b32 v32, 16, v165
    v_and_b32 v33, 0xffff0000, v165
    v_lshlrev_b32 v34, 16, v37
    v_and_b32 v35, 0xffff0000, v37
    v_fmac_f32 v24, s64, v32
    v_fmac_f32 v25, s64, v33
    v_fmac_f32 v26, s65, v32
    v_fmac_f32 v27, s65, v33
    v_fmac_f32 v28, s64, v34
    v_fmac_f32 v29, s64, v35
    v_fmac_f32 v30, s65, v34
    v_fmac_f32 v31, s65, v35
    v_readlane_b32 s66, v16, 19
    v_readlane_b32 s67, v17, 19
    v_accvgpr_read_b32 v36, a38
    v_accvgpr_read_b32 v37, a39
    s_lshl_b32 s68, s66, 16
    s_lshl_b32 s69, s67, 16
    s_and_b32 s70, s66, 0xffff0000
    s_and_b32 s71, s67, 0xffff0000
    v_lshlrev_b32 v32, 16, v166
    v_and_b32 v33, 0xffff0000, v166
    v_lshlrev_b32 v34, 16, v36
    v_and_b32 v35, 0xffff0000, v36
    v_fmac_f32 v24, s68, v32
    v_fmac_f32 v25, s68, v33
    v_fmac_f32 v26, s69, v32
    v_fmac_f32 v27, s69, v33
    v_fmac_f32 v28, s68, v34
    v_fmac_f32 v29, s68, v35
    v_fmac_f32 v30, s69, v34
    v_fmac_f32 v31, s69, v35
    v_lshlrev_b32 v32, 16, v167
    v_and_b32 v33, 0xffff0000, v167
    v_lshlrev_b32 v34, 16, v37
    v_and_b32 v35, 0xffff0000, v37
    v_fmac_f32 v24, s70, v32
    v_fmac_f32 v25, s70, v33
    v_fmac_f32 v26, s71, v32
    v_fmac_f32 v27, s71, v33
    v_fmac_f32 v28, s70, v34
    v_fmac_f32 v29, s70, v35
    v_fmac_f32 v30, s71, v34
    v_fmac_f32 v31, s71, v35
    v_readlane_b32 s60, v16, 20
    v_readlane_b32 s61, v17, 20
    v_accvgpr_read_b32 v36, a40
    v_accvgpr_read_b32 v37, a41
    s_lshl_b32 s62, s60, 16
    s_lshl_b32 s63, s61, 16
    s_and_b32 s64, s60, 0xffff0000
    s_and_b32 s65, s61, 0xffff0000
    v_lshlrev_b32 v32, 16, v168
    v_and_b32 v33, 0xffff0000, v168
    v_lshlrev_b32 v34, 16, v36
    v_and_b32 v35, 0xffff0000, v36
    v_fmac_f32 v24, s62, v32
    v_fmac_f32 v25, s62, v33
    v_fmac_f32 v26, s63, v32
    v_fmac_f32 v27, s63, v33
    v_fmac_f32 v28, s62, v34
    v_fmac_f32 v29, s62, v35
    v_fmac_f32 v30, s63, v34
    v_fmac_f32 v31, s63, v35
    v_lshlrev_b32 v32, 16, v169
    v_and_b32 v33, 0xffff0000, v169
    v_lshlrev_b32 v34, 16, v37
    v_and_b32 v35, 0xffff0000, v37
    v_fmac_f32 v24, s64, v32
    v_fmac_f32 v25, s64, v33
    v_fmac_f32 v26, s65, v32
    v_fmac_f32 v27, s65, v33
    v_fmac_f32 v28, s64, v34
    v_fmac_f32 v29, s64, v35
    v_fmac_f32 v30, s65, v34
    v_fmac_f32 v31, s65, v35
    v_readlane_b32 s66, v16, 21
    v_readlane_b32 s67, v17, 21
    v_accvgpr_read_b32 v36, a42
    v_accvgpr_read_b32 v37, a43
    s_lshl_b32 s68, s66, 16
    s_lshl_b32 s69, s67, 16
    s_and_b32 s70, s66, 0xffff0000
    s_and_b32 s71, s67, 0xffff0000
    v_lshlrev_b32 v32, 16, v170
    v_and_b32 v33, 0xffff0000, v170
    v_lshlrev_b32 v34, 16, v36
    v_and_b32 v35, 0xffff0000, v36
    v_fmac_f32 v24, s68, v32
    v_fmac_f32 v25, s68, v33
    v_fmac_f32 v26, s69, v32
    v_fmac_f32 v27, s69, v33
    v_fmac_f32 v28, s68, v34
    v_fmac_f32 v29, s68, v35
    v_fmac_f32 v30, s69, v34
    v_fmac_f32 v31, s69, v35
    v_lshlrev_b32 v32, 16, v171
    v_and_b32 v33, 0xffff0000, v171
    v_lshlrev_b32 v34, 16, v37
    v_and_b32 v35, 0xffff0000, v37
    v_fmac_f32 v24, s70, v32
    v_fmac_f32 v25, s70, v33
    v_fmac_f32 v26, s71, v32
    v_fmac_f32 v27, s71, v33
    v_fmac_f32 v28, s70, v34
    v_fmac_f32 v29, s70, v35
    v_fmac_f32 v30, s71, v34
    v_fmac_f32 v31, s71, v35
    v_readlane_b32 s60, v16, 22
    v_readlane_b32 s61, v17, 22
    v_accvgpr_read_b32 v36, a44
    v_accvgpr_read_b32 v37, a45
    s_lshl_b32 s62, s60, 16
    s_lshl_b32 s63, s61, 16
    s_and_b32 s64, s60, 0xffff0000
    s_and_b32 s65, s61, 0xffff0000
    v_lshlrev_b32 v32, 16, v172
    v_and_b32 v33, 0xffff0000, v172
    v_lshlrev_b32 v34, 16, v36
    v_and_b32 v35, 0xffff0000, v36
    v_fmac_f32 v24, s62, v32
    v_fmac_f32 v25, s62, v33
    v_fmac_f32 v26, s63, v32
    v_fmac_f32 v27, s63, v33
    v_fmac_f32 v28, s62, v34
    v_fmac_f32 v29, s62, v35
    v_fmac_f32 v30, s63, v34
    v_fmac_f32 v31, s63, v35
    v_lshlrev_b32 v32, 16, v173
    v_and_b32 v33, 0xffff0000, v173
    v_lshlrev_b32 v34, 16, v37
    v_and_b32 v35, 0xffff0000, v37
    v_fmac_f32 v24, s64, v32
    v_fmac_f32 v25, s64, v33
    v_fmac_f32 v26, s65, v32
    v_fmac_f32 v27, s65, v33
    v_fmac_f32 v28, s64, v34
    v_fmac_f32 v29, s64, v35
    v_fmac_f32 v30, s65, v34
    v_fmac_f32 v31, s65, v35
    v_readlane_b32 s66, v16, 23
    v_readlane_b32 s67, v17, 23
    v_accvgpr_read_b32 v36, a46
    v_accvgpr_read_b32 v37, a47
    s_lshl_b32 s68, s66, 16
    s_lshl_b32 s69, s67, 16
    s_and_b32 s70, s66, 0xffff0000
    s_and_b32 s71, s67, 0xffff0000
    v_lshlrev_b32 v32, 16, v174
    v_and_b32 v33, 0xffff0000, v174
    v_lshlrev_b32 v34, 16, v36
    v_and_b32 v35, 0xffff0000, v36
    v_fmac_f32 v24, s68, v32
    v_fmac_f32 v25, s68, v33
    v_fmac_f32 v26, s69, v32
    v_fmac_f32 v27, s69, v33
    v_fmac_f32 v28, s68, v34
    v_fmac_f32 v29, s68, v35
    v_fmac_f32 v30, s69, v34
    v_fmac_f32 v31, s69, v35
    v_lshlrev_b32 v32, 16, v175
    v_and_b32 v33, 0xffff0000, v175
    v_lshlrev_b32 v34, 16, v37
    v_and_b32 v35, 0xffff0000, v37
    v_fmac_f32 v24, s70, v32
    v_fmac_f32 v25, s70, v33
    v_fmac_f32 v26, s71, v32
    v_fmac_f32 v27, s71, v33
    v_fmac_f32 v28, s70, v34
    v_fmac_f32 v29, s70, v35
    v_fmac_f32 v30, s71, v34
    v_fmac_f32 v31, s71, v35
    v_readlane_b32 s60, v16, 24
    v_readlane_b32 s61, v17, 24
    v_accvgpr_read_b32 v36, a48
    v_accvgpr_read_b32 v37, a49
    s_lshl_b32 s62, s60, 16
    s_lshl_b32 s63, s61, 16
    s_and_b32 s64, s60, 0xffff0000
    s_and_b32 s65, s61, 0xffff0000
    v_lshlrev_b32 v32, 16, v176
    v_and_b32 v33, 0xffff0000, v176
    v_lshlrev_b32 v34, 16, v36
    v_and_b32 v35, 0xffff0000, v36
    v_fmac_f32 v24, s62, v32
    v_fmac_f32 v25, s62, v33
    v_fmac_f32 v26, s63, v32
    v_fmac_f32 v27, s63, v33
    v_fmac_f32 v28, s62, v34
    v_fmac_f32 v29, s62, v35
    v_fmac_f32 v30, s63, v34
    v_fmac_f32 v31, s63, v35
    v_lshlrev_b32 v32, 16, v177
    v_and_b32 v33, 0xffff0000, v177
    v_lshlrev_b32 v34, 16, v37
    v_and_b32 v35, 0xffff0000, v37
    v_fmac_f32 v24, s64, v32
    v_fmac_f32 v25, s64, v33
    v_fmac_f32 v26, s65, v32
    v_fmac_f32 v27, s65, v33
    v_fmac_f32 v28, s64, v34
    v_fmac_f32 v29, s64, v35
    v_fmac_f32 v30, s65, v34
    v_fmac_f32 v31, s65, v35
    v_readlane_b32 s66, v16, 25
    v_readlane_b32 s67, v17, 25
    v_accvgpr_read_b32 v36, a50
    v_accvgpr_read_b32 v37, a51
    s_lshl_b32 s68, s66, 16
    s_lshl_b32 s69, s67, 16
    s_and_b32 s70, s66, 0xffff0000
    s_and_b32 s71, s67, 0xffff0000
    v_lshlrev_b32 v32, 16, v178
    v_and_b32 v33, 0xffff0000, v178
    v_lshlrev_b32 v34, 16, v36
    v_and_b32 v35, 0xffff0000, v36
    v_fmac_f32 v24, s68, v32
    v_fmac_f32 v25, s68, v33
    v_fmac_f32 v26, s69, v32
    v_fmac_f32 v27, s69, v33
    v_fmac_f32 v28, s68, v34
    v_fmac_f32 v29, s68, v35
    v_fmac_f32 v30, s69, v34
    v_fmac_f32 v31, s69, v35
    v_lshlrev_b32 v32, 16, v179
    v_and_b32 v33, 0xffff0000, v179
    v_lshlrev_b32 v34, 16, v37
    v_and_b32 v35, 0xffff0000, v37
    v_fmac_f32 v24, s70, v32
    v_fmac_f32 v25, s70, v33
    v_fmac_f32 v26, s71, v32
    v_fmac_f32 v27, s71, v33
    v_fmac_f32 v28, s70, v34
    v_fmac_f32 v29, s70, v35
    v_fmac_f32 v30, s71, v34
    v_fmac_f32 v31, s71, v35
    v_readlane_b32 s60, v16, 26
    v_readlane_b32 s61, v17, 26
    v_accvgpr_read_b32 v36, a52
    v_accvgpr_read_b32 v37, a53
    s_lshl_b32 s62, s60, 16
    s_lshl_b32 s63, s61, 16
    s_and_b32 s64, s60, 0xffff0000
    s_and_b32 s65, s61, 0xffff0000
    v_lshlrev_b32 v32, 16, v180
    v_and_b32 v33, 0xffff0000, v180
    v_lshlrev_b32 v34, 16, v36
    v_and_b32 v35, 0xffff0000, v36
    v_fmac_f32 v24, s62, v32
    v_fmac_f32 v25, s62, v33
    v_fmac_f32 v26, s63, v32
    v_fmac_f32 v27, s63, v33
    v_fmac_f32 v28, s62, v34
    v_fmac_f32 v29, s62, v35
    v_fmac_f32 v30, s63, v34
    v_fmac_f32 v31, s63, v35
    v_lshlrev_b32 v32, 16, v181
    v_and_b32 v33, 0xffff0000, v181
    v_lshlrev_b32 v34, 16, v37
    v_and_b32 v35, 0xffff0000, v37
    v_fmac_f32 v24, s64, v32
    v_fmac_f32 v25, s64, v33
    v_fmac_f32 v26, s65, v32
    v_fmac_f32 v27, s65, v33
    v_fmac_f32 v28, s64, v34
    v_fmac_f32 v29, s64, v35
    v_fmac_f32 v30, s65, v34
    v_fmac_f32 v31, s65, v35
    v_readlane_b32 s66, v16, 27
    v_readlane_b32 s67, v17, 27
    v_accvgpr_read_b32 v36, a54
    v_accvgpr_read_b32 v37, a55
    s_lshl_b32 s68, s66, 16
    s_lshl_b32 s69, s67, 16
    s_and_b32 s70, s66, 0xffff0000
    s_and_b32 s71, s67, 0xffff0000
    v_lshlrev_b32 v32, 16, v182
    v_and_b32 v33, 0xffff0000, v182
    v_lshlrev_b32 v34, 16, v36
    v_and_b32 v35, 0xffff0000, v36
    v_fmac_f32 v24, s68, v32
    v_fmac_f32 v25, s68, v33
    v_fmac_f32 v26, s69, v32
    v_fmac_f32 v27, s69, v33
    v_fmac_f32 v28, s68, v34
    v_fmac_f32 v29, s68, v35
    v_fmac_f32 v30, s69, v34
    v_fmac_f32 v31, s69, v35
    v_lshlrev_b32 v32, 16, v183
    v_and_b32 v33, 0xffff0000, v183
    v_lshlrev_b32 v34, 16, v37
    v_and_b32 v35, 0xffff0000, v37
    v_fmac_f32 v24, s70, v32
    v_fmac_f32 v25, s70, v33
    v_fmac_f32 v26, s71, v32
    v_fmac_f32 v27, s71, v33
    v_fmac_f32 v28, s70, v34
    v_fmac_f32 v29, s70, v35
    v_fmac_f32 v30, s71, v34
    v_fmac_f32 v31, s71, v35
    v_readlane_b32 s60, v16, 28
    v_readlane_b32 s61, v17, 28
    v_accvgpr_read_b32 v36, a56
    v_accvgpr_read_b32 v37, a57
    s_lshl_b32 s62, s60, 16
    s_lshl_b32 s63, s61, 16
    s_and_b32 s64, s60, 0xffff0000
    s_and_b32 s65, s61, 0xffff0000
    v_lshlrev_b32 v32, 16, v184
    v_and_b32 v33, 0xffff0000, v184
    v_lshlrev_b32 v34, 16, v36
    v_and_b32 v35, 0xffff0000, v36
    v_fmac_f32 v24, s62, v32
    v_fmac_f32 v25, s62, v33
    v_fmac_f32 v26, s63, v32
    v_fmac_f32 v27, s63, v33
    v_fmac_f32 v28, s62, v34
    v_fmac_f32 v29, s62, v35
    v_fmac_f32 v30, s63, v34
    v_fmac_f32 v31, s63, v35
    v_lshlrev_b32 v32, 16, v185
    v_and_b32 v33, 0xffff0000, v185
    v_lshlrev_b32 v34, 16, v37
    v_and_b32 v35, 0xffff0000, v37
    v_fmac_f32 v24, s64, v32
    v_fmac_f32 v25, s64, v33
    v_fmac_f32 v26, s65, v32
    v_fmac_f32 v27, s65, v33
    v_fmac_f32 v28, s64, v34
    v_fmac_f32 v29, s64, v35
    v_fmac_f32 v30, s65, v34
    v_fmac_f32 v31, s65, v35
    v_readlane_b32 s66, v16, 29
    v_readlane_b32 s67, v17, 29
    v_accvgpr_read_b32 v36, a58
    v_accvgpr_read_b32 v37, a59
    s_lshl_b32 s68, s66, 16
    s_lshl_b32 s69, s67, 16
    s_and_b32 s70, s66, 0xffff0000
    s_and_b32 s71, s67, 0xffff0000
    v_lshlrev_b32 v32, 16, v186
    v_and_b32 v33, 0xffff0000, v186
    v_lshlrev_b32 v34, 16, v36
    v_and_b32 v35, 0xffff0000, v36
    v_fmac_f32 v24, s68, v32
    v_fmac_f32 v25, s68, v33
    v_fmac_f32 v26, s69, v32
    v_fmac_f32 v27, s69, v33
    v_fmac_f32 v28, s68, v34
    v_fmac_f32 v29, s68, v35
    v_fmac_f32 v30, s69, v34
    v_fmac_f32 v31, s69, v35
    v_lshlrev_b32 v32, 16, v187
    v_and_b32 v33, 0xffff0000, v187
    v_lshlrev_b32 v34, 16, v37
    v_and_b32 v35, 0xffff0000, v37
    v_fmac_f32 v24, s70, v32
    v_fmac_f32 v25, s70, v33
    v_fmac_f32 v26, s71, v32
    v_fmac_f32 v27, s71, v33
    v_fmac_f32 v28, s70, v34
    v_fmac_f32 v29, s70, v35
    v_fmac_f32 v30, s71, v34
    v_fmac_f32 v31, s71, v35
    v_readlane_b32 s60, v16, 30
    v_readlane_b32 s61, v17, 30
    v_accvgpr_read_b32 v36, a60
    v_accvgpr_read_b32 v37, a61
    s_lshl_b32 s62, s60, 16
    s_lshl_b32 s63, s61, 16
    s_and_b32 s64, s60, 0xffff0000
    s_and_b32 s65, s61, 0xffff0000
    v_lshlrev_b32 v32, 16, v188
    v_and_b32 v33, 0xffff0000, v188
    v_lshlrev_b32 v34, 16, v36
    v_and_b32 v35, 0xffff0000, v36
    v_fmac_f32 v24, s62, v32
    v_fmac_f32 v25, s62, v33
    v_fmac_f32 v26, s63, v32
    v_fmac_f32 v27, s63, v33
    v_fmac_f32 v28, s62, v34
    v_fmac_f32 v29, s62, v35
    v_fmac_f32 v30, s63, v34
    v_fmac_f32 v31, s63, v35
    v_lshlrev_b32 v32, 16, v189
    v_and_b32 v33, 0xffff0000, v189
    v_lshlrev_b32 v34, 16, v37
    v_and_b32 v35, 0xffff0000, v37
    v_fmac_f32 v24, s64, v32
    v_fmac_f32 v25, s64, v33
    v_fmac_f32 v26, s65, v32
    v_fmac_f32 v27, s65, v33
    v_fmac_f32 v28, s64, v34
    v_fmac_f32 v29, s64, v35
    v_fmac_f32 v30, s65, v34
    v_fmac_f32 v31, s65, v35
    v_readlane_b32 s66, v16, 31
    v_readlane_b32 s67, v17, 31
    v_accvgpr_read_b32 v36, a62
    v_accvgpr_read_b32 v37, a63
    s_lshl_b32 s68, s66, 16
    s_lshl_b32 s69, s67, 16
    s_and_b32 s70, s66, 0xffff0000
    s_and_b32 s71, s67, 0xffff0000
    v_lshlrev_b32 v32, 16, v190
    v_and_b32 v33, 0xffff0000, v190
    v_lshlrev_b32 v34, 16, v36
    v_and_b32 v35, 0xffff0000, v36
    v_fmac_f32 v24, s68, v32
    v_fmac_f32 v25, s68, v33
    v_fmac_f32 v26, s69, v32
    v_fmac_f32 v27, s69, v33
    v_fmac_f32 v28, s68, v34
    v_fmac_f32 v29, s68, v35
    v_fmac_f32 v30, s69, v34
    v_fmac_f32 v31, s69, v35
    v_lshlrev_b32 v32, 16, v191
    v_and_b32 v33, 0xffff0000, v191
    v_lshlrev_b32 v34, 16, v37
    v_and_b32 v35, 0xffff0000, v37
    v_fmac_f32 v24, s70, v32
    v_fmac_f32 v25, s70, v33
    v_fmac_f32 v26, s71, v32
    v_fmac_f32 v27, s71, v33
    v_fmac_f32 v28, s70, v34
    v_fmac_f32 v29, s70, v35
    v_fmac_f32 v30, s71, v34
    v_fmac_f32 v31, s71, v35
    v_readlane_b32 s60, v16, 32
    v_readlane_b32 s61, v17, 32
    v_accvgpr_read_b32 v36, a64
    v_accvgpr_read_b32 v37, a65
    s_lshl_b32 s62, s60, 16
    s_lshl_b32 s63, s61, 16
    s_and_b32 s64, s60, 0xffff0000
    s_and_b32 s65, s61, 0xffff0000
    v_lshlrev_b32 v32, 16, v192
    v_and_b32 v33, 0xffff0000, v192
    v_lshlrev_b32 v34, 16, v36
    v_and_b32 v35, 0xffff0000, v36
    v_fmac_f32 v24, s62, v32
    v_fmac_f32 v25, s62, v33
    v_fmac_f32 v26, s63, v32
    v_fmac_f32 v27, s63, v33
    v_fmac_f32 v28, s62, v34
    v_fmac_f32 v29, s62, v35
    v_fmac_f32 v30, s63, v34
    v_fmac_f32 v31, s63, v35
    v_lshlrev_b32 v32, 16, v193
    v_and_b32 v33, 0xffff0000, v193
    v_lshlrev_b32 v34, 16, v37
    v_and_b32 v35, 0xffff0000, v37
    v_fmac_f32 v24, s64, v32
    v_fmac_f32 v25, s64, v33
    v_fmac_f32 v26, s65, v32
    v_fmac_f32 v27, s65, v33
    v_fmac_f32 v28, s64, v34
    v_fmac_f32 v29, s64, v35
    v_fmac_f32 v30, s65, v34
    v_fmac_f32 v31, s65, v35
    v_readlane_b32 s66, v16, 33
    v_readlane_b32 s67, v17, 33
    v_accvgpr_read_b32 v36, a66
    v_accvgpr_read_b32 v37, a67
    s_lshl_b32 s68, s66, 16
    s_lshl_b32 s69, s67, 16
    s_and_b32 s70, s66, 0xffff0000
    s_and_b32 s71, s67, 0xffff0000
    v_lshlrev_b32 v32, 16, v194
    v_and_b32 v33, 0xffff0000, v194
    v_lshlrev_b32 v34, 16, v36
    v_and_b32 v35, 0xffff0000, v36
    v_fmac_f32 v24, s68, v32
    v_fmac_f32 v25, s68, v33
    v_fmac_f32 v26, s69, v32
    v_fmac_f32 v27, s69, v33
    v_fmac_f32 v28, s68, v34
    v_fmac_f32 v29, s68, v35
    v_fmac_f32 v30, s69, v34
    v_fmac_f32 v31, s69, v35
    v_lshlrev_b32 v32, 16, v195
    v_and_b32 v33, 0xffff0000, v195
    v_lshlrev_b32 v34, 16, v37
    v_and_b32 v35, 0xffff0000, v37
    v_fmac_f32 v24, s70, v32
    v_fmac_f32 v25, s70, v33
    v_fmac_f32 v26, s71, v32
    v_fmac_f32 v27, s71, v33
    v_fmac_f32 v28, s70, v34
    v_fmac_f32 v29, s70, v35
    v_fmac_f32 v30, s71, v34
    v_fmac_f32 v31, s71, v35
    v_readlane_b32 s60, v16, 34
    v_readlane_b32 s61, v17, 34
    v_accvgpr_read_b32 v36, a68
    v_accvgpr_read_b32 v37, a69
    s_lshl_b32 s62, s60, 16
    s_lshl_b32 s63, s61, 16
    s_and_b32 s64, s60, 0xffff0000
    s_and_b32 s65, s61, 0xffff0000
    v_lshlrev_b32 v32, 16, v196
    v_and_b32 v33, 0xffff0000, v196
    v_lshlrev_b32 v34, 16, v36
    v_and_b32 v35, 0xffff0000, v36
    v_fmac_f32 v24, s62, v32
    v_fmac_f32 v25, s62, v33
    v_fmac_f32 v26, s63, v32
    v_fmac_f32 v27, s63, v33
    v_fmac_f32 v28, s62, v34
    v_fmac_f32 v29, s62, v35
    v_fmac_f32 v30, s63, v34
    v_fmac_f32 v31, s63, v35
    v_lshlrev_b32 v32, 16, v197
    v_and_b32 v33, 0xffff0000, v197
    v_lshlrev_b32 v34, 16, v37
    v_and_b32 v35, 0xffff0000, v37
    v_fmac_f32 v24, s64, v32
    v_fmac_f32 v25, s64, v33
    v_fmac_f32 v26, s65, v32
    v_fmac_f32 v27, s65, v33
    v_fmac_f32 v28, s64, v34
    v_fmac_f32 v29, s64, v35
    v_fmac_f32 v30, s65, v34
    v_fmac_f32 v31, s65, v35
    v_readlane_b32 s66, v16, 35
    v_readlane_b32 s67, v17, 35
    v_accvgpr_read_b32 v36, a70
    v_accvgpr_read_b32 v37, a71
    s_lshl_b32 s68, s66, 16
    s_lshl_b32 s69, s67, 16
    s_and_b32 s70, s66, 0xffff0000
    s_and_b32 s71, s67, 0xffff0000
    v_lshlrev_b32 v32, 16, v198
    v_and_b32 v33, 0xffff0000, v198
    v_lshlrev_b32 v34, 16, v36
    v_and_b32 v35, 0xffff0000, v36
    v_fmac_f32 v24, s68, v32
    v_fmac_f32 v25, s68, v33
    v_fmac_f32 v26, s69, v32
    v_fmac_f32 v27, s69, v33
    v_fmac_f32 v28, s68, v34
    v_fmac_f32 v29, s68, v35
    v_fmac_f32 v30, s69, v34
    v_fmac_f32 v31, s69, v35
    v_lshlrev_b32 v32, 16, v199
    v_and_b32 v33, 0xffff0000, v199
    v_lshlrev_b32 v34, 16, v37
    v_and_b32 v35, 0xffff0000, v37
    v_fmac_f32 v24, s70, v32
    v_fmac_f32 v25, s70, v33
    v_fmac_f32 v26, s71, v32
    v_fmac_f32 v27, s71, v33
    v_fmac_f32 v28, s70, v34
    v_fmac_f32 v29, s70, v35
    v_fmac_f32 v30, s71, v34
    v_fmac_f32 v31, s71, v35
    v_readlane_b32 s60, v16, 36
    v_readlane_b32 s61, v17, 36
    v_accvgpr_read_b32 v36, a72
    v_accvgpr_read_b32 v37, a73
    s_lshl_b32 s62, s60, 16
    s_lshl_b32 s63, s61, 16
    s_and_b32 s64, s60, 0xffff0000
    s_and_b32 s65, s61, 0xffff0000
    v_lshlrev_b32 v32, 16, v200
    v_and_b32 v33, 0xffff0000, v200
    v_lshlrev_b32 v34, 16, v36
    v_and_b32 v35, 0xffff0000, v36
    v_fmac_f32 v24, s62, v32
    v_fmac_f32 v25, s62, v33
    v_fmac_f32 v26, s63, v32
    v_fmac_f32 v27, s63, v33
    v_fmac_f32 v28, s62, v34
    v_fmac_f32 v29, s62, v35
    v_fmac_f32 v30, s63, v34
    v_fmac_f32 v31, s63, v35
    v_lshlrev_b32 v32, 16, v201
    v_and_b32 v33, 0xffff0000, v201
    v_lshlrev_b32 v34, 16, v37
    v_and_b32 v35, 0xffff0000, v37
    v_fmac_f32 v24, s64, v32
    v_fmac_f32 v25, s64, v33
    v_fmac_f32 v26, s65, v32
    v_fmac_f32 v27, s65, v33
    v_fmac_f32 v28, s64, v34
    v_fmac_f32 v29, s64, v35
    v_fmac_f32 v30, s65, v34
    v_fmac_f32 v31, s65, v35
    v_readlane_b32 s66, v16, 37
    v_readlane_b32 s67, v17, 37
    v_accvgpr_read_b32 v36, a74
    v_accvgpr_read_b32 v37, a75
    s_lshl_b32 s68, s66, 16
    s_lshl_b32 s69, s67, 16
    s_and_b32 s70, s66, 0xffff0000
    s_and_b32 s71, s67, 0xffff0000
    v_lshlrev_b32 v32, 16, v202
    v_and_b32 v33, 0xffff0000, v202
    v_lshlrev_b32 v34, 16, v36
    v_and_b32 v35, 0xffff0000, v36
    v_fmac_f32 v24, s68, v32
    v_fmac_f32 v25, s68, v33
    v_fmac_f32 v26, s69, v32
    v_fmac_f32 v27, s69, v33
    v_fmac_f32 v28, s68, v34
    v_fmac_f32 v29, s68, v35
    v_fmac_f32 v30, s69, v34
    v_fmac_f32 v31, s69, v35
    v_lshlrev_b32 v32, 16, v203
    v_and_b32 v33, 0xffff0000, v203
    v_lshlrev_b32 v34, 16, v37
    v_and_b32 v35, 0xffff0000, v37
    v_fmac_f32 v24, s70, v32
    v_fmac_f32 v25, s70, v33
    v_fmac_f32 v26, s71, v32
    v_fmac_f32 v27, s71, v33
    v_fmac_f32 v28, s70, v34
    v_fmac_f32 v29, s70, v35
    v_fmac_f32 v30, s71, v34
    v_fmac_f32 v31, s71, v35
    v_readlane_b32 s60, v16, 38
    v_readlane_b32 s61, v17, 38
    v_accvgpr_read_b32 v36, a76
    v_accvgpr_read_b32 v37, a77
    s_lshl_b32 s62, s60, 16
    s_lshl_b32 s63, s61, 16
    s_and_b32 s64, s60, 0xffff0000
    s_and_b32 s65, s61, 0xffff0000
    v_lshlrev_b32 v32, 16, v204
    v_and_b32 v33, 0xffff0000, v204
    v_lshlrev_b32 v34, 16, v36
    v_and_b32 v35, 0xffff0000, v36
    v_fmac_f32 v24, s62, v32
    v_fmac_f32 v25, s62, v33
    v_fmac_f32 v26, s63, v32
    v_fmac_f32 v27, s63, v33
    v_fmac_f32 v28, s62, v34
    v_fmac_f32 v29, s62, v35
    v_fmac_f32 v30, s63, v34
    v_fmac_f32 v31, s63, v35
    v_lshlrev_b32 v32, 16, v205
    v_and_b32 v33, 0xffff0000, v205
    v_lshlrev_b32 v34, 16, v37
    v_and_b32 v35, 0xffff0000, v37
    v_fmac_f32 v24, s64, v32
    v_fmac_f32 v25, s64, v33
    v_fmac_f32 v26, s65, v32
    v_fmac_f32 v27, s65, v33
    v_fmac_f32 v28, s64, v34
    v_fmac_f32 v29, s64, v35
    v_fmac_f32 v30, s65, v34
    v_fmac_f32 v31, s65, v35
    v_readlane_b32 s66, v16, 39
    v_readlane_b32 s67, v17, 39
    v_accvgpr_read_b32 v36, a78
    v_accvgpr_read_b32 v37, a79
    s_lshl_b32 s68, s66, 16
    s_lshl_b32 s69, s67, 16
    s_and_b32 s70, s66, 0xffff0000
    s_and_b32 s71, s67, 0xffff0000
    v_lshlrev_b32 v32, 16, v206
    v_and_b32 v33, 0xffff0000, v206
    v_lshlrev_b32 v34, 16, v36
    v_and_b32 v35, 0xffff0000, v36
    v_fmac_f32 v24, s68, v32
    v_fmac_f32 v25, s68, v33
    v_fmac_f32 v26, s69, v32
    v_fmac_f32 v27, s69, v33
    v_fmac_f32 v28, s68, v34
    v_fmac_f32 v29, s68, v35
    v_fmac_f32 v30, s69, v34
    v_fmac_f32 v31, s69, v35
    v_lshlrev_b32 v32, 16, v207
    v_and_b32 v33, 0xffff0000, v207
    v_lshlrev_b32 v34, 16, v37
    v_and_b32 v35, 0xffff0000, v37
    v_fmac_f32 v24, s70, v32
    v_fmac_f32 v25, s70, v33
    v_fmac_f32 v26, s71, v32
    v_fmac_f32 v27, s71, v33
    v_fmac_f32 v28, s70, v34
    v_fmac_f32 v29, s70, v35
    v_fmac_f32 v30, s71, v34
    v_fmac_f32 v31, s71, v35
    v_readlane_b32 s60, v16, 40
    v_readlane_b32 s61, v17, 40
    v_accvgpr_read_b32 v36, a80
    v_accvgpr_read_b32 v37, a81
    s_lshl_b32 s62, s60, 16
    s_lshl_b32 s63, s61, 16
    s_and_b32 s64, s60, 0xffff0000
    s_and_b32 s65, s61, 0xffff0000
    v_lshlrev_b32 v32, 16, v208
    v_and_b32 v33, 0xffff0000, v208
    v_lshlrev_b32 v34, 16, v36
    v_and_b32 v35, 0xffff0000, v36
    v_fmac_f32 v24, s62, v32
    v_fmac_f32 v25, s62, v33
    v_fmac_f32 v26, s63, v32
    v_fmac_f32 v27, s63, v33
    v_fmac_f32 v28, s62, v34
    v_fmac_f32 v29, s62, v35
    v_fmac_f32 v30, s63, v34
    v_fmac_f32 v31, s63, v35
    v_lshlrev_b32 v32, 16, v209
    v_and_b32 v33, 0xffff0000, v209
    v_lshlrev_b32 v34, 16, v37
    v_and_b32 v35, 0xffff0000, v37
    v_fmac_f32 v24, s64, v32
    v_fmac_f32 v25, s64, v33
    v_fmac_f32 v26, s65, v32
    v_fmac_f32 v27, s65, v33
    v_fmac_f32 v28, s64, v34
    v_fmac_f32 v29, s64, v35
    v_fmac_f32 v30, s65, v34
    v_fmac_f32 v31, s65, v35
    v_readlane_b32 s66, v16, 41
    v_readlane_b32 s67, v17, 41
    v_accvgpr_read_b32 v36, a82
    v_accvgpr_read_b32 v37, a83
    s_lshl_b32 s68, s66, 16
    s_lshl_b32 s69, s67, 16
    s_and_b32 s70, s66, 0xffff0000
    s_and_b32 s71, s67, 0xffff0000
    v_lshlrev_b32 v32, 16, v210
    v_and_b32 v33, 0xffff0000, v210
    v_lshlrev_b32 v34, 16, v36
    v_and_b32 v35, 0xffff0000, v36
    v_fmac_f32 v24, s68, v32
    v_fmac_f32 v25, s68, v33
    v_fmac_f32 v26, s69, v32
    v_fmac_f32 v27, s69, v33
    v_fmac_f32 v28, s68, v34
    v_fmac_f32 v29, s68, v35
    v_fmac_f32 v30, s69, v34
    v_fmac_f32 v31, s69, v35
    v_lshlrev_b32 v32, 16, v211
    v_and_b32 v33, 0xffff0000, v211
    v_lshlrev_b32 v34, 16, v37
    v_and_b32 v35, 0xffff0000, v37
    v_fmac_f32 v24, s70, v32
    v_fmac_f32 v25, s70, v33
    v_fmac_f32 v26, s71, v32
    v_fmac_f32 v27, s71, v33
    v_fmac_f32 v28, s70, v34
    v_fmac_f32 v29, s70, v35
    v_fmac_f32 v30, s71, v34
    v_fmac_f32 v31, s71, v35
    v_readlane_b32 s60, v16, 42
    v_readlane_b32 s61, v17, 42
    v_accvgpr_read_b32 v36, a84
    v_accvgpr_read_b32 v37, a85
    s_lshl_b32 s62, s60, 16
    s_lshl_b32 s63, s61, 16
    s_and_b32 s64, s60, 0xffff0000
    s_and_b32 s65, s61, 0xffff0000
    v_lshlrev_b32 v32, 16, v212
    v_and_b32 v33, 0xffff0000, v212
    v_lshlrev_b32 v34, 16, v36
    v_and_b32 v35, 0xffff0000, v36
    v_fmac_f32 v24, s62, v32
    v_fmac_f32 v25, s62, v33
    v_fmac_f32 v26, s63, v32
    v_fmac_f32 v27, s63, v33
    v_fmac_f32 v28, s62, v34
    v_fmac_f32 v29, s62, v35
    v_fmac_f32 v30, s63, v34
    v_fmac_f32 v31, s63, v35
    v_lshlrev_b32 v32, 16, v213
    v_and_b32 v33, 0xffff0000, v213
    v_lshlrev_b32 v34, 16, v37
    v_and_b32 v35, 0xffff0000, v37
    v_fmac_f32 v24, s64, v32
    v_fmac_f32 v25, s64, v33
    v_fmac_f32 v26, s65, v32
    v_fmac_f32 v27, s65, v33
    v_fmac_f32 v28, s64, v34
    v_fmac_f32 v29, s64, v35
    v_fmac_f32 v30, s65, v34
    v_fmac_f32 v31, s65, v35
    v_readlane_b32 s66, v16, 43
    v_readlane_b32 s67, v17, 43
    v_accvgpr_read_b32 v36, a86
    v_accvgpr_read_b32 v37, a87
    s_lshl_b32 s68, s66, 16
    s_lshl_b32 s69, s67, 16
    s_and_b32 s70, s66, 0xffff0000
    s_and_b32 s71, s67, 0xffff0000
    v_lshlrev_b32 v32, 16, v214
    v_and_b32 v33, 0xffff0000, v214
    v_lshlrev_b32 v34, 16, v36
    v_and_b32 v35, 0xffff0000, v36
    v_fmac_f32 v24, s68, v32
    v_fmac_f32 v25, s68, v33
    v_fmac_f32 v26, s69, v32
    v_fmac_f32 v27, s69, v33
    v_fmac_f32 v28, s68, v34
    v_fmac_f32 v29, s68, v35
    v_fmac_f32 v30, s69, v34
    v_fmac_f32 v31, s69, v35
    v_lshlrev_b32 v32, 16, v215
    v_and_b32 v33, 0xffff0000, v215
    v_lshlrev_b32 v34, 16, v37
    v_and_b32 v35, 0xffff0000, v37
    v_fmac_f32 v24, s70, v32
    v_fmac_f32 v25, s70, v33
    v_fmac_f32 v26, s71, v32
    v_fmac_f32 v27, s71, v33
    v_fmac_f32 v28, s70, v34
    v_fmac_f32 v29, s70, v35
    v_fmac_f32 v30, s71, v34
    v_fmac_f32 v31, s71, v35
    v_readlane_b32 s60, v16, 44
    v_readlane_b32 s61, v17, 44
    v_accvgpr_read_b32 v36, a88
    v_accvgpr_read_b32 v37, a89
    s_lshl_b32 s62, s60, 16
    s_lshl_b32 s63, s61, 16
    s_and_b32 s64, s60, 0xffff0000
    s_and_b32 s65, s61, 0xffff0000
    v_lshlrev_b32 v32, 16, v216
    v_and_b32 v33, 0xffff0000, v216
    v_lshlrev_b32 v34, 16, v36
    v_and_b32 v35, 0xffff0000, v36
    v_fmac_f32 v24, s62, v32
    v_fmac_f32 v25, s62, v33
    v_fmac_f32 v26, s63, v32
    v_fmac_f32 v27, s63, v33
    v_fmac_f32 v28, s62, v34
    v_fmac_f32 v29, s62, v35
    v_fmac_f32 v30, s63, v34
    v_fmac_f32 v31, s63, v35
    v_lshlrev_b32 v32, 16, v217
    v_and_b32 v33, 0xffff0000, v217
    v_lshlrev_b32 v34, 16, v37
    v_and_b32 v35, 0xffff0000, v37
    v_fmac_f32 v24, s64, v32
    v_fmac_f32 v25, s64, v33
    v_fmac_f32 v26, s65, v32
    v_fmac_f32 v27, s65, v33
    v_fmac_f32 v28, s64, v34
    v_fmac_f32 v29, s64, v35
    v_fmac_f32 v30, s65, v34
    v_fmac_f32 v31, s65, v35
    v_readlane_b32 s66, v16, 45
    v_readlane_b32 s67, v17, 45
    v_accvgpr_read_b32 v36, a90
    v_accvgpr_read_b32 v37, a91
    s_lshl_b32 s68, s66, 16
    s_lshl_b32 s69, s67, 16
    s_and_b32 s70, s66, 0xffff0000
    s_and_b32 s71, s67, 0xffff0000
    v_lshlrev_b32 v32, 16, v218
    v_and_b32 v33, 0xffff0000, v218
    v_lshlrev_b32 v34, 16, v36
    v_and_b32 v35, 0xffff0000, v36
    v_fmac_f32 v24, s68, v32
    v_fmac_f32 v25, s68, v33
    v_fmac_f32 v26, s69, v32
    v_fmac_f32 v27, s69, v33
    v_fmac_f32 v28, s68, v34
    v_fmac_f32 v29, s68, v35
    v_fmac_f32 v30, s69, v34
    v_fmac_f32 v31, s69, v35
    v_lshlrev_b32 v32, 16, v219
    v_and_b32 v33, 0xffff0000, v219
    v_lshlrev_b32 v34, 16, v37
    v_and_b32 v35, 0xffff0000, v37
    v_fmac_f32 v24, s70, v32
    v_fmac_f32 v25, s70, v33
    v_fmac_f32 v26, s71, v32
    v_fmac_f32 v27, s71, v33
    v_fmac_f32 v28, s70, v34
    v_fmac_f32 v29, s70, v35
    v_fmac_f32 v30, s71, v34
    v_fmac_f32 v31, s71, v35
    v_readlane_b32 s60, v16, 46
    v_readlane_b32 s61, v17, 46
    v_accvgpr_read_b32 v36, a92
    v_accvgpr_read_b32 v37, a93
    s_lshl_b32 s62, s60, 16
    s_lshl_b32 s63, s61, 16
    s_and_b32 s64, s60, 0xffff0000
    s_and_b32 s65, s61, 0xffff0000
    v_lshlrev_b32 v32, 16, v220
    v_and_b32 v33, 0xffff0000, v220
    v_lshlrev_b32 v34, 16, v36
    v_and_b32 v35, 0xffff0000, v36
    v_fmac_f32 v24, s62, v32
    v_fmac_f32 v25, s62, v33
    v_fmac_f32 v26, s63, v32
    v_fmac_f32 v27, s63, v33
    v_fmac_f32 v28, s62, v34
    v_fmac_f32 v29, s62, v35
    v_fmac_f32 v30, s63, v34
    v_fmac_f32 v31, s63, v35
    v_lshlrev_b32 v32, 16, v221
    v_and_b32 v33, 0xffff0000, v221
    v_lshlrev_b32 v34, 16, v37
    v_and_b32 v35, 0xffff0000, v37
    v_fmac_f32 v24, s64, v32
    v_fmac_f32 v25, s64, v33
    v_fmac_f32 v26, s65, v32
    v_fmac_f32 v27, s65, v33
    v_fmac_f32 v28, s64, v34
    v_fmac_f32 v29, s64, v35
    v_fmac_f32 v30, s65, v34
    v_fmac_f32 v31, s65, v35
    v_readlane_b32 s66, v16, 47
    v_readlane_b32 s67, v17, 47
    v_accvgpr_read_b32 v36, a94
    v_accvgpr_read_b32 v37, a95
    s_lshl_b32 s68, s66, 16
    s_lshl_b32 s69, s67, 16
    s_and_b32 s70, s66, 0xffff0000
    s_and_b32 s71, s67, 0xffff0000
    v_lshlrev_b32 v32, 16, v222
    v_and_b32 v33, 0xffff0000, v222
    v_lshlrev_b32 v34, 16, v36
    v_and_b32 v35, 0xffff0000, v36
    v_fmac_f32 v24, s68, v32
    v_fmac_f32 v25, s68, v33
    v_fmac_f32 v26, s69, v32
    v_fmac_f32 v27, s69, v33
    v_fmac_f32 v28, s68, v34
    v_fmac_f32 v29, s68, v35
    v_fmac_f32 v30, s69, v34
    v_fmac_f32 v31, s69, v35
    v_lshlrev_b32 v32, 16, v223
    v_and_b32 v33, 0xffff0000, v223
    v_lshlrev_b32 v34, 16, v37
    v_and_b32 v35, 0xffff0000, v37
    v_fmac_f32 v24, s70, v32
    v_fmac_f32 v25, s70, v33
    v_fmac_f32 v26, s71, v32
    v_fmac_f32 v27, s71, v33
    v_fmac_f32 v28, s70, v34
    v_fmac_f32 v29, s70, v35
    v_fmac_f32 v30, s71, v34
    v_fmac_f32 v31, s71, v35
    v_readlane_b32 s60, v16, 48
    v_readlane_b32 s61, v17, 48
    v_accvgpr_read_b32 v36, a96
    v_accvgpr_read_b32 v37, a97
    s_lshl_b32 s62, s60, 16
    s_lshl_b32 s63, s61, 16
    s_and_b32 s64, s60, 0xffff0000
    s_and_b32 s65, s61, 0xffff0000
    v_lshlrev_b32 v32, 16, v224
    v_and_b32 v33, 0xffff0000, v224
    v_lshlrev_b32 v34, 16, v36
    v_and_b32 v35, 0xffff0000, v36
    v_fmac_f32 v24, s62, v32
    v_fmac_f32 v25, s62, v33
    v_fmac_f32 v26, s63, v32
    v_fmac_f32 v27, s63, v33
    v_fmac_f32 v28, s62, v34
    v_fmac_f32 v29, s62, v35
    v_fmac_f32 v30, s63, v34
    v_fmac_f32 v31, s63, v35
    v_lshlrev_b32 v32, 16, v225
    v_and_b32 v33, 0xffff0000, v225
    v_lshlrev_b32 v34, 16, v37
    v_and_b32 v35, 0xffff0000, v37
    v_fmac_f32 v24, s64, v32
    v_fmac_f32 v25, s64, v33
    v_fmac_f32 v26, s65, v32
    v_fmac_f32 v27, s65, v33
    v_fmac_f32 v28, s64, v34
    v_fmac_f32 v29, s64, v35
    v_fmac_f32 v30, s65, v34
    v_fmac_f32 v31, s65, v35
    v_readlane_b32 s66, v16, 49
    v_readlane_b32 s67, v17, 49
    v_accvgpr_read_b32 v36, a98
    v_accvgpr_read_b32 v37, a99
    s_lshl_b32 s68, s66, 16
    s_lshl_b32 s69, s67, 16
    s_and_b32 s70, s66, 0xffff0000
    s_and_b32 s71, s67, 0xffff0000
    v_lshlrev_b32 v32, 16, v226
    v_and_b32 v33, 0xffff0000, v226
    v_lshlrev_b32 v34, 16, v36
    v_and_b32 v35, 0xffff0000, v36
    v_fmac_f32 v24, s68, v32
    v_fmac_f32 v25, s68, v33
    v_fmac_f32 v26, s69, v32
    v_fmac_f32 v27, s69, v33
    v_fmac_f32 v28, s68, v34
    v_fmac_f32 v29, s68, v35
    v_fmac_f32 v30, s69, v34
    v_fmac_f32 v31, s69, v35
    v_lshlrev_b32 v32, 16, v227
    v_and_b32 v33, 0xffff0000, v227
    v_lshlrev_b32 v34, 16, v37
    v_and_b32 v35, 0xffff0000, v37
    v_fmac_f32 v24, s70, v32
    v_fmac_f32 v25, s70, v33
    v_fmac_f32 v26, s71, v32
    v_fmac_f32 v27, s71, v33
    v_fmac_f32 v28, s70, v34
    v_fmac_f32 v29, s70, v35
    v_fmac_f32 v30, s71, v34
    v_fmac_f32 v31, s71, v35
    v_readlane_b32 s60, v16, 50
    v_readlane_b32 s61, v17, 50
    v_accvgpr_read_b32 v36, a100
    v_accvgpr_read_b32 v37, a101
    s_lshl_b32 s62, s60, 16
    s_lshl_b32 s63, s61, 16
    s_and_b32 s64, s60, 0xffff0000
    s_and_b32 s65, s61, 0xffff0000
    v_lshlrev_b32 v32, 16, v228
    v_and_b32 v33, 0xffff0000, v228
    v_lshlrev_b32 v34, 16, v36
    v_and_b32 v35, 0xffff0000, v36
    v_fmac_f32 v24, s62, v32
    v_fmac_f32 v25, s62, v33
    v_fmac_f32 v26, s63, v32
    v_fmac_f32 v27, s63, v33
    v_fmac_f32 v28, s62, v34
    v_fmac_f32 v29, s62, v35
    v_fmac_f32 v30, s63, v34
    v_fmac_f32 v31, s63, v35
    v_lshlrev_b32 v32, 16, v229
    v_and_b32 v33, 0xffff0000, v229
    v_lshlrev_b32 v34, 16, v37
    v_and_b32 v35, 0xffff0000, v37
    v_fmac_f32 v24, s64, v32
    v_fmac_f32 v25, s64, v33
    v_fmac_f32 v26, s65, v32
    v_fmac_f32 v27, s65, v33
    v_fmac_f32 v28, s64, v34
    v_fmac_f32 v29, s64, v35
    v_fmac_f32 v30, s65, v34
    v_fmac_f32 v31, s65, v35
    v_readlane_b32 s66, v16, 51
    v_readlane_b32 s67, v17, 51
    v_accvgpr_read_b32 v36, a102
    v_accvgpr_read_b32 v37, a103
    s_lshl_b32 s68, s66, 16
    s_lshl_b32 s69, s67, 16
    s_and_b32 s70, s66, 0xffff0000
    s_and_b32 s71, s67, 0xffff0000
    v_lshlrev_b32 v32, 16, v230
    v_and_b32 v33, 0xffff0000, v230
    v_lshlrev_b32 v34, 16, v36
    v_and_b32 v35, 0xffff0000, v36
    v_fmac_f32 v24, s68, v32
    v_fmac_f32 v25, s68, v33
    v_fmac_f32 v26, s69, v32
    v_fmac_f32 v27, s69, v33
    v_fmac_f32 v28, s68, v34
    v_fmac_f32 v29, s68, v35
    v_fmac_f32 v30, s69, v34
    v_fmac_f32 v31, s69, v35
    v_lshlrev_b32 v32, 16, v231
    v_and_b32 v33, 0xffff0000, v231
    v_lshlrev_b32 v34, 16, v37
    v_and_b32 v35, 0xffff0000, v37
    v_fmac_f32 v24, s70, v32
    v_fmac_f32 v25, s70, v33
    v_fmac_f32 v26, s71, v32
    v_fmac_f32 v27, s71, v33
    v_fmac_f32 v28, s70, v34
    v_fmac_f32 v29, s70, v35
    v_fmac_f32 v30, s71, v34
    v_fmac_f32 v31, s71, v35
    v_readlane_b32 s60, v16, 52
    v_readlane_b32 s61, v17, 52
    v_accvgpr_read_b32 v36, a104
    v_accvgpr_read_b32 v37, a105
    s_lshl_b32 s62, s60, 16
    s_lshl_b32 s63, s61, 16
    s_and_b32 s64, s60, 0xffff0000
    s_and_b32 s65, s61, 0xffff0000
    v_lshlrev_b32 v32, 16, v232
    v_and_b32 v33, 0xffff0000, v232
    v_lshlrev_b32 v34, 16, v36
    v_and_b32 v35, 0xffff0000, v36
    v_fmac_f32 v24, s62, v32
    v_fmac_f32 v25, s62, v33
    v_fmac_f32 v26, s63, v32
    v_fmac_f32 v27, s63, v33
    v_fmac_f32 v28, s62, v34
    v_fmac_f32 v29, s62, v35
    v_fmac_f32 v30, s63, v34
    v_fmac_f32 v31, s63, v35
    v_lshlrev_b32 v32, 16, v233
    v_and_b32 v33, 0xffff0000, v233
    v_lshlrev_b32 v34, 16, v37
    v_and_b32 v35, 0xffff0000, v37
    v_fmac_f32 v24, s64, v32
    v_fmac_f32 v25, s64, v33
    v_fmac_f32 v26, s65, v32
    v_fmac_f32 v27, s65, v33
    v_fmac_f32 v28, s64, v34
    v_fmac_f32 v29, s64, v35
    v_fmac_f32 v30, s65, v34
    v_fmac_f32 v31, s65, v35
    v_readlane_b32 s66, v16, 53
    v_readlane_b32 s67, v17, 53
    v_accvgpr_read_b32 v36, a106
    v_accvgpr_read_b32 v37, a107
    s_lshl_b32 s68, s66, 16
    s_lshl_b32 s69, s67, 16
    s_and_b32 s70, s66, 0xffff0000
    s_and_b32 s71, s67, 0xffff0000
    v_lshlrev_b32 v32, 16, v234
    v_and_b32 v33, 0xffff0000, v234
    v_lshlrev_b32 v34, 16, v36
    v_and_b32 v35, 0xffff0000, v36
    v_fmac_f32 v24, s68, v32
    v_fmac_f32 v25, s68, v33
    v_fmac_f32 v26, s69, v32
    v_fmac_f32 v27, s69, v33
    v_fmac_f32 v28, s68, v34
    v_fmac_f32 v29, s68, v35
    v_fmac_f32 v30, s69, v34
    v_fmac_f32 v31, s69, v35
    v_lshlrev_b32 v32, 16, v235
    v_and_b32 v33, 0xffff0000, v235
    v_lshlrev_b32 v34, 16, v37
    v_and_b32 v35, 0xffff0000, v37
    v_fmac_f32 v24, s70, v32
    v_fmac_f32 v25, s70, v33
    v_fmac_f32 v26, s71, v32
    v_fmac_f32 v27, s71, v33
    v_fmac_f32 v28, s70, v34
    v_fmac_f32 v29, s70, v35
    v_fmac_f32 v30, s71, v34
    v_fmac_f32 v31, s71, v35
    v_readlane_b32 s60, v16, 54
    v_readlane_b32 s61, v17, 54
    v_accvgpr_read_b32 v36, a108
    v_accvgpr_read_b32 v37, a109
    s_lshl_b32 s62, s60, 16
    s_lshl_b32 s63, s61, 16
    s_and_b32 s64, s60, 0xffff0000
    s_and_b32 s65, s61, 0xffff0000
    v_lshlrev_b32 v32, 16, v236
    v_and_b32 v33, 0xffff0000, v236
    v_lshlrev_b32 v34, 16, v36
    v_and_b32 v35, 0xffff0000, v36
    v_fmac_f32 v24, s62, v32
    v_fmac_f32 v25, s62, v33
    v_fmac_f32 v26, s63, v32
    v_fmac_f32 v27, s63, v33
    v_fmac_f32 v28, s62, v34
    v_fmac_f32 v29, s62, v35
    v_fmac_f32 v30, s63, v34
    v_fmac_f32 v31, s63, v35
    v_lshlrev_b32 v32, 16, v237
    v_and_b32 v33, 0xffff0000, v237
    v_lshlrev_b32 v34, 16, v37
    v_and_b32 v35, 0xffff0000, v37
    v_fmac_f32 v24, s64, v32
    v_fmac_f32 v25, s64, v33
    v_fmac_f32 v26, s65, v32
    v_fmac_f32 v27, s65, v33
    v_fmac_f32 v28, s64, v34
    v_fmac_f32 v29, s64, v35
    v_fmac_f32 v30, s65, v34
    v_fmac_f32 v31, s65, v35
    v_readlane_b32 s66, v16, 55
    v_readlane_b32 s67, v17, 55
    v_accvgpr_read_b32 v36, a110
    v_accvgpr_read_b32 v37, a111
    s_lshl_b32 s68, s66, 16
    s_lshl_b32 s69, s67, 16
    s_and_b32 s70, s66, 0xffff0000
    s_and_b32 s71, s67, 0xffff0000
    v_lshlrev_b32 v32, 16, v238
    v_and_b32 v33, 0xffff0000, v238
    v_lshlrev_b32 v34, 16, v36
    v_and_b32 v35, 0xffff0000, v36
    v_fmac_f32 v24, s68, v32
    v_fmac_f32 v25, s68, v33
    v_fmac_f32 v26, s69, v32
    v_fmac_f32 v27, s69, v33
    v_fmac_f32 v28, s68, v34
    v_fmac_f32 v29, s68, v35
    v_fmac_f32 v30, s69, v34
    v_fmac_f32 v31, s69, v35
    v_lshlrev_b32 v32, 16, v239
    v_and_b32 v33, 0xffff0000, v239
    v_lshlrev_b32 v34, 16, v37
    v_and_b32 v35, 0xffff0000, v37
    v_fmac_f32 v24, s70, v32
    v_fmac_f32 v25, s70, v33
    v_fmac_f32 v26, s71, v32
    v_fmac_f32 v27, s71, v33
    v_fmac_f32 v28, s70, v34
    v_fmac_f32 v29, s70, v35
    v_fmac_f32 v30, s71, v34
    v_fmac_f32 v31, s71, v35
    v_readlane_b32 s60, v16, 56
    v_readlane_b32 s61, v17, 56
    v_accvgpr_read_b32 v36, a112
    v_accvgpr_read_b32 v37, a113
    s_lshl_b32 s62, s60, 16
    s_lshl_b32 s63, s61, 16
    s_and_b32 s64, s60, 0xffff0000
    s_and_b32 s65, s61, 0xffff0000
    v_lshlrev_b32 v32, 16, v240
    v_and_b32 v33, 0xffff0000, v240
    v_lshlrev_b32 v34, 16, v36
    v_and_b32 v35, 0xffff0000, v36
    v_fmac_f32 v24, s62, v32
    v_fmac_f32 v25, s62, v33
    v_fmac_f32 v26, s63, v32
    v_fmac_f32 v27, s63, v33
    v_fmac_f32 v28, s62, v34
    v_fmac_f32 v29, s62, v35
    v_fmac_f32 v30, s63, v34
    v_fmac_f32 v31, s63, v35
    v_lshlrev_b32 v32, 16, v241
    v_and_b32 v33, 0xffff0000, v241
    v_lshlrev_b32 v34, 16, v37
    v_and_b32 v35, 0xffff0000, v37
    v_fmac_f32 v24, s64, v32
    v_fmac_f32 v25, s64, v33
    v_fmac_f32 v26, s65, v32
    v_fmac_f32 v27, s65, v33
    v_fmac_f32 v28, s64, v34
    v_fmac_f32 v29, s64, v35
    v_fmac_f32 v30, s65, v34
    v_fmac_f32 v31, s65, v35
    v_readlane_b32 s66, v16, 57
    v_readlane_b32 s67, v17, 57
    v_accvgpr_read_b32 v36, a114
    v_accvgpr_read_b32 v37, a115
    s_lshl_b32 s68, s66, 16
    s_lshl_b32 s69, s67, 16
    s_and_b32 s70, s66, 0xffff0000
    s_and_b32 s71, s67, 0xffff0000
    v_lshlrev_b32 v32, 16, v242
    v_and_b32 v33, 0xffff0000, v242
    v_lshlrev_b32 v34, 16, v36
    v_and_b32 v35, 0xffff0000, v36
    v_fmac_f32 v24, s68, v32
    v_fmac_f32 v25, s68, v33
    v_fmac_f32 v26, s69, v32
    v_fmac_f32 v27, s69, v33
    v_fmac_f32 v28, s68, v34
    v_fmac_f32 v29, s68, v35
    v_fmac_f32 v30, s69, v34
    v_fmac_f32 v31, s69, v35
    v_lshlrev_b32 v32, 16, v243
    v_and_b32 v33, 0xffff0000, v243
    v_lshlrev_b32 v34, 16, v37
    v_and_b32 v35, 0xffff0000, v37
    v_fmac_f32 v24, s70, v32
    v_fmac_f32 v25, s70, v33
    v_fmac_f32 v26, s71, v32
    v_fmac_f32 v27, s71, v33
    v_fmac_f32 v28, s70, v34
    v_fmac_f32 v29, s70, v35
    v_fmac_f32 v30, s71, v34
    v_fmac_f32 v31, s71, v35
    v_readlane_b32 s60, v16, 58
    v_readlane_b32 s61, v17, 58
    v_accvgpr_read_b32 v36, a116
    v_accvgpr_read_b32 v37, a117
    s_lshl_b32 s62, s60, 16
    s_lshl_b32 s63, s61, 16
    s_and_b32 s64, s60, 0xffff0000
    s_and_b32 s65, s61, 0xffff0000
    v_lshlrev_b32 v32, 16, v244
    v_and_b32 v33, 0xffff0000, v244
    v_lshlrev_b32 v34, 16, v36
    v_and_b32 v35, 0xffff0000, v36
    v_fmac_f32 v24, s62, v32
    v_fmac_f32 v25, s62, v33
    v_fmac_f32 v26, s63, v32
    v_fmac_f32 v27, s63, v33
    v_fmac_f32 v28, s62, v34
    v_fmac_f32 v29, s62, v35
    v_fmac_f32 v30, s63, v34
    v_fmac_f32 v31, s63, v35
    v_lshlrev_b32 v32, 16, v245
    v_and_b32 v33, 0xffff0000, v245
    v_lshlrev_b32 v34, 16, v37
    v_and_b32 v35, 0xffff0000, v37
    v_fmac_f32 v24, s64, v32
    v_fmac_f32 v25, s64, v33
    v_fmac_f32 v26, s65, v32
    v_fmac_f32 v27, s65, v33
    v_fmac_f32 v28, s64, v34
    v_fmac_f32 v29, s64, v35
    v_fmac_f32 v30, s65, v34
    v_fmac_f32 v31, s65, v35
    v_readlane_b32 s66, v16, 59
    v_readlane_b32 s67, v17, 59
    v_accvgpr_read_b32 v36, a118
    v_accvgpr_read_b32 v37, a119
    s_lshl_b32 s68, s66, 16
    s_lshl_b32 s69, s67, 16
    s_and_b32 s70, s66, 0xffff0000
    s_and_b32 s71, s67, 0xffff0000
    v_lshlrev_b32 v32, 16, v246
    v_and_b32 v33, 0xffff0000, v246
    v_lshlrev_b32 v34, 16, v36
    v_and_b32 v35, 0xffff0000, v36
    v_fmac_f32 v24, s68, v32
    v_fmac_f32 v25, s68, v33
    v_fmac_f32 v26, s69, v32
    v_fmac_f32 v27, s69, v33
    v_fmac_f32 v28, s68, v34
    v_fmac_f32 v29, s68, v35
    v_fmac_f32 v30, s69, v34
    v_fmac_f32 v31, s69, v35
    v_lshlrev_b32 v32, 16, v247
    v_and_b32 v33, 0xffff0000, v247
    v_lshlrev_b32 v34, 16, v37
    v_and_b32 v35, 0xffff0000, v37
    v_fmac_f32 v24, s70, v32
    v_fmac_f32 v25, s70, v33
    v_fmac_f32 v26, s71, v32
    v_fmac_f32 v27, s71, v33
    v_fmac_f32 v28, s70, v34
    v_fmac_f32 v29, s70, v35
    v_fmac_f32 v30, s71, v34
    v_fmac_f32 v31, s71, v35
    v_readlane_b32 s60, v16, 60
    v_readlane_b32 s61, v17, 60
    v_accvgpr_read_b32 v36, a120
    v_accvgpr_read_b32 v37, a121
    s_lshl_b32 s62, s60, 16
    s_lshl_b32 s63, s61, 16
    s_and_b32 s64, s60, 0xffff0000
    s_and_b32 s65, s61, 0xffff0000
    v_lshlrev_b32 v32, 16, v248
    v_and_b32 v33, 0xffff0000, v248
    v_lshlrev_b32 v34, 16, v36
    v_and_b32 v35, 0xffff0000, v36
    v_fmac_f32 v24, s62, v32
    v_fmac_f32 v25, s62, v33
    v_fmac_f32 v26, s63, v32
    v_fmac_f32 v27, s63, v33
    v_fmac_f32 v28, s62, v34
    v_fmac_f32 v29, s62, v35
    v_fmac_f32 v30, s63, v34
    v_fmac_f32 v31, s63, v35
    v_lshlrev_b32 v32, 16, v249
    v_and_b32 v33, 0xffff0000, v249
    v_lshlrev_b32 v34, 16, v37
    v_and_b32 v35, 0xffff0000, v37
    v_fmac_f32 v24, s64, v32
    v_fmac_f32 v25, s64, v33
    v_fmac_f32 v26, s65, v32
    v_fmac_f32 v27, s65, v33
    v_fmac_f32 v28, s64, v34
    v_fmac_f32 v29, s64, v35
    v_fmac_f32 v30, s65, v34
    v_fmac_f32 v31, s65, v35
    v_readlane_b32 s66, v16, 61
    v_readlane_b32 s67, v17, 61
    v_accvgpr_read_b32 v36, a122
    v_accvgpr_read_b32 v37, a123
    s_lshl_b32 s68, s66, 16
    s_lshl_b32 s69, s67, 16
    s_and_b32 s70, s66, 0xffff0000
    s_and_b32 s71, s67, 0xffff0000
    v_lshlrev_b32 v32, 16, v250
    v_and_b32 v33, 0xffff0000, v250
    v_lshlrev_b32 v34, 16, v36
    v_and_b32 v35, 0xffff0000, v36
    v_fmac_f32 v24, s68, v32
    v_fmac_f32 v25, s68, v33
    v_fmac_f32 v26, s69, v32
    v_fmac_f32 v27, s69, v33
    v_fmac_f32 v28, s68, v34
    v_fmac_f32 v29, s68, v35
    v_fmac_f32 v30, s69, v34
    v_fmac_f32 v31, s69, v35
    v_lshlrev_b32 v32, 16, v251
    v_and_b32 v33, 0xffff0000, v251
    v_lshlrev_b32 v34, 16, v37
    v_and_b32 v35, 0xffff0000, v37
    v_fmac_f32 v24, s70, v32
    v_fmac_f32 v25, s70, v33
    v_fmac_f32 v26, s71, v32
    v_fmac_f32 v27, s71, v33
    v_fmac_f32 v28, s70, v34
    v_fmac_f32 v29, s70, v35
    v_fmac_f32 v30, s71, v34
    v_fmac_f32 v31, s71, v35
    v_readlane_b32 s60, v16, 62
    v_readlane_b32 s61, v17, 62
    v_accvgpr_read_b32 v36, a124
    v_accvgpr_read_b32 v37, a125
    s_lshl_b32 s62, s60, 16
    s_lshl_b32 s63, s61, 16
    s_and_b32 s64, s60, 0xffff0000
    s_and_b32 s65, s61, 0xffff0000
    v_lshlrev_b32 v32, 16, v252
    v_and_b32 v33, 0xffff0000, v252
    v_lshlrev_b32 v34, 16, v36
    v_and_b32 v35, 0xffff0000, v36
    v_fmac_f32 v24, s62, v32
    v_fmac_f32 v25, s62, v33
    v_fmac_f32 v26, s63, v32
    v_fmac_f32 v27, s63, v33
    v_fmac_f32 v28, s62, v34
    v_fmac_f32 v29, s62, v35
    v_fmac_f32 v30, s63, v34
    v_fmac_f32 v31, s63, v35
    v_lshlrev_b32 v32, 16, v253
    v_and_b32 v33, 0xffff0000, v253
    v_lshlrev_b32 v34, 16, v37
    v_and_b32 v35, 0xffff0000, v37
    v_fmac_f32 v24, s64, v32
    v_fmac_f32 v25, s64, v33
    v_fmac_f32 v26, s65, v32
    v_fmac_f32 v27, s65, v33
    v_fmac_f32 v28, s64, v34
    v_fmac_f32 v29, s64, v35
    v_fmac_f32 v30, s65, v34
    v_fmac_f32 v31, s65, v35
    v_readlane_b32 s66, v16, 63
    v_readlane_b32 s67, v17, 63
    v_accvgpr_read_b32 v36, a126
    v_accvgpr_read_b32 v37, a127
    s_lshl_b32 s68, s66, 16
    s_lshl_b32 s69, s67, 16
    s_and_b32 s70, s66, 0xffff0000
    s_and_b32 s71, s67, 0xffff0000
    v_lshlrev_b32 v32, 16, v254
    v_and_b32 v33, 0xffff0000, v254
    v_lshlrev_b32 v34, 16, v36
    v_and_b32 v35, 0xffff0000, v36
    v_fmac_f32 v24, s68, v32
    v_fmac_f32 v25, s68, v33
    v_fmac_f32 v26, s69, v32
    v_fmac_f32 v27, s69, v33
    v_fmac_f32 v28, s68, v34
    v_fmac_f32 v29, s68, v35
    v_fmac_f32 v30, s69, v34
    v_fmac_f32 v31, s69, v35
    v_lshlrev_b32 v32, 16, v255
    v_and_b32 v33, 0xffff0000, v255
    v_lshlrev_b32 v34, 16, v37
    v_and_b32 v35, 0xffff0000, v37
    v_fmac_f32 v24, s70, v32
    v_fmac_f32 v25, s70, v33
    v_fmac_f32 v26, s71, v32
    v_fmac_f32 v27, s71, v33
    v_fmac_f32 v28, s70, v34
    v_fmac_f32 v29, s70, v35
    v_fmac_f32 v30, s71, v34
    v_fmac_f32 v31, s71, v35
    ds_write_b128 v2, v[24:27] offset:64
    ds_write_b128 v2, v[28:31] offset:4160
    s_waitcnt lgkmcnt(0)
    s_barrier
    ds_read_b128 v[40:43], v1 offset:64
    ds_read_b128 v[44:47], v1 offset:1088
    ds_read_b128 v[48:51], v1 offset:2112
    ds_read_b128 v[52:55], v1 offset:3136
    ds_read_b128 v[56:59], v1 offset:4160
    ds_read_b128 v[60:63], v1 offset:5184
    ds_read_b128 v[64:67], v1 offset:6208
    ds_read_b128 v[68:71], v1 offset:7232
    s_waitcnt lgkmcnt(0)
    v_add_f32 v40, v40, v44
    v_add_f32 v48, v48, v52
    v_add_f32 v40, v40, v48
    v_cvt_pk_bf16_f32 v40, v40, v40
    v_and_b32 v40, 0xffff0000, v40
    v_add_f32 v41, v41, v45
    v_add_f32 v49, v49, v53
    v_add_f32 v41, v41, v49
    v_cvt_pk_bf16_f32 v41, v41, v41
    v_and_b32 v41, 0xffff0000, v41
    v_add_f32 v42, v42, v46
    v_add_f32 v50, v50, v54
    v_add_f32 v42, v42, v50
    v_cvt_pk_bf16_f32 v42, v42, v42
    v_and_b32 v42, 0xffff0000, v42
    v_add_f32 v43, v43, v47
    v_add_f32 v51, v51, v55
    v_add_f32 v43, v43, v51
    v_cvt_pk_bf16_f32 v43, v43, v43
    v_and_b32 v43, 0xffff0000, v43
    v_add_f32 v56, v56, v60
    v_add_f32 v64, v64, v68
    v_add_f32 v56, v56, v64
    v_cvt_pk_bf16_f32 v56, v56, v56
    v_and_b32 v56, 0xffff0000, v56
    v_add_f32 v57, v57, v61
    v_add_f32 v65, v65, v69
    v_add_f32 v57, v57, v65
    v_cvt_pk_bf16_f32 v57, v57, v57
    v_and_b32 v57, 0xffff0000, v57
    v_add_f32 v58, v58, v62
    v_add_f32 v66, v66, v70
    v_add_f32 v58, v58, v66
    v_cvt_pk_bf16_f32 v58, v58, v58
    v_and_b32 v58, 0xffff0000, v58
    v_add_f32 v59, v59, v63
    v_add_f32 v67, v67, v71
    v_add_f32 v59, v59, v67
    v_cvt_pk_bf16_f32 v59, v59, v59
    v_and_b32 v59, 0xffff0000, v59
    v_mul_f32 v44, 0xbfb8aa3b, v40
    v_exp_f32 v44, v44
    s_nop 0
    v_add_f32 v44, 1.0, v44
    v_rcp_f32 v44, v44
    s_nop 0
    v_mul_f32 v40, v40, v44
    v_cvt_pk_bf16_f32 v40, v40, v40
    v_and_b32 v40, 0xffff0000, v40
    v_mul_f32 v40, v40, v56
    v_cvt_pk_bf16_f32 v40, v40, v40
    v_and_b32 v40, 0xffff0000, v40
    v_mul_f32 v45, 0xbfb8aa3b, v41
    v_exp_f32 v45, v45
    s_nop 0
    v_add_f32 v45, 1.0, v45
    v_rcp_f32 v45, v45
    s_nop 0
    v_mul_f32 v41, v41, v45
    v_cvt_pk_bf16_f32 v41, v41, v41
    v_and_b32 v41, 0xffff0000, v41
    v_mul_f32 v41, v41, v57
    v_cvt_pk_bf16_f32 v41, v41, v41
    v_and_b32 v41, 0xffff0000, v41
    v_mul_f32 v46, 0xbfb8aa3b, v42
    v_exp_f32 v46, v46
    s_nop 0
    v_add_f32 v46, 1.0, v46
    v_rcp_f32 v46, v46
    s_nop 0
    v_mul_f32 v42, v42, v46
    v_cvt_pk_bf16_f32 v42, v42, v42
    v_and_b32 v42, 0xffff0000, v42
    v_mul_f32 v42, v42, v58
    v_cvt_pk_bf16_f32 v42, v42, v42
    v_and_b32 v42, 0xffff0000, v42
    v_mul_f32 v47, 0xbfb8aa3b, v43
    v_exp_f32 v47, v47
    s_nop 0
    v_add_f32 v47, 1.0, v47
    v_rcp_f32 v47, v47
    s_nop 0
    v_mul_f32 v43, v43, v47
    v_cvt_pk_bf16_f32 v43, v43, v43
    v_and_b32 v43, 0xffff0000, v43
    v_mul_f32 v43, v43, v59
    v_cvt_pk_bf16_f32 v43, v43, v43
    v_and_b32 v43, 0xffff0000, v43
    ds_write_b128 v1, v[40:43] offset:8256
    v_mov_b32 v24, 0
    v_mov_b32 v25, 0
    v_mov_b32 v26, 0
    v_mov_b32 v27, 0
    s_waitcnt lgkmcnt(0)
    ds_read_b128 v[40:43], v14 offset:8256
    ds_read_b128 v[44:47], v14 offset:8272
    ds_read_b128 v[48:51], v14 offset:8288
    ds_read_b128 v[52:55], v14 offset:8304
    ds_read_b128 v[56:59], v14 offset:8320
    ds_read_b128 v[60:63], v14 offset:8336
    ds_read_b128 v[64:67], v14 offset:8352
    ds_read_b128 v[68:71], v14 offset:8368
    s_waitcnt lgkmcnt(0)
    v_accvgpr_read_b32 v34, a128
    v_lshlrev_b32 v32, 16, v34
    v_and_b32 v33, 0xffff0000, v34
    v_fmac_f32 v24, v40, v32
    v_fmac_f32 v25, v40, v33
    v_fmac_f32 v26, v42, v32
    v_fmac_f32 v27, v42, v33
    v_accvgpr_read_b32 v34, a129
    v_lshlrev_b32 v32, 16, v34
    v_and_b32 v33, 0xffff0000, v34
    v_fmac_f32 v24, v41, v32
    v_fmac_f32 v25, v41, v33
    v_fmac_f32 v26, v43, v32
    v_fmac_f32 v27, v43, v33
    v_accvgpr_read_b32 v34, a130
    v_lshlrev_b32 v32, 16, v34
    v_and_b32 v33, 0xffff0000, v34
    v_fmac_f32 v24, v44, v32
    v_fmac_f32 v25, v44, v33
    v_fmac_f32 v26, v46, v32
    v_fmac_f32 v27, v46, v33
    v_accvgpr_read_b32 v34, a131
    v_lshlrev_b32 v32, 16, v34
    v_and_b32 v33, 0xffff0000, v34
    v_fmac_f32 v24, v45, v32
    v_fmac_f32 v25, v45, v33
    v_fmac_f32 v26, v47, v32
    v_fmac_f32 v27, v47, v33
    v_accvgpr_read_b32 v34, a132
    v_lshlrev_b32 v32, 16, v34
    v_and_b32 v33, 0xffff0000, v34
    v_fmac_f32 v24, v48, v32
    v_fmac_f32 v25, v48, v33
    v_fmac_f32 v26, v50, v32
    v_fmac_f32 v27, v50, v33
    v_accvgpr_read_b32 v34, a133
    v_lshlrev_b32 v32, 16, v34
    v_and_b32 v33, 0xffff0000, v34
    v_fmac_f32 v24, v49, v32
    v_fmac_f32 v25, v49, v33
    v_fmac_f32 v26, v51, v32
    v_fmac_f32 v27, v51, v33
    v_accvgpr_read_b32 v34, a134
    v_lshlrev_b32 v32, 16, v34
    v_and_b32 v33, 0xffff0000, v34
    v_fmac_f32 v24, v52, v32
    v_fmac_f32 v25, v52, v33
    v_fmac_f32 v26, v54, v32
    v_fmac_f32 v27, v54, v33
    v_accvgpr_read_b32 v34, a135
    v_lshlrev_b32 v32, 16, v34
    v_and_b32 v33, 0xffff0000, v34
    v_fmac_f32 v24, v53, v32
    v_fmac_f32 v25, v53, v33
    v_fmac_f32 v26, v55, v32
    v_fmac_f32 v27, v55, v33
    v_accvgpr_read_b32 v34, a136
    v_lshlrev_b32 v32, 16, v34
    v_and_b32 v33, 0xffff0000, v34
    v_fmac_f32 v24, v56, v32
    v_fmac_f32 v25, v56, v33
    v_fmac_f32 v26, v58, v32
    v_fmac_f32 v27, v58, v33
    v_accvgpr_read_b32 v34, a137
    v_lshlrev_b32 v32, 16, v34
    v_and_b32 v33, 0xffff0000, v34
    v_fmac_f32 v24, v57, v32
    v_fmac_f32 v25, v57, v33
    v_fmac_f32 v26, v59, v32
    v_fmac_f32 v27, v59, v33
    v_accvgpr_read_b32 v34, a138
    v_lshlrev_b32 v32, 16, v34
    v_and_b32 v33, 0xffff0000, v34
    v_fmac_f32 v24, v60, v32
    v_fmac_f32 v25, v60, v33
    v_fmac_f32 v26, v62, v32
    v_fmac_f32 v27, v62, v33
    v_accvgpr_read_b32 v34, a139
    v_lshlrev_b32 v32, 16, v34
    v_and_b32 v33, 0xffff0000, v34
    v_fmac_f32 v24, v61, v32
    v_fmac_f32 v25, v61, v33
    v_fmac_f32 v26, v63, v32
    v_fmac_f32 v27, v63, v33
    v_accvgpr_read_b32 v34, a140
    v_lshlrev_b32 v32, 16, v34
    v_and_b32 v33, 0xffff0000, v34
    v_fmac_f32 v24, v64, v32
    v_fmac_f32 v25, v64, v33
    v_fmac_f32 v26, v66, v32
    v_fmac_f32 v27, v66, v33
    v_accvgpr_read_b32 v34, a141
    v_lshlrev_b32 v32, 16, v34
    v_and_b32 v33, 0xffff0000, v34
    v_fmac_f32 v24, v65, v32
    v_fmac_f32 v25, v65, v33
    v_fmac_f32 v26, v67, v32
    v_fmac_f32 v27, v67, v33
    v_accvgpr_read_b32 v34, a142
    v_lshlrev_b32 v32, 16, v34
    v_and_b32 v33, 0xffff0000, v34
    v_fmac_f32 v24, v68, v32
    v_fmac_f32 v25, v68, v33
    v_fmac_f32 v26, v70, v32
    v_fmac_f32 v27, v70, v33
    v_accvgpr_read_b32 v34, a143
    v_lshlrev_b32 v32, 16, v34
    v_and_b32 v33, 0xffff0000, v34
    v_fmac_f32 v24, v69, v32
    v_fmac_f32 v25, v69, v33
    v_fmac_f32 v26, v71, v32
    v_fmac_f32 v27, v71, v33
    ds_read_b128 v[40:43], v14 offset:8384
    ds_read_b128 v[44:47], v14 offset:8400
    ds_read_b128 v[48:51], v14 offset:8416
    ds_read_b128 v[52:55], v14 offset:8432
    ds_read_b128 v[56:59], v14 offset:8448
    ds_read_b128 v[60:63], v14 offset:8464
    ds_read_b128 v[64:67], v14 offset:8480
    ds_read_b128 v[68:71], v14 offset:8496
    s_waitcnt lgkmcnt(0)
    v_accvgpr_read_b32 v34, a144
    v_lshlrev_b32 v32, 16, v34
    v_and_b32 v33, 0xffff0000, v34
    v_fmac_f32 v24, v40, v32
    v_fmac_f32 v25, v40, v33
    v_fmac_f32 v26, v42, v32
    v_fmac_f32 v27, v42, v33
    v_accvgpr_read_b32 v34, a145
    v_lshlrev_b32 v32, 16, v34
    v_and_b32 v33, 0xffff0000, v34
    v_fmac_f32 v24, v41, v32
    v_fmac_f32 v25, v41, v33
    v_fmac_f32 v26, v43, v32
    v_fmac_f32 v27, v43, v33
    v_accvgpr_read_b32 v34, a146
    v_lshlrev_b32 v32, 16, v34
    v_and_b32 v33, 0xffff0000, v34
    v_fmac_f32 v24, v44, v32
    v_fmac_f32 v25, v44, v33
    v_fmac_f32 v26, v46, v32
    v_fmac_f32 v27, v46, v33
    v_accvgpr_read_b32 v34, a147
    v_lshlrev_b32 v32, 16, v34
    v_and_b32 v33, 0xffff0000, v34
    v_fmac_f32 v24, v45, v32
    v_fmac_f32 v25, v45, v33
    v_fmac_f32 v26, v47, v32
    v_fmac_f32 v27, v47, v33
    v_accvgpr_read_b32 v34, a148
    v_lshlrev_b32 v32, 16, v34
    v_and_b32 v33, 0xffff0000, v34
    v_fmac_f32 v24, v48, v32
    v_fmac_f32 v25, v48, v33
    v_fmac_f32 v26, v50, v32
    v_fmac_f32 v27, v50, v33
    v_accvgpr_read_b32 v34, a149
    v_lshlrev_b32 v32, 16, v34
    v_and_b32 v33, 0xffff0000, v34
    v_fmac_f32 v24, v49, v32
    v_fmac_f32 v25, v49, v33
    v_fmac_f32 v26, v51, v32
    v_fmac_f32 v27, v51, v33
    v_accvgpr_read_b32 v34, a150
    v_lshlrev_b32 v32, 16, v34
    v_and_b32 v33, 0xffff0000, v34
    v_fmac_f32 v24, v52, v32
    v_fmac_f32 v25, v52, v33
    v_fmac_f32 v26, v54, v32
    v_fmac_f32 v27, v54, v33
    v_accvgpr_read_b32 v34, a151
    v_lshlrev_b32 v32, 16, v34
    v_and_b32 v33, 0xffff0000, v34
    v_fmac_f32 v24, v53, v32
    v_fmac_f32 v25, v53, v33
    v_fmac_f32 v26, v55, v32
    v_fmac_f32 v27, v55, v33
    v_accvgpr_read_b32 v34, a152
    v_lshlrev_b32 v32, 16, v34
    v_and_b32 v33, 0xffff0000, v34
    v_fmac_f32 v24, v56, v32
    v_fmac_f32 v25, v56, v33
    v_fmac_f32 v26, v58, v32
    v_fmac_f32 v27, v58, v33
    v_accvgpr_read_b32 v34, a153
    v_lshlrev_b32 v32, 16, v34
    v_and_b32 v33, 0xffff0000, v34
    v_fmac_f32 v24, v57, v32
    v_fmac_f32 v25, v57, v33
    v_fmac_f32 v26, v59, v32
    v_fmac_f32 v27, v59, v33
    v_accvgpr_read_b32 v34, a154
    v_lshlrev_b32 v32, 16, v34
    v_and_b32 v33, 0xffff0000, v34
    v_fmac_f32 v24, v60, v32
    v_fmac_f32 v25, v60, v33
    v_fmac_f32 v26, v62, v32
    v_fmac_f32 v27, v62, v33
    v_accvgpr_read_b32 v34, a155
    v_lshlrev_b32 v32, 16, v34
    v_and_b32 v33, 0xffff0000, v34
    v_fmac_f32 v24, v61, v32
    v_fmac_f32 v25, v61, v33
    v_fmac_f32 v26, v63, v32
    v_fmac_f32 v27, v63, v33
    v_accvgpr_read_b32 v34, a156
    v_lshlrev_b32 v32, 16, v34
    v_and_b32 v33, 0xffff0000, v34
    v_fmac_f32 v24, v64, v32
    v_fmac_f32 v25, v64, v33
    v_fmac_f32 v26, v66, v32
    v_fmac_f32 v27, v66, v33
    v_accvgpr_read_b32 v34, a157
    v_lshlrev_b32 v32, 16, v34
    v_and_b32 v33, 0xffff0000, v34
    v_fmac_f32 v24, v65, v32
    v_fmac_f32 v25, v65, v33
    v_fmac_f32 v26, v67, v32
    v_fmac_f32 v27, v67, v33
    v_accvgpr_read_b32 v34, a158
    v_lshlrev_b32 v32, 16, v34
    v_and_b32 v33, 0xffff0000, v34
    v_fmac_f32 v24, v68, v32
    v_fmac_f32 v25, v68, v33
    v_fmac_f32 v26, v70, v32
    v_fmac_f32 v27, v70, v33
    v_accvgpr_read_b32 v34, a159
    v_lshlrev_b32 v32, 16, v34
    v_and_b32 v33, 0xffff0000, v34
    v_fmac_f32 v24, v69, v32
    v_fmac_f32 v25, v69, v33
    v_fmac_f32 v26, v71, v32
    v_fmac_f32 v27, v71, v33
    ds_read_b128 v[40:43], v14 offset:8512
    ds_read_b128 v[44:47], v14 offset:8528
    ds_read_b128 v[48:51], v14 offset:8544
    ds_read_b128 v[52:55], v14 offset:8560
    ds_read_b128 v[56:59], v14 offset:8576
    ds_read_b128 v[60:63], v14 offset:8592
    ds_read_b128 v[64:67], v14 offset:8608
    ds_read_b128 v[68:71], v14 offset:8624
    s_waitcnt lgkmcnt(0)
    v_accvgpr_read_b32 v34, a160
    v_lshlrev_b32 v32, 16, v34
    v_and_b32 v33, 0xffff0000, v34
    v_fmac_f32 v24, v40, v32
    v_fmac_f32 v25, v40, v33
    v_fmac_f32 v26, v42, v32
    v_fmac_f32 v27, v42, v33
    v_accvgpr_read_b32 v34, a161
    v_lshlrev_b32 v32, 16, v34
    v_and_b32 v33, 0xffff0000, v34
    v_fmac_f32 v24, v41, v32
    v_fmac_f32 v25, v41, v33
    v_fmac_f32 v26, v43, v32
    v_fmac_f32 v27, v43, v33
    v_accvgpr_read_b32 v34, a162
    v_lshlrev_b32 v32, 16, v34
    v_and_b32 v33, 0xffff0000, v34
    v_fmac_f32 v24, v44, v32
    v_fmac_f32 v25, v44, v33
    v_fmac_f32 v26, v46, v32
    v_fmac_f32 v27, v46, v33
    v_accvgpr_read_b32 v34, a163
    v_lshlrev_b32 v32, 16, v34
    v_and_b32 v33, 0xffff0000, v34
    v_fmac_f32 v24, v45, v32
    v_fmac_f32 v25, v45, v33
    v_fmac_f32 v26, v47, v32
    v_fmac_f32 v27, v47, v33
    v_accvgpr_read_b32 v34, a164
    v_lshlrev_b32 v32, 16, v34
    v_and_b32 v33, 0xffff0000, v34
    v_fmac_f32 v24, v48, v32
    v_fmac_f32 v25, v48, v33
    v_fmac_f32 v26, v50, v32
    v_fmac_f32 v27, v50, v33
    v_accvgpr_read_b32 v34, a165
    v_lshlrev_b32 v32, 16, v34
    v_and_b32 v33, 0xffff0000, v34
    v_fmac_f32 v24, v49, v32
    v_fmac_f32 v25, v49, v33
    v_fmac_f32 v26, v51, v32
    v_fmac_f32 v27, v51, v33
    v_accvgpr_read_b32 v34, a166
    v_lshlrev_b32 v32, 16, v34
    v_and_b32 v33, 0xffff0000, v34
    v_fmac_f32 v24, v52, v32
    v_fmac_f32 v25, v52, v33
    v_fmac_f32 v26, v54, v32
    v_fmac_f32 v27, v54, v33
    v_accvgpr_read_b32 v34, a167
    v_lshlrev_b32 v32, 16, v34
    v_and_b32 v33, 0xffff0000, v34
    v_fmac_f32 v24, v53, v32
    v_fmac_f32 v25, v53, v33
    v_fmac_f32 v26, v55, v32
    v_fmac_f32 v27, v55, v33
    v_accvgpr_read_b32 v34, a168
    v_lshlrev_b32 v32, 16, v34
    v_and_b32 v33, 0xffff0000, v34
    v_fmac_f32 v24, v56, v32
    v_fmac_f32 v25, v56, v33
    v_fmac_f32 v26, v58, v32
    v_fmac_f32 v27, v58, v33
    v_accvgpr_read_b32 v34, a169
    v_lshlrev_b32 v32, 16, v34
    v_and_b32 v33, 0xffff0000, v34
    v_fmac_f32 v24, v57, v32
    v_fmac_f32 v25, v57, v33
    v_fmac_f32 v26, v59, v32
    v_fmac_f32 v27, v59, v33
    v_accvgpr_read_b32 v34, a170
    v_lshlrev_b32 v32, 16, v34
    v_and_b32 v33, 0xffff0000, v34
    v_fmac_f32 v24, v60, v32
    v_fmac_f32 v25, v60, v33
    v_fmac_f32 v26, v62, v32
    v_fmac_f32 v27, v62, v33
    v_accvgpr_read_b32 v34, a171
    v_lshlrev_b32 v32, 16, v34
    v_and_b32 v33, 0xffff0000, v34
    v_fmac_f32 v24, v61, v32
    v_fmac_f32 v25, v61, v33
    v_fmac_f32 v26, v63, v32
    v_fmac_f32 v27, v63, v33
    v_accvgpr_read_b32 v34, a172
    v_lshlrev_b32 v32, 16, v34
    v_and_b32 v33, 0xffff0000, v34
    v_fmac_f32 v24, v64, v32
    v_fmac_f32 v25, v64, v33
    v_fmac_f32 v26, v66, v32
    v_fmac_f32 v27, v66, v33
    v_accvgpr_read_b32 v34, a173
    v_lshlrev_b32 v32, 16, v34
    v_and_b32 v33, 0xffff0000, v34
    v_fmac_f32 v24, v65, v32
    v_fmac_f32 v25, v65, v33
    v_fmac_f32 v26, v67, v32
    v_fmac_f32 v27, v67, v33
    v_accvgpr_read_b32 v34, a174
    v_lshlrev_b32 v32, 16, v34
    v_and_b32 v33, 0xffff0000, v34
    v_fmac_f32 v24, v68, v32
    v_fmac_f32 v25, v68, v33
    v_fmac_f32 v26, v70, v32
    v_fmac_f32 v27, v70, v33
    v_accvgpr_read_b32 v34, a175
    v_lshlrev_b32 v32, 16, v34
    v_and_b32 v33, 0xffff0000, v34
    v_fmac_f32 v24, v69, v32
    v_fmac_f32 v25, v69, v33
    v_fmac_f32 v26, v71, v32
    v_fmac_f32 v27, v71, v33
    ds_read_b128 v[40:43], v14 offset:8640
    ds_read_b128 v[44:47], v14 offset:8656
    ds_read_b128 v[48:51], v14 offset:8672
    ds_read_b128 v[52:55], v14 offset:8688
    ds_read_b128 v[56:59], v14 offset:8704
    ds_read_b128 v[60:63], v14 offset:8720
    ds_read_b128 v[64:67], v14 offset:8736
    ds_read_b128 v[68:71], v14 offset:8752
    s_waitcnt lgkmcnt(0)
    v_accvgpr_read_b32 v34, a176
    v_lshlrev_b32 v32, 16, v34
    v_and_b32 v33, 0xffff0000, v34
    v_fmac_f32 v24, v40, v32
    v_fmac_f32 v25, v40, v33
    v_fmac_f32 v26, v42, v32
    v_fmac_f32 v27, v42, v33
    v_accvgpr_read_b32 v34, a177
    v_lshlrev_b32 v32, 16, v34
    v_and_b32 v33, 0xffff0000, v34
    v_fmac_f32 v24, v41, v32
    v_fmac_f32 v25, v41, v33
    v_fmac_f32 v26, v43, v32
    v_fmac_f32 v27, v43, v33
    v_accvgpr_read_b32 v34, a178
    v_lshlrev_b32 v32, 16, v34
    v_and_b32 v33, 0xffff0000, v34
    v_fmac_f32 v24, v44, v32
    v_fmac_f32 v25, v44, v33
    v_fmac_f32 v26, v46, v32
    v_fmac_f32 v27, v46, v33
    v_accvgpr_read_b32 v34, a179
    v_lshlrev_b32 v32, 16, v34
    v_and_b32 v33, 0xffff0000, v34
    v_fmac_f32 v24, v45, v32
    v_fmac_f32 v25, v45, v33
    v_fmac_f32 v26, v47, v32
    v_fmac_f32 v27, v47, v33
    v_accvgpr_read_b32 v34, a180
    v_lshlrev_b32 v32, 16, v34
    v_and_b32 v33, 0xffff0000, v34
    v_fmac_f32 v24, v48, v32
    v_fmac_f32 v25, v48, v33
    v_fmac_f32 v26, v50, v32
    v_fmac_f32 v27, v50, v33
    v_accvgpr_read_b32 v34, a181
    v_lshlrev_b32 v32, 16, v34
    v_and_b32 v33, 0xffff0000, v34
    v_fmac_f32 v24, v49, v32
    v_fmac_f32 v25, v49, v33
    v_fmac_f32 v26, v51, v32
    v_fmac_f32 v27, v51, v33
    v_accvgpr_read_b32 v34, a182
    v_lshlrev_b32 v32, 16, v34
    v_and_b32 v33, 0xffff0000, v34
    v_fmac_f32 v24, v52, v32
    v_fmac_f32 v25, v52, v33
    v_fmac_f32 v26, v54, v32
    v_fmac_f32 v27, v54, v33
    v_accvgpr_read_b32 v34, a183
    v_lshlrev_b32 v32, 16, v34
    v_and_b32 v33, 0xffff0000, v34
    v_fmac_f32 v24, v53, v32
    v_fmac_f32 v25, v53, v33
    v_fmac_f32 v26, v55, v32
    v_fmac_f32 v27, v55, v33
    v_accvgpr_read_b32 v34, a184
    v_lshlrev_b32 v32, 16, v34
    v_and_b32 v33, 0xffff0000, v34
    v_fmac_f32 v24, v56, v32
    v_fmac_f32 v25, v56, v33
    v_fmac_f32 v26, v58, v32
    v_fmac_f32 v27, v58, v33
    v_accvgpr_read_b32 v34, a185
    v_lshlrev_b32 v32, 16, v34
    v_and_b32 v33, 0xffff0000, v34
    v_fmac_f32 v24, v57, v32
    v_fmac_f32 v25, v57, v33
    v_fmac_f32 v26, v59, v32
    v_fmac_f32 v27, v59, v33
    v_accvgpr_read_b32 v34, a186
    v_lshlrev_b32 v32, 16, v34
    v_and_b32 v33, 0xffff0000, v34
    v_fmac_f32 v24, v60, v32
    v_fmac_f32 v25, v60, v33
    v_fmac_f32 v26, v62, v32
    v_fmac_f32 v27, v62, v33
    v_accvgpr_read_b32 v34, a187
    v_lshlrev_b32 v32, 16, v34
    v_and_b32 v33, 0xffff0000, v34
    v_fmac_f32 v24, v61, v32
    v_fmac_f32 v25, v61, v33
    v_fmac_f32 v26, v63, v32
    v_fmac_f32 v27, v63, v33
    v_accvgpr_read_b32 v34, a188
    v_lshlrev_b32 v32, 16, v34
    v_and_b32 v33, 0xffff0000, v34
    v_fmac_f32 v24, v64, v32
    v_fmac_f32 v25, v64, v33
    v_fmac_f32 v26, v66, v32
    v_fmac_f32 v27, v66, v33
    v_accvgpr_read_b32 v34, a189
    v_lshlrev_b32 v32, 16, v34
    v_and_b32 v33, 0xffff0000, v34
    v_fmac_f32 v24, v65, v32
    v_fmac_f32 v25, v65, v33
    v_fmac_f32 v26, v67, v32
    v_fmac_f32 v27, v67, v33
    v_accvgpr_read_b32 v34, a190
    v_lshlrev_b32 v32, 16, v34
    v_and_b32 v33, 0xffff0000, v34
    v_fmac_f32 v24, v68, v32
    v_fmac_f32 v25, v68, v33
    v_fmac_f32 v26, v70, v32
    v_fmac_f32 v27, v70, v33
    v_accvgpr_read_b32 v34, a191
    v_lshlrev_b32 v32, 16, v34
    v_and_b32 v33, 0xffff0000, v34
    v_fmac_f32 v24, v69, v32
    v_fmac_f32 v25, v69, v33
    v_fmac_f32 v26, v71, v32
    v_fmac_f32 v27, v71, v33
    ds_read_b128 v[40:43], v14 offset:8768
    ds_read_b128 v[44:47], v14 offset:8784
    ds_read_b128 v[48:51], v14 offset:8800
    ds_read_b128 v[52:55], v14 offset:8816
    ds_read_b128 v[56:59], v14 offset:8832
    ds_read_b128 v[60:63], v14 offset:8848
    ds_read_b128 v[64:67], v14 offset:8864
    ds_read_b128 v[68:71], v14 offset:8880
    s_waitcnt lgkmcnt(0)
    v_accvgpr_read_b32 v34, a192
    v_lshlrev_b32 v32, 16, v34
    v_and_b32 v33, 0xffff0000, v34
    v_fmac_f32 v24, v40, v32
    v_fmac_f32 v25, v40, v33
    v_fmac_f32 v26, v42, v32
    v_fmac_f32 v27, v42, v33
    v_accvgpr_read_b32 v34, a193
    v_lshlrev_b32 v32, 16, v34
    v_and_b32 v33, 0xffff0000, v34
    v_fmac_f32 v24, v41, v32
    v_fmac_f32 v25, v41, v33
    v_fmac_f32 v26, v43, v32
    v_fmac_f32 v27, v43, v33
    v_accvgpr_read_b32 v34, a194
    v_lshlrev_b32 v32, 16, v34
    v_and_b32 v33, 0xffff0000, v34
    v_fmac_f32 v24, v44, v32
    v_fmac_f32 v25, v44, v33
    v_fmac_f32 v26, v46, v32
    v_fmac_f32 v27, v46, v33
    v_accvgpr_read_b32 v34, a195
    v_lshlrev_b32 v32, 16, v34
    v_and_b32 v33, 0xffff0000, v34
    v_fmac_f32 v24, v45, v32
    v_fmac_f32 v25, v45, v33
    v_fmac_f32 v26, v47, v32
    v_fmac_f32 v27, v47, v33
    v_accvgpr_read_b32 v34, a196
    v_lshlrev_b32 v32, 16, v34
    v_and_b32 v33, 0xffff0000, v34
    v_fmac_f32 v24, v48, v32
    v_fmac_f32 v25, v48, v33
    v_fmac_f32 v26, v50, v32
    v_fmac_f32 v27, v50, v33
    v_accvgpr_read_b32 v34, a197
    v_lshlrev_b32 v32, 16, v34
    v_and_b32 v33, 0xffff0000, v34
    v_fmac_f32 v24, v49, v32
    v_fmac_f32 v25, v49, v33
    v_fmac_f32 v26, v51, v32
    v_fmac_f32 v27, v51, v33
    v_accvgpr_read_b32 v34, a198
    v_lshlrev_b32 v32, 16, v34
    v_and_b32 v33, 0xffff0000, v34
    v_fmac_f32 v24, v52, v32
    v_fmac_f32 v25, v52, v33
    v_fmac_f32 v26, v54, v32
    v_fmac_f32 v27, v54, v33
    v_accvgpr_read_b32 v34, a199
    v_lshlrev_b32 v32, 16, v34
    v_and_b32 v33, 0xffff0000, v34
    v_fmac_f32 v24, v53, v32
    v_fmac_f32 v25, v53, v33
    v_fmac_f32 v26, v55, v32
    v_fmac_f32 v27, v55, v33
    v_accvgpr_read_b32 v34, a200
    v_lshlrev_b32 v32, 16, v34
    v_and_b32 v33, 0xffff0000, v34
    v_fmac_f32 v24, v56, v32
    v_fmac_f32 v25, v56, v33
    v_fmac_f32 v26, v58, v32
    v_fmac_f32 v27, v58, v33
    v_accvgpr_read_b32 v34, a201
    v_lshlrev_b32 v32, 16, v34
    v_and_b32 v33, 0xffff0000, v34
    v_fmac_f32 v24, v57, v32
    v_fmac_f32 v25, v57, v33
    v_fmac_f32 v26, v59, v32
    v_fmac_f32 v27, v59, v33
    v_accvgpr_read_b32 v34, a202
    v_lshlrev_b32 v32, 16, v34
    v_and_b32 v33, 0xffff0000, v34
    v_fmac_f32 v24, v60, v32
    v_fmac_f32 v25, v60, v33
    v_fmac_f32 v26, v62, v32
    v_fmac_f32 v27, v62, v33
    v_accvgpr_read_b32 v34, a203
    v_lshlrev_b32 v32, 16, v34
    v_and_b32 v33, 0xffff0000, v34
    v_fmac_f32 v24, v61, v32
    v_fmac_f32 v25, v61, v33
    v_fmac_f32 v26, v63, v32
    v_fmac_f32 v27, v63, v33
    v_accvgpr_read_b32 v34, a204
    v_lshlrev_b32 v32, 16, v34
    v_and_b32 v33, 0xffff0000, v34
    v_fmac_f32 v24, v64, v32
    v_fmac_f32 v25, v64, v33
    v_fmac_f32 v26, v66, v32
    v_fmac_f32 v27, v66, v33
    v_accvgpr_read_b32 v34, a205
    v_lshlrev_b32 v32, 16, v34
    v_and_b32 v33, 0xffff0000, v34
    v_fmac_f32 v24, v65, v32
    v_fmac_f32 v25, v65, v33
    v_fmac_f32 v26, v67, v32
    v_fmac_f32 v27, v67, v33
    v_accvgpr_read_b32 v34, a206
    v_lshlrev_b32 v32, 16, v34
    v_and_b32 v33, 0xffff0000, v34
    v_fmac_f32 v24, v68, v32
    v_fmac_f32 v25, v68, v33
    v_fmac_f32 v26, v70, v32
    v_fmac_f32 v27, v70, v33
    v_accvgpr_read_b32 v34, a207
    v_lshlrev_b32 v32, 16, v34
    v_and_b32 v33, 0xffff0000, v34
    v_fmac_f32 v24, v69, v32
    v_fmac_f32 v25, v69, v33
    v_fmac_f32 v26, v71, v32
    v_fmac_f32 v27, v71, v33
    ds_read_b128 v[40:43], v14 offset:8896
    ds_read_b128 v[44:47], v14 offset:8912
    ds_read_b128 v[48:51], v14 offset:8928
    ds_read_b128 v[52:55], v14 offset:8944
    ds_read_b128 v[56:59], v14 offset:8960
    ds_read_b128 v[60:63], v14 offset:8976
    ds_read_b128 v[64:67], v14 offset:8992
    ds_read_b128 v[68:71], v14 offset:9008
    s_waitcnt lgkmcnt(0)
    v_accvgpr_read_b32 v34, a208
    v_lshlrev_b32 v32, 16, v34
    v_and_b32 v33, 0xffff0000, v34
    v_fmac_f32 v24, v40, v32
    v_fmac_f32 v25, v40, v33
    v_fmac_f32 v26, v42, v32
    v_fmac_f32 v27, v42, v33
    v_accvgpr_read_b32 v34, a209
    v_lshlrev_b32 v32, 16, v34
    v_and_b32 v33, 0xffff0000, v34
    v_fmac_f32 v24, v41, v32
    v_fmac_f32 v25, v41, v33
    v_fmac_f32 v26, v43, v32
    v_fmac_f32 v27, v43, v33
    v_accvgpr_read_b32 v34, a210
    v_lshlrev_b32 v32, 16, v34
    v_and_b32 v33, 0xffff0000, v34
    v_fmac_f32 v24, v44, v32
    v_fmac_f32 v25, v44, v33
    v_fmac_f32 v26, v46, v32
    v_fmac_f32 v27, v46, v33
    v_accvgpr_read_b32 v34, a211
    v_lshlrev_b32 v32, 16, v34
    v_and_b32 v33, 0xffff0000, v34
    v_fmac_f32 v24, v45, v32
    v_fmac_f32 v25, v45, v33
    v_fmac_f32 v26, v47, v32
    v_fmac_f32 v27, v47, v33
    v_accvgpr_read_b32 v34, a212
    v_lshlrev_b32 v32, 16, v34
    v_and_b32 v33, 0xffff0000, v34
    v_fmac_f32 v24, v48, v32
    v_fmac_f32 v25, v48, v33
    v_fmac_f32 v26, v50, v32
    v_fmac_f32 v27, v50, v33
    v_accvgpr_read_b32 v34, a213
    v_lshlrev_b32 v32, 16, v34
    v_and_b32 v33, 0xffff0000, v34
    v_fmac_f32 v24, v49, v32
    v_fmac_f32 v25, v49, v33
    v_fmac_f32 v26, v51, v32
    v_fmac_f32 v27, v51, v33
    v_accvgpr_read_b32 v34, a214
    v_lshlrev_b32 v32, 16, v34
    v_and_b32 v33, 0xffff0000, v34
    v_fmac_f32 v24, v52, v32
    v_fmac_f32 v25, v52, v33
    v_fmac_f32 v26, v54, v32
    v_fmac_f32 v27, v54, v33
    v_accvgpr_read_b32 v34, a215
    v_lshlrev_b32 v32, 16, v34
    v_and_b32 v33, 0xffff0000, v34
    v_fmac_f32 v24, v53, v32
    v_fmac_f32 v25, v53, v33
    v_fmac_f32 v26, v55, v32
    v_fmac_f32 v27, v55, v33
    v_accvgpr_read_b32 v34, a216
    v_lshlrev_b32 v32, 16, v34
    v_and_b32 v33, 0xffff0000, v34
    v_fmac_f32 v24, v56, v32
    v_fmac_f32 v25, v56, v33
    v_fmac_f32 v26, v58, v32
    v_fmac_f32 v27, v58, v33
    v_accvgpr_read_b32 v34, a217
    v_lshlrev_b32 v32, 16, v34
    v_and_b32 v33, 0xffff0000, v34
    v_fmac_f32 v24, v57, v32
    v_fmac_f32 v25, v57, v33
    v_fmac_f32 v26, v59, v32
    v_fmac_f32 v27, v59, v33
    v_accvgpr_read_b32 v34, a218
    v_lshlrev_b32 v32, 16, v34
    v_and_b32 v33, 0xffff0000, v34
    v_fmac_f32 v24, v60, v32
    v_fmac_f32 v25, v60, v33
    v_fmac_f32 v26, v62, v32
    v_fmac_f32 v27, v62, v33
    v_accvgpr_read_b32 v34, a219
    v_lshlrev_b32 v32, 16, v34
    v_and_b32 v33, 0xffff0000, v34
    v_fmac_f32 v24, v61, v32
    v_fmac_f32 v25, v61, v33
    v_fmac_f32 v26, v63, v32
    v_fmac_f32 v27, v63, v33
    v_accvgpr_read_b32 v34, a220
    v_lshlrev_b32 v32, 16, v34
    v_and_b32 v33, 0xffff0000, v34
    v_fmac_f32 v24, v64, v32
    v_fmac_f32 v25, v64, v33
    v_fmac_f32 v26, v66, v32
    v_fmac_f32 v27, v66, v33
    v_accvgpr_read_b32 v34, a221
    v_lshlrev_b32 v32, 16, v34
    v_and_b32 v33, 0xffff0000, v34
    v_fmac_f32 v24, v65, v32
    v_fmac_f32 v25, v65, v33
    v_fmac_f32 v26, v67, v32
    v_fmac_f32 v27, v67, v33
    v_accvgpr_read_b32 v34, a222
    v_lshlrev_b32 v32, 16, v34
    v_and_b32 v33, 0xffff0000, v34
    v_fmac_f32 v24, v68, v32
    v_fmac_f32 v25, v68, v33
    v_fmac_f32 v26, v70, v32
    v_fmac_f32 v27, v70, v33
    v_accvgpr_read_b32 v34, a223
    v_lshlrev_b32 v32, 16, v34
    v_and_b32 v33, 0xffff0000, v34
    v_fmac_f32 v24, v69, v32
    v_fmac_f32 v25, v69, v33
    v_fmac_f32 v26, v71, v32
    v_fmac_f32 v27, v71, v33
    ds_read_b128 v[40:43], v14 offset:9024
    ds_read_b128 v[44:47], v14 offset:9040
    ds_read_b128 v[48:51], v14 offset:9056
    ds_read_b128 v[52:55], v14 offset:9072
    ds_read_b128 v[56:59], v14 offset:9088
    ds_read_b128 v[60:63], v14 offset:9104
    ds_read_b128 v[64:67], v14 offset:9120
    ds_read_b128 v[68:71], v14 offset:9136
    s_waitcnt lgkmcnt(0)
    v_accvgpr_read_b32 v34, a224
    v_lshlrev_b32 v32, 16, v34
    v_and_b32 v33, 0xffff0000, v34
    v_fmac_f32 v24, v40, v32
    v_fmac_f32 v25, v40, v33
    v_fmac_f32 v26, v42, v32
    v_fmac_f32 v27, v42, v33
    v_accvgpr_read_b32 v34, a225
    v_lshlrev_b32 v32, 16, v34
    v_and_b32 v33, 0xffff0000, v34
    v_fmac_f32 v24, v41, v32
    v_fmac_f32 v25, v41, v33
    v_fmac_f32 v26, v43, v32
    v_fmac_f32 v27, v43, v33
    v_accvgpr_read_b32 v34, a226
    v_lshlrev_b32 v32, 16, v34
    v_and_b32 v33, 0xffff0000, v34
    v_fmac_f32 v24, v44, v32
    v_fmac_f32 v25, v44, v33
    v_fmac_f32 v26, v46, v32
    v_fmac_f32 v27, v46, v33
    v_accvgpr_read_b32 v34, a227
    v_lshlrev_b32 v32, 16, v34
    v_and_b32 v33, 0xffff0000, v34
    v_fmac_f32 v24, v45, v32
    v_fmac_f32 v25, v45, v33
    v_fmac_f32 v26, v47, v32
    v_fmac_f32 v27, v47, v33
    v_accvgpr_read_b32 v34, a228
    v_lshlrev_b32 v32, 16, v34
    v_and_b32 v33, 0xffff0000, v34
    v_fmac_f32 v24, v48, v32
    v_fmac_f32 v25, v48, v33
    v_fmac_f32 v26, v50, v32
    v_fmac_f32 v27, v50, v33
    v_accvgpr_read_b32 v34, a229
    v_lshlrev_b32 v32, 16, v34
    v_and_b32 v33, 0xffff0000, v34
    v_fmac_f32 v24, v49, v32
    v_fmac_f32 v25, v49, v33
    v_fmac_f32 v26, v51, v32
    v_fmac_f32 v27, v51, v33
    v_accvgpr_read_b32 v34, a230
    v_lshlrev_b32 v32, 16, v34
    v_and_b32 v33, 0xffff0000, v34
    v_fmac_f32 v24, v52, v32
    v_fmac_f32 v25, v52, v33
    v_fmac_f32 v26, v54, v32
    v_fmac_f32 v27, v54, v33
    v_accvgpr_read_b32 v34, a231
    v_lshlrev_b32 v32, 16, v34
    v_and_b32 v33, 0xffff0000, v34
    v_fmac_f32 v24, v53, v32
    v_fmac_f32 v25, v53, v33
    v_fmac_f32 v26, v55, v32
    v_fmac_f32 v27, v55, v33
    v_accvgpr_read_b32 v34, a232
    v_lshlrev_b32 v32, 16, v34
    v_and_b32 v33, 0xffff0000, v34
    v_fmac_f32 v24, v56, v32
    v_fmac_f32 v25, v56, v33
    v_fmac_f32 v26, v58, v32
    v_fmac_f32 v27, v58, v33
    v_accvgpr_read_b32 v34, a233
    v_lshlrev_b32 v32, 16, v34
    v_and_b32 v33, 0xffff0000, v34
    v_fmac_f32 v24, v57, v32
    v_fmac_f32 v25, v57, v33
    v_fmac_f32 v26, v59, v32
    v_fmac_f32 v27, v59, v33
    v_accvgpr_read_b32 v34, a234
    v_lshlrev_b32 v32, 16, v34
    v_and_b32 v33, 0xffff0000, v34
    v_fmac_f32 v24, v60, v32
    v_fmac_f32 v25, v60, v33
    v_fmac_f32 v26, v62, v32
    v_fmac_f32 v27, v62, v33
    v_accvgpr_read_b32 v34, a235
    v_lshlrev_b32 v32, 16, v34
    v_and_b32 v33, 0xffff0000, v34
    v_fmac_f32 v24, v61, v32
    v_fmac_f32 v25, v61, v33
    v_fmac_f32 v26, v63, v32
    v_fmac_f32 v27, v63, v33
    v_accvgpr_read_b32 v34, a236
    v_lshlrev_b32 v32, 16, v34
    v_and_b32 v33, 0xffff0000, v34
    v_fmac_f32 v24, v64, v32
    v_fmac_f32 v25, v64, v33
    v_fmac_f32 v26, v66, v32
    v_fmac_f32 v27, v66, v33
    v_accvgpr_read_b32 v34, a237
    v_lshlrev_b32 v32, 16, v34
    v_and_b32 v33, 0xffff0000, v34
    v_fmac_f32 v24, v65, v32
    v_fmac_f32 v25, v65, v33
    v_fmac_f32 v26, v67, v32
    v_fmac_f32 v27, v67, v33
    v_accvgpr_read_b32 v34, a238
    v_lshlrev_b32 v32, 16, v34
    v_and_b32 v33, 0xffff0000, v34
    v_fmac_f32 v24, v68, v32
    v_fmac_f32 v25, v68, v33
    v_fmac_f32 v26, v70, v32
    v_fmac_f32 v27, v70, v33
    v_accvgpr_read_b32 v34, a239
    v_lshlrev_b32 v32, 16, v34
    v_and_b32 v33, 0xffff0000, v34
    v_fmac_f32 v24, v69, v32
    v_fmac_f32 v25, v69, v33
    v_fmac_f32 v26, v71, v32
    v_fmac_f32 v27, v71, v33
    s_lshl_b32 s25, s28, 12
    s_add_u32 s25, s25, 6356992
    buffer_store_dwordx4 v[24:27], v2, s[8:11], s25 offen sc1
    s_waitcnt vmcnt(0)
    s_barrier
    s_cmp_lg_u32 s21, 0
    s_cbranch_scc1 L_sigmoe
    s_mov_b64 exec, 1
    v_mov_b32 v10, 100
    v_mov_b32 v11, 1
    buffer_atomic_add v11, v10, s[12:15], 0 offen sc0
    s_mov_b64 exec, -1
L_sigmoe:
    s_waitcnt vmcnt(0)
    s_cmp_lg_u32 s21, 0
    s_cbranch_scc1 L_m_w
    s_mov_b64 exec, 1
    ds_write_b32 v14, v11 offset:32
    s_mov_b64 exec, -1
L_m_w:
    s_waitcnt lgkmcnt(0)
    s_barrier
    ds_read_b32 v11, v14 offset:32
    s_waitcnt lgkmcnt(0)
    v_readfirstlane_b32 s25, v11
    s_cmp_lg_u32 s25, 15
    s_cbranch_scc1 L_orole2
    s_mov_b32 s25, 6356992
    s_nop 1
    buffer_load_dwordx4 v[40:43], v2, s[8:11], s25 offen sc1
    s_mov_b32 s25, 6361088
    buffer_load_dwordx4 v[44:47], v2, s[8:11], s25 offen sc1
    s_mov_b32 s25, 6365184
    buffer_load_dwordx4 v[48:51], v2, s[8:11], s25 offen sc1
    s_mov_b32 s25, 6369280
    buffer_load_dwordx4 v[52:55], v2, s[8:11], s25 offen sc1
    s_mov_b32 s25, 6373376
    buffer_load_dwordx4 v[56:59], v2, s[8:11], s25 offen sc1
    s_mov_b32 s25, 6377472
    buffer_load_dwordx4 v[60:63], v2, s[8:11], s25 offen sc1
    s_mov_b32 s25, 6381568
    buffer_load_dwordx4 v[64:67], v2, s[8:11], s25 offen sc1
    s_mov_b32 s25, 6385664
    buffer_load_dwordx4 v[68:71], v2, s[8:11], s25 offen sc1
    s_mov_b32 s25, 6389760
    buffer_load_dwordx4 v[72:75], v2, s[8:11], s25 offen sc1
    s_mov_b32 s25, 6393856
    buffer_load_dwordx4 v[76:79], v2, s[8:11], s25 offen sc1
    s_mov_b32 s25, 6397952
    buffer_load_dwordx4 v[80:83], v2, s[8:11], s25 offen sc1
    s_mov_b32 s25, 6402048
    buffer_load_dwordx4 v[84:87], v2, s[8:11], s25 offen sc1
    s_mov_b32 s25, 6406144
    buffer_load_dwordx4 v[88:91], v2, s[8:11], s25 offen sc1
    s_mov_b32 s25, 6410240
    buffer_load_dwordx4 v[92:95], v2, s[8:11], s25 offen sc1
    s_mov_b32 s25, 6414336
    buffer_load_dwordx4 v[96:99], v2, s[8:11], s25 offen sc1
    s_mov_b32 s25, 6418432
    buffer_load_dwordx4 v[100:103], v2, s[8:11], s25 offen sc1
    v_mul_f32 v32, 0xbfb8aa3b, v18
    v_exp_f32 v32, v32
    s_nop 0
    v_add_f32 v32, 1.0, v32
    v_rcp_f32 v32, v32
    s_nop 0
    v_cvt_pk_bf16_f32 v32, v32, v32
    v_and_b32 v32, 0xffff0000, v32
    v_mul_f32 v33, 0xbfb8aa3b, v19
    v_exp_f32 v33, v33
    s_nop 0
    v_add_f32 v33, 1.0, v33
    v_rcp_f32 v33, v33
    s_nop 0
    v_cvt_pk_bf16_f32 v33, v33, v33
    v_and_b32 v33, 0xffff0000, v33
    s_waitcnt vmcnt(0)
    v_add_f32 v40, v40, v44
    v_add_f32 v41, v41, v45
    v_add_f32 v42, v42, v46
    v_add_f32 v43, v43, v47
    v_add_f32 v40, v40, v48
    v_add_f32 v41, v41, v49
    v_add_f32 v42, v42, v50
    v_add_f32 v43, v43, v51
    v_add_f32 v40, v40, v52
    v_add_f32 v41, v41, v53
    v_add_f32 v42, v42, v54
    v_add_f32 v43, v43, v55
    v_add_f32 v40, v40, v56
    v_add_f32 v41, v41, v57
    v_add_f32 v42, v42, v58
    v_add_f32 v43, v43, v59
    v_add_f32 v40, v40, v60
    v_add_f32 v41, v41, v61
    v_add_f32 v42, v42, v62
    v_add_f32 v43, v43, v63
    v_add_f32 v40, v40, v64
    v_add_f32 v41, v41, v65
    v_add_f32 v42, v42, v66
    v_add_f32 v43, v43, v67
    v_add_f32 v40, v40, v68
    v_add_f32 v41, v41, v69
    v_add_f32 v42, v42, v70
    v_add_f32 v43, v43, v71
    v_add_f32 v40, v40, v72
    v_add_f32 v41, v41, v73
    v_add_f32 v42, v42, v74
    v_add_f32 v43, v43, v75
    v_add_f32 v40, v40, v76
    v_add_f32 v41, v41, v77
    v_add_f32 v42, v42, v78
    v_add_f32 v43, v43, v79
    v_add_f32 v40, v40, v80
    v_add_f32 v41, v41, v81
    v_add_f32 v42, v42, v82
    v_add_f32 v43, v43, v83
    v_add_f32 v40, v40, v84
    v_add_f32 v41, v41, v85
    v_add_f32 v42, v42, v86
    v_add_f32 v43, v43, v87
    v_add_f32 v40, v40, v88
    v_add_f32 v41, v41, v89
    v_add_f32 v42, v42, v90
    v_add_f32 v43, v43, v91
    v_add_f32 v40, v40, v92
    v_add_f32 v41, v41, v93
    v_add_f32 v42, v42, v94
    v_add_f32 v43, v43, v95
    v_add_f32 v40, v40, v96
    v_add_f32 v41, v41, v97
    v_add_f32 v42, v42, v98
    v_add_f32 v43, v43, v99
    v_add_f32 v40, v40, v100
    v_add_f32 v41, v41, v101
    v_add_f32 v42, v42, v102
    v_add_f32 v43, v43, v103
    v_lshlrev_b32 v34, 16, v16
    v_and_b32 v35, 0xffff0000, v16
    v_cvt_pk_bf16_f32 v40, v40, v40
    v_and_b32 v40, 0xffff0000, v40
    v_mul_f32 v40, v40, v32
    v_cvt_pk_bf16_f32 v40, v40, v40
    v_and_b32 v40, 0xffff0000, v40
    v_add_f32 v40, v40, v34
    v_cvt_pk_bf16_f32 v41, v41, v41
    v_and_b32 v41, 0xffff0000, v41
    v_mul_f32 v41, v41, v32
    v_cvt_pk_bf16_f32 v41, v41, v41
    v_and_b32 v41, 0xffff0000, v41
    v_add_f32 v41, v41, v35
    v_cvt_pk_bf16_f32 v48, v40, v41
    s_lshl_b32 s25, s29, 10
    s_add_u32 s25, s25, 4194304
    buffer_store_dword v48, v7, s[8:11], s25 offen sc1
    v_lshlrev_b32 v34, 16, v17
    v_and_b32 v35, 0xffff0000, v17
    v_cvt_pk_bf16_f32 v42, v42, v42
    v_and_b32 v42, 0xffff0000, v42
    v_mul_f32 v42, v42, v33
    v_cvt_pk_bf16_f32 v42, v42, v42
    v_and_b32 v42, 0xffff0000, v42
    v_add_f32 v42, v42, v34
    v_cvt_pk_bf16_f32 v43, v43, v43
    v_and_b32 v43, 0xffff0000, v43
    v_mul_f32 v43, v43, v33
    v_cvt_pk_bf16_f32 v43, v43, v43
    v_and_b32 v43, 0xffff0000, v43
    v_add_f32 v43, v43, v35
    v_cvt_pk_bf16_f32 v49, v42, v43
    s_lshl_b32 s25, s30, 10
    s_add_u32 s25, s25, 4194304
    buffer_store_dword v49, v7, s[8:11], s25 offen sc1
    s_waitcnt vmcnt(0)
    s_barrier
    s_cmp_lg_u32 s21, 0
    s_cbranch_scc1 L_sigmoed
    s_mov_b64 exec, 1
    v_mov_b32 v10, 132
    v_mov_b32 v11, 1
    buffer_atomic_add v11, v10, s[12:15], 0 offen
    s_mov_b64 exec, -1
L_sigmoed:
    s_branch L_orole2
L_code_end:
.section .rodata,"a"
.p2align 6
.amdhsa_kernel parallel_sum__memory_aug_recurrent_mem_tr__moe_arch_mod__prompt_kernel
  .amdhsa_next_free_vgpr 512
  .amdhsa_next_free_sgpr 102
  .amdhsa_accum_offset 256
  .amdhsa_group_segment_fixed_size 0
  .amdhsa_kernarg_size 120
  .amdhsa_user_sgpr_count 2
  .amdhsa_user_sgpr_kernarg_segment_ptr 1
  .amdhsa_system_sgpr_workgroup_id_x 1
  .amdhsa_float_denorm_mode_32 3
  .amdhsa_float_denorm_mode_16_64 3
.end_amdhsa_kernel
```
